```python
import torch

def _softmax(x, axis=-1):
    return torch.softmax(x, dim=axis)
def _gelu(x):
    return torch.nn.functional.gelu(x, approximate="tanh")
def _silu(x):
    return torch.nn.functional.silu(x)
def _sigmoid(x):
    return torch.sigmoid(x)
def _layernorm(x, axis=-1, eps=1e-5):
    m = x.mean(dim=axis, keepdim=True)
    v = x.var(dim=axis, keepdim=True, unbiased=False)
    return (x - m) / torch.sqrt(v + eps)
def _scatter_add(tgt, idx, src, axis=0):
    return tgt.clone().index_add_(axis, idx, src)
def _segment_sum(src, seg, n):
    out = torch.zeros((n,) + src.shape[1:], dtype=src.dtype)
    return out.index_add_(0, seg, src)
def _pad(x, pw):
    flat = tuple(v for pair in reversed(pw) for v in pair)
    return torch.nn.functional.pad(x, flat)

kernel_name = 'standalone__mha_softmax__near_ridge'

def setup_inputs():

    _w = (lambda a: (lambda t: t.to(torch.bfloat16) if t.is_floating_point() else t)(torch.as_tensor(a)))
    B, H, Sq, Sk, D = 8, 32, 512, 512, 128
    return {
        "q": _w((lambda *s: torch.randn(*s, dtype=torch.bfloat16) * 0.8)(B, H, Sq, D)),
        "k": _w((lambda *s: torch.randn(*s, dtype=torch.bfloat16) * 0.8)(B, H, Sk, D)),
        "v": _w((lambda *s: torch.randn(*s, dtype=torch.bfloat16) * 0.05)(B, H, Sk, D)),
    }

def reference(q, k, v):
    scale = q.shape[-1] ** -0.5
    scores = torch.einsum("bhqd,bhkd->bhqk", q, k) * scale
    p = _softmax(scores, axis=-1)
    return torch.einsum("bhqk,bhkd->bhqd", p, v)
```

```asm
; @launch grid=(256,1,1) block=(256,1,1) lds=163840
.amdgcn_target "amdgcn-amd-amdhsa--gfx950"
.text
.p2align 12
.globl standalone__mha_softmax__near_ridge_kernel
.p2align 8
.type standalone__mha_softmax__near_ridge_kernel,@function
standalone__mha_softmax__near_ridge_kernel:
    s_cmp_ge_u32 s2, 256
    s_cbranch_scc1 L_end
    s_load_dwordx2 s[8:9], s[0:1], 8
    s_load_dwordx2 s[4:5], s[0:1], 0
    s_load_dwordx2 s[12:13], s[0:1], 16
    s_load_dwordx2 s[16:17], s[0:1], 24
    s_getpc_b64 s[96:97]
L_pc:
    v_lshrrev_b32 v132, 2, v0
    s_and_b32 s97, s97, 0xffff
    s_mov_b32 s98, L_slow_next-L_pc
    s_mov_b32 s99, 0x20000
    v_lshlrev_b32 v132, 7, v132
    buffer_load_dword a247, v132, s[96:99], 0 offen offset:0
    s_bfe_u32 s23, s2, 0x50003
    s_lshl_b32 s23, s23, 9
    v_lshrrev_b32 v133, 6, v0
    v_bfe_u32 v132, v0, 4, 2
    v_lshlrev_b32 v133, 14, v133
    v_lshl_add_u32 v132, v132, 7, v133
    buffer_load_dword a247, v132, s[96:99], s23 offen offset:0
    v_lshrrev_b32 v128, 6, v0
    v_and_b32 v0, 63, v0
    v_readfirstlane_b32 s21, v128
    v_lshrrev_b32 v129, 4, v0
    v_bfe_u32 v130, v0, 2, 2
    v_and_b32 v131, 3, v0
    v_lshlrev_b32 v5, 6, v129
    v_lshl_add_u32 v5, v130, 8, v5
    v_lshl_add_u32 v5, v131, 4, v5
    v_xor_b32 v6, 32, v5
    s_and_b32 s3, s2, 7
    s_lshr_b32 s23, s2, 3
    s_lshr_b32 s24, s23, 1
    s_lshl_b32 s3, s3, 4
    s_add_u32 s3, s3, s24
    s_lshl_b32 s3, s3, 18
    s_and_b32 s23, s23, 1
    s_lshl_b32 s23, s23, 16
    s_lshl_b32 s24, s21, 14
    s_add_u32 s24, s24, s23
    s_add_u32 s24, s24, s3
    s_add_u32 s25, s24, 131072
    s_lshl_b32 s22, s21, 11
    s_lshl_b32 s26, s21, 13
    s_and_b32 s23, s21, 1
    s_lshl_b32 s23, s23, 5
    s_or_b32 s23, s23, s22
    v_xor_b32 v1, s23, v5
    s_add_u32 s32, s3, 0
    s_add_u32 s33, s3, 8192
    s_mov_b32 s10, 33554432
    s_mov_b32 s11, 0x20000
    s_mov_b32 s6, 33554432
    s_mov_b32 s7, 0x20000
    s_mov_b32 s14, 33554432
    s_mov_b32 s15, 0x20000
    s_mov_b32 s18, 33554432
    s_mov_b32 s19, 0x20000
    s_add_u32 m0, s22, 0
    s_waitcnt lgkmcnt(0)
    buffer_load_dwordx4 v1, s[8:11], s32 offen offset:0 nt lds
    buffer_load_dwordx4 v1, s[8:11], s32 offen offset:1024 nt lds
    s_add_u32 m0, s26, 131072
    s_xor_b32 s27, s24, 0
    buffer_load_dwordx4 v5, s[4:7], s27 offen offset:0 nt lds
    buffer_load_dwordx4 v5, s[4:7], s27 offen offset:1024 nt lds
    buffer_load_dwordx4 v6, s[4:7], s27 offen offset:2048 nt lds
    buffer_load_dwordx4 v6, s[4:7], s27 offen offset:3072 nt lds
    s_add_u32 m0, s26, 135168
    s_xor_b32 s27, s24, 4096
    buffer_load_dwordx4 v5, s[4:7], s27 offen offset:0 nt lds
    buffer_load_dwordx4 v5, s[4:7], s27 offen offset:1024 nt lds
    buffer_load_dwordx4 v6, s[4:7], s27 offen offset:2048 nt lds
    buffer_load_dwordx4 v6, s[4:7], s27 offen offset:3072 nt lds
    s_add_u32 s34, s3, 16384
    s_add_u32 s35, s3, 24576
    s_add_u32 s36, s3, 32768
    s_add_u32 s37, s3, 40960
    s_add_u32 s38, s3, 49152
    s_add_u32 s39, s3, 57344
    s_add_u32 s40, s3, 65536
    s_add_u32 s41, s3, 73728
    s_add_u32 s42, s3, 81920
    s_add_u32 s43, s3, 90112
    s_add_u32 s44, s3, 98304
    s_add_u32 s45, s3, 106496
    s_add_u32 s46, s3, 114688
    s_add_u32 s47, s3, 122880
    s_add_u32 s48, s3, 131072
    s_add_u32 s49, s3, 139264
    s_add_u32 s50, s3, 147456
    s_add_u32 s51, s3, 155648
    s_add_u32 s52, s3, 163840
    s_add_u32 s53, s3, 172032
    s_add_u32 s54, s3, 180224
    s_add_u32 s55, s3, 188416
    s_add_u32 s56, s3, 196608
    s_add_u32 s57, s3, 204800
    s_add_u32 s58, s3, 212992
    s_add_u32 s59, s3, 221184
    s_add_u32 s60, s3, 229376
    s_add_u32 s61, s3, 237568
    s_add_u32 s62, s3, 245760
    s_add_u32 s63, s3, 253952
    s_bfe_u32 s0, s2, 0x50003
    s_lshl_b32 s0, s0, 2
    s_add_u32 s0, s0, s21
    s_lshl_b32 s0, s0, 7
    s_mov_b32 s20, 0x3e0293ee
    v_lshlrev_b32 v138, 4, v0
    v_accvgpr_write_b32 a244, v138
    v_bfe_u32 v132, v0, 2, 1
    v_bfe_u32 v133, v0, 3, 1
    v_lshlrev_b32 v134, 1, v132
    v_add_u32 v135, v134, v133
    v_lshlrev_b32 v2, 10, v135
    v_lshl_add_u32 v2, v131, 6, v2
    v_xor_b32 v134, v134, v129
    v_lshl_add_u32 v2, v134, 4, v2
    s_add_u32 s23, s26, 98304
    v_add_u32 v7, s23, v2
    v_lshl_add_u32 v135, v135, 2, v131
    v_bfe_u32 v136, v0, 4, 1
    v_lshrrev_b32 v137, 5, v0
    v_lshlrev_b32 v138, 8, v135
    v_xor_b32 v139, v129, v0
    v_and_b32 v139, 7, v139
    v_lshl_add_u32 v138, v139, 4, v138
    s_add_u32 s23, s26, 131072
    v_add_u32 v138, s23, v138
    v_accvgpr_write_b32 a245, v138
    v_xor_b32 v135, v129, v0
    v_and_b32 v135, 15, v135
    v_lshlrev_b32 v138, 8, v129
    v_lshl_add_u32 v138, v135, 4, v138
    v_add_u32 v138, s23, v138
    v_accvgpr_write_b32 a246, v138
    v_lshlrev_b32 v3, 11, v136
    v_lshl_add_u32 v3, v137, 10, v3
    v_lshl_add_u32 v3, v130, 6, v3
    v_add_u32 v3, 65536, v3
    v_lshlrev_b32 v139, 1, v136
    v_xor_b32 v139, v139, v131
    v_lshl_add_u32 v3, v139, 4, v3
    v_add_u32 v4, 8, v3
    v_mov_b32 v135, 0x3f803f80
    v_cmp_eq_u32 vcc, 0, v131
    s_nop 1
    v_cndmask_b32 v135, 0, v135, vcc
    v_accvgpr_write_b32 a240, v135
    v_accvgpr_write_b32 a241, v135
    v_accvgpr_write_b32 a242, v135
    v_accvgpr_write_b32 a243, v135
    s_add_u32 m0, s22, 8192
    s_nop 0
    buffer_load_dwordx4 v1, s[8:11], s33 offen offset:0 nt lds
    buffer_load_dwordx4 v1, s[8:11], s33 offen offset:1024 nt lds
    s_branch L_warm
.p2align 12
L_warm:
    s_mov_b64 exec, 0
    s_cmp_eq_u32 s21, 0
    s_cbranch_scc1 L_pad0
    s_cmp_eq_u32 s21, 1
    s_cbranch_scc1 L_pad1
    s_cmp_eq_u32 s21, 2
    s_cbranch_scc1 L_pad2
    s_branch L_pad3
L_back0:
    s_mov_b64 exec, -1
    s_waitcnt vmcnt(6)
    s_barrier
    ds_read_b128 v[128:131], v7 offset:32768
    ds_read_b128 v[132:135], v7 offset:33024
    ds_read_b128 v[136:139], v7 offset:33280
    ds_read_b128 v[140:143], v7 offset:33536
    ds_read_b128 a[96:99], v2 offset:0
    ds_read_b128 a[100:103], v2 offset:256
    ds_read_b128 a[104:107], v2 offset:512
    ds_read_b128 a[108:111], v2 offset:768
    ds_read_b128 a[112:115], v2 offset:4096
    ds_read_b128 a[116:119], v2 offset:4352
    ds_read_b128 a[120:123], v2 offset:4608
    ds_read_b128 a[124:127], v2 offset:4864
    s_add_u32 m0, s26, 98304
    s_xor_b32 s27, s24, 8192
    buffer_load_dwordx4 v5, s[4:7], s27 offen offset:0 nt lds
    buffer_load_dwordx4 v5, s[4:7], s27 offen offset:1024 nt lds
    buffer_load_dwordx4 v6, s[4:7], s27 offen offset:2048 nt lds
    buffer_load_dwordx4 v6, s[4:7], s27 offen offset:3072 nt lds
    s_waitcnt lgkmcnt(8)
    v_lshlrev_b32 v160, 16, v128
    v_and_b32 v161, 0xffff0000, v128
    v_pk_mul_f32 v[160:161], v[160:161], s[20:21] op_sel_hi:[1,0]
    v_cvt_pk_bf16_f32 v128, v160, v161
    v_accvgpr_write_b32 a0, v128
    v_lshlrev_b32 v160, 16, v129
    v_and_b32 v161, 0xffff0000, v129
    v_pk_mul_f32 v[160:161], v[160:161], s[20:21] op_sel_hi:[1,0]
    v_cvt_pk_bf16_f32 v129, v160, v161
    v_accvgpr_write_b32 a1, v129
    v_lshlrev_b32 v160, 16, v130
    v_and_b32 v161, 0xffff0000, v130
    v_pk_mul_f32 v[160:161], v[160:161], s[20:21] op_sel_hi:[1,0]
    v_cvt_pk_bf16_f32 v130, v160, v161
    v_accvgpr_write_b32 a2, v130
    v_lshlrev_b32 v160, 16, v131
    v_and_b32 v161, 0xffff0000, v131
    v_pk_mul_f32 v[160:161], v[160:161], s[20:21] op_sel_hi:[1,0]
    v_cvt_pk_bf16_f32 v131, v160, v161
    v_accvgpr_write_b32 a3, v131
    v_lshlrev_b32 v162, 16, v132
    v_and_b32 v163, 0xffff0000, v132
    v_pk_mul_f32 v[162:163], v[162:163], s[20:21] op_sel_hi:[1,0]
    v_cvt_pk_bf16_f32 v132, v162, v163
    v_accvgpr_write_b32 a4, v132
    v_lshlrev_b32 v162, 16, v133
    v_and_b32 v163, 0xffff0000, v133
    v_pk_mul_f32 v[162:163], v[162:163], s[20:21] op_sel_hi:[1,0]
    v_cvt_pk_bf16_f32 v133, v162, v163
    v_accvgpr_write_b32 a5, v133
    v_lshlrev_b32 v162, 16, v134
    v_and_b32 v163, 0xffff0000, v134
    v_pk_mul_f32 v[162:163], v[162:163], s[20:21] op_sel_hi:[1,0]
    v_cvt_pk_bf16_f32 v134, v162, v163
    v_accvgpr_write_b32 a6, v134
    v_lshlrev_b32 v162, 16, v135
    v_and_b32 v163, 0xffff0000, v135
    v_pk_mul_f32 v[162:163], v[162:163], s[20:21] op_sel_hi:[1,0]
    v_cvt_pk_bf16_f32 v135, v162, v163
    v_accvgpr_write_b32 a7, v135
    v_lshlrev_b32 v160, 16, v136
    v_and_b32 v161, 0xffff0000, v136
    v_pk_mul_f32 v[160:161], v[160:161], s[20:21] op_sel_hi:[1,0]
    v_cvt_pk_bf16_f32 v136, v160, v161
    v_accvgpr_write_b32 a8, v136
    v_lshlrev_b32 v160, 16, v137
    v_and_b32 v161, 0xffff0000, v137
    v_pk_mul_f32 v[160:161], v[160:161], s[20:21] op_sel_hi:[1,0]
    v_cvt_pk_bf16_f32 v137, v160, v161
    v_accvgpr_write_b32 a9, v137
    v_lshlrev_b32 v160, 16, v138
    v_and_b32 v161, 0xffff0000, v138
    v_pk_mul_f32 v[160:161], v[160:161], s[20:21] op_sel_hi:[1,0]
    v_cvt_pk_bf16_f32 v138, v160, v161
    v_accvgpr_write_b32 a10, v138
    v_lshlrev_b32 v160, 16, v139
    v_and_b32 v161, 0xffff0000, v139
    v_pk_mul_f32 v[160:161], v[160:161], s[20:21] op_sel_hi:[1,0]
    v_cvt_pk_bf16_f32 v139, v160, v161
    v_accvgpr_write_b32 a11, v139
    v_lshlrev_b32 v162, 16, v140
    v_and_b32 v163, 0xffff0000, v140
    v_pk_mul_f32 v[162:163], v[162:163], s[20:21] op_sel_hi:[1,0]
    v_cvt_pk_bf16_f32 v140, v162, v163
    v_accvgpr_write_b32 a12, v140
    v_lshlrev_b32 v162, 16, v141
    v_and_b32 v163, 0xffff0000, v141
    v_pk_mul_f32 v[162:163], v[162:163], s[20:21] op_sel_hi:[1,0]
    v_cvt_pk_bf16_f32 v141, v162, v163
    v_accvgpr_write_b32 a13, v141
    v_lshlrev_b32 v162, 16, v142
    v_and_b32 v163, 0xffff0000, v142
    v_pk_mul_f32 v[162:163], v[162:163], s[20:21] op_sel_hi:[1,0]
    v_cvt_pk_bf16_f32 v142, v162, v163
    v_accvgpr_write_b32 a14, v142
    v_lshlrev_b32 v162, 16, v143
    v_and_b32 v163, 0xffff0000, v143
    v_pk_mul_f32 v[162:163], v[162:163], s[20:21] op_sel_hi:[1,0]
    v_cvt_pk_bf16_f32 v143, v162, v163
    v_accvgpr_write_b32 a15, v143
    s_waitcnt lgkmcnt(0)
    v_mfma_f32_16x16x32_bf16 v[64:67], a[96:99], a[0:3], 0
    v_mfma_f32_16x16x32_bf16 v[64:67], a[100:103], a[4:7], v[64:67]
    v_mfma_f32_16x16x32_bf16 v[64:67], a[104:107], a[8:11], v[64:67]
    v_mfma_f32_16x16x32_bf16 v[64:67], a[108:111], a[12:15], v[64:67]
    v_mfma_f32_16x16x32_bf16 v[68:71], a[124:127], a[12:15], 0
    v_mfma_f32_16x16x32_bf16 v[68:71], a[120:123], a[8:11], v[68:71]
    v_mfma_f32_16x16x32_bf16 v[68:71], a[116:119], a[4:7], v[68:71]
    v_mfma_f32_16x16x32_bf16 v[68:71], a[112:115], a[0:3], v[68:71]
    s_nop 3
    v_max3_f32 v15, v64, v65, v66
    s_nop 2
    v_max3_f32 v15, v15, v67, v68
    v_max3_f32 v15, v15, v69, v70
    v_max_f32 v15, v15, v71
    v_mov_b32 v28, v15
    s_nop 1
    v_permlane32_swap_b32 v28, v15
    v_max_f32 v15, v15, v28
    v_mov_b32 v28, v15
    s_nop 1
    v_permlane16_swap_b32 v28, v15
    v_max_f32 v15, v15, v28
    v_sub_f32 v12, 0, v15
    v_sub_f32 v13, 0, v15
    v_sub_f32 v14, 0, v15
    v_sub_f32 v15, 0, v15
    v_add_f32 v64, v64, v12
    v_add_f32 v65, v65, v12
    v_exp_f32 v64, v64
    v_add_f32 v66, v66, v12
    v_exp_f32 v65, v65
    v_add_f32 v67, v67, v12
    v_exp_f32 v66, v66
    v_add_f32 v68, v68, v12
    v_exp_f32 v67, v67
    v_cvt_pk_bf16_f32 v32, v64, v65
    v_add_f32 v69, v69, v12
    v_exp_f32 v68, v68
    v_add_f32 v70, v70, v12
    v_exp_f32 v69, v69
    v_cvt_pk_bf16_f32 v33, v66, v67
    v_add_f32 v71, v71, v12
    v_exp_f32 v70, v70
    v_exp_f32 v71, v71
    v_cvt_pk_bf16_f32 v34, v68, v69
    v_cvt_pk_bf16_f32 v35, v70, v71
    s_mov_b64 exec, 0
    s_cmp_eq_u32 s21, 0
    s_cbranch_scc1 L_pad4
    s_cmp_eq_u32 s21, 1
    s_cbranch_scc1 L_pad5
    s_cmp_eq_u32 s21, 2
    s_cbranch_scc1 L_pad6
    s_branch L_pad7
L_back1:
    s_mov_b64 exec, -1
    s_waitcnt vmcnt(6)
    ds_read_b128 v[144:147], v7 offset:36864
    ds_read_b128 v[148:151], v7 offset:37120
    ds_read_b128 v[152:155], v7 offset:37376
    ds_read_b128 v[156:159], v7 offset:37632
    s_add_u32 m0, s26, 102400
    s_xor_b32 s27, s24, 12288
    buffer_load_dwordx4 v5, s[4:7], s27 offen offset:0 nt lds
    buffer_load_dwordx4 v5, s[4:7], s27 offen offset:1024 nt lds
    buffer_load_dwordx4 v6, s[4:7], s27 offen offset:2048 nt lds
    buffer_load_dwordx4 v6, s[4:7], s27 offen offset:3072 nt lds
    s_add_u32 m0, s22, 16384
    s_nop 0
    buffer_load_dwordx4 v1, s[8:11], s34 offen offset:0 nt lds
    buffer_load_dwordx4 v1, s[8:11], s34 offen offset:1024 nt lds
    s_waitcnt lgkmcnt(0)
    v_lshlrev_b32 v160, 16, v144
    v_and_b32 v161, 0xffff0000, v144
    v_pk_mul_f32 v[160:161], v[160:161], s[20:21] op_sel_hi:[1,0]
    v_cvt_pk_bf16_f32 v144, v160, v161
    v_accvgpr_write_b32 a16, v144
    v_lshlrev_b32 v160, 16, v145
    v_and_b32 v161, 0xffff0000, v145
    v_pk_mul_f32 v[160:161], v[160:161], s[20:21] op_sel_hi:[1,0]
    v_cvt_pk_bf16_f32 v145, v160, v161
    v_accvgpr_write_b32 a17, v145
    v_lshlrev_b32 v160, 16, v146
    v_and_b32 v161, 0xffff0000, v146
    v_pk_mul_f32 v[160:161], v[160:161], s[20:21] op_sel_hi:[1,0]
    v_cvt_pk_bf16_f32 v146, v160, v161
    v_accvgpr_write_b32 a18, v146
    v_lshlrev_b32 v160, 16, v147
    v_and_b32 v161, 0xffff0000, v147
    v_pk_mul_f32 v[160:161], v[160:161], s[20:21] op_sel_hi:[1,0]
    v_cvt_pk_bf16_f32 v147, v160, v161
    v_accvgpr_write_b32 a19, v147
    v_lshlrev_b32 v162, 16, v148
    v_and_b32 v163, 0xffff0000, v148
    v_pk_mul_f32 v[162:163], v[162:163], s[20:21] op_sel_hi:[1,0]
    v_cvt_pk_bf16_f32 v148, v162, v163
    v_accvgpr_write_b32 a20, v148
    v_lshlrev_b32 v162, 16, v149
    v_and_b32 v163, 0xffff0000, v149
    v_pk_mul_f32 v[162:163], v[162:163], s[20:21] op_sel_hi:[1,0]
    v_cvt_pk_bf16_f32 v149, v162, v163
    v_accvgpr_write_b32 a21, v149
    v_lshlrev_b32 v162, 16, v150
    v_and_b32 v163, 0xffff0000, v150
    v_pk_mul_f32 v[162:163], v[162:163], s[20:21] op_sel_hi:[1,0]
    v_cvt_pk_bf16_f32 v150, v162, v163
    v_accvgpr_write_b32 a22, v150
    v_lshlrev_b32 v162, 16, v151
    v_and_b32 v163, 0xffff0000, v151
    v_pk_mul_f32 v[162:163], v[162:163], s[20:21] op_sel_hi:[1,0]
    v_cvt_pk_bf16_f32 v151, v162, v163
    v_accvgpr_write_b32 a23, v151
    v_lshlrev_b32 v160, 16, v152
    v_and_b32 v161, 0xffff0000, v152
    v_pk_mul_f32 v[160:161], v[160:161], s[20:21] op_sel_hi:[1,0]
    v_cvt_pk_bf16_f32 v152, v160, v161
    v_accvgpr_write_b32 a24, v152
    v_lshlrev_b32 v160, 16, v153
    v_and_b32 v161, 0xffff0000, v153
    v_pk_mul_f32 v[160:161], v[160:161], s[20:21] op_sel_hi:[1,0]
    v_cvt_pk_bf16_f32 v153, v160, v161
    v_accvgpr_write_b32 a25, v153
    v_lshlrev_b32 v160, 16, v154
    v_and_b32 v161, 0xffff0000, v154
    v_pk_mul_f32 v[160:161], v[160:161], s[20:21] op_sel_hi:[1,0]
    v_cvt_pk_bf16_f32 v154, v160, v161
    v_accvgpr_write_b32 a26, v154
    v_lshlrev_b32 v160, 16, v155
    v_and_b32 v161, 0xffff0000, v155
    v_pk_mul_f32 v[160:161], v[160:161], s[20:21] op_sel_hi:[1,0]
    v_cvt_pk_bf16_f32 v155, v160, v161
    v_accvgpr_write_b32 a27, v155
    v_lshlrev_b32 v162, 16, v156
    v_and_b32 v163, 0xffff0000, v156
    v_pk_mul_f32 v[162:163], v[162:163], s[20:21] op_sel_hi:[1,0]
    v_cvt_pk_bf16_f32 v156, v162, v163
    v_accvgpr_write_b32 a28, v156
    v_lshlrev_b32 v162, 16, v157
    v_and_b32 v163, 0xffff0000, v157
    v_pk_mul_f32 v[162:163], v[162:163], s[20:21] op_sel_hi:[1,0]
    v_cvt_pk_bf16_f32 v157, v162, v163
    v_accvgpr_write_b32 a29, v157
    v_lshlrev_b32 v162, 16, v158
    v_and_b32 v163, 0xffff0000, v158
    v_pk_mul_f32 v[162:163], v[162:163], s[20:21] op_sel_hi:[1,0]
    v_cvt_pk_bf16_f32 v158, v162, v163
    v_accvgpr_write_b32 a30, v158
    v_lshlrev_b32 v162, 16, v159
    v_and_b32 v163, 0xffff0000, v159
    v_pk_mul_f32 v[162:163], v[162:163], s[20:21] op_sel_hi:[1,0]
    v_cvt_pk_bf16_f32 v159, v162, v163
    v_accvgpr_write_b32 a31, v159
    v_mfma_f32_16x16x32_bf16 v[80:83], a[96:99], a[16:19], 0
    v_mfma_f32_16x16x32_bf16 v[80:83], a[100:103], a[20:23], v[80:83]
    v_mfma_f32_16x16x32_bf16 v[80:83], a[104:107], a[24:27], v[80:83]
    v_mfma_f32_16x16x32_bf16 v[80:83], a[108:111], a[28:31], v[80:83]
    v_mfma_f32_16x16x32_bf16 v[84:87], a[124:127], a[28:31], 0
    v_mfma_f32_16x16x32_bf16 v[84:87], a[120:123], a[24:27], v[84:87]
    v_mfma_f32_16x16x32_bf16 v[84:87], a[116:119], a[20:23], v[84:87]
    v_mfma_f32_16x16x32_bf16 v[84:87], a[112:115], a[16:19], v[84:87]
    s_nop 3
    v_max3_f32 v19, v80, v81, v82
    s_nop 2
    v_max3_f32 v19, v19, v83, v84
    v_max3_f32 v19, v19, v85, v86
    v_max_f32 v19, v19, v87
    v_mov_b32 v28, v19
    s_nop 1
    v_permlane32_swap_b32 v28, v19
    v_max_f32 v19, v19, v28
    v_mov_b32 v28, v19
    s_nop 1
    v_permlane16_swap_b32 v28, v19
    v_max_f32 v19, v19, v28
    v_sub_f32 v16, 0, v19
    v_sub_f32 v17, 0, v19
    v_sub_f32 v18, 0, v19
    v_sub_f32 v19, 0, v19
    s_waitcnt vmcnt(10)
    s_barrier
    ds_read_b128 a[128:131], v2 offset:8192
    ds_read_b128 a[132:135], v2 offset:8448
    ds_read_b128 a[136:139], v2 offset:8704
    ds_read_b128 a[140:143], v2 offset:8960
    ds_read_b128 a[144:147], v2 offset:12288
    ds_read_b128 a[148:151], v2 offset:12544
    ds_read_b128 a[152:155], v2 offset:12800
    ds_read_b128 a[156:159], v2 offset:13056
    v_add_f32 v80, v80, v16
    v_add_f32 v81, v81, v16
    v_exp_f32 v80, v80
    v_add_f32 v82, v82, v16
    v_exp_f32 v81, v81
    v_add_f32 v83, v83, v16
    v_exp_f32 v82, v82
    v_add_f32 v84, v84, v16
    v_exp_f32 v83, v83
    v_cvt_pk_bf16_f32 v40, v80, v81
    v_add_f32 v85, v85, v16
    v_exp_f32 v84, v84
    v_add_f32 v86, v86, v16
    v_exp_f32 v85, v85
    v_cvt_pk_bf16_f32 v41, v82, v83
    v_add_f32 v87, v87, v16
    s_waitcnt lgkmcnt(0)
    v_mfma_f32_16x16x32_bf16 v[72:75], a[128:131], a[0:3], v[12:15]
    v_exp_f32 v86, v86
    v_mfma_f32_16x16x32_bf16 v[72:75], a[132:135], a[4:7], v[72:75]
    v_mfma_f32_16x16x32_bf16 v[72:75], a[136:139], a[8:11], v[72:75]
    v_cvt_pk_bf16_f32 v42, v84, v85
    v_mfma_f32_16x16x32_bf16 v[72:75], a[140:143], a[12:15], v[72:75]
    v_mfma_f32_16x16x32_bf16 v[76:79], a[156:159], a[12:15], v[12:15]
    v_mfma_f32_16x16x32_bf16 v[76:79], a[152:155], a[8:11], v[76:79]
    v_mfma_f32_16x16x32_bf16 v[76:79], a[148:151], a[4:7], v[76:79]
    v_mfma_f32_16x16x32_bf16 v[76:79], a[144:147], a[0:3], v[76:79]
    v_exp_f32 v87, v87
    v_mfma_f32_16x16x32_bf16 v[88:91], a[128:131], a[16:19], v[16:19]
    v_mfma_f32_16x16x32_bf16 v[88:91], a[132:135], a[20:23], v[88:91]
    v_mfma_f32_16x16x32_bf16 v[88:91], a[136:139], a[24:27], v[88:91]
    v_cvt_pk_bf16_f32 v43, v86, v87
    v_mfma_f32_16x16x32_bf16 v[88:91], a[140:143], a[28:31], v[88:91]
    v_mfma_f32_16x16x32_bf16 v[92:95], a[156:159], a[28:31], v[16:19]
    v_mfma_f32_16x16x32_bf16 v[92:95], a[152:155], a[24:27], v[92:95]
    v_mfma_f32_16x16x32_bf16 v[92:95], a[148:151], a[20:23], v[92:95]
    v_mfma_f32_16x16x32_bf16 v[92:95], a[144:147], a[16:19], v[92:95]
    s_mov_b64 exec, 0
    s_cmp_eq_u32 s21, 0
    s_cbranch_scc1 L_pad8
    s_cmp_eq_u32 s21, 1
    s_cbranch_scc1 L_pad9
    s_cmp_eq_u32 s21, 2
    s_cbranch_scc1 L_back2
    s_branch L_back2
L_back2:
    s_mov_b64 exec, -1
    s_waitcnt vmcnt(6)
    ds_read_b128 v[128:131], v7 offset:0
    ds_read_b128 v[132:135], v7 offset:256
    ds_read_b128 v[136:139], v7 offset:512
    ds_read_b128 v[140:143], v7 offset:768
    s_add_u32 m0, s22, 24576
    s_nop 0
    buffer_load_dwordx4 v1, s[8:11], s35 offen offset:0 nt lds
    buffer_load_dwordx4 v1, s[8:11], s35 offen offset:1024 nt lds
    s_add_u32 m0, s22, 65536
    s_nop 0
    buffer_load_dwordx4 v1, s[12:15], s32 offen offset:0 nt lds
    buffer_load_dwordx4 v1, s[12:15], s32 offen offset:1024 nt lds
    s_waitcnt lgkmcnt(0)
    v_lshlrev_b32 v160, 16, v128
    v_and_b32 v161, 0xffff0000, v128
    v_pk_mul_f32 v[160:161], v[160:161], s[20:21] op_sel_hi:[1,0]
    v_cvt_pk_bf16_f32 v128, v160, v161
    v_accvgpr_write_b32 a32, v128
    v_lshlrev_b32 v160, 16, v129
    v_and_b32 v161, 0xffff0000, v129
    v_pk_mul_f32 v[160:161], v[160:161], s[20:21] op_sel_hi:[1,0]
    v_cvt_pk_bf16_f32 v129, v160, v161
    v_accvgpr_write_b32 a33, v129
    v_lshlrev_b32 v160, 16, v130
    v_and_b32 v161, 0xffff0000, v130
    v_pk_mul_f32 v[160:161], v[160:161], s[20:21] op_sel_hi:[1,0]
    v_cvt_pk_bf16_f32 v130, v160, v161
    v_accvgpr_write_b32 a34, v130
    v_lshlrev_b32 v160, 16, v131
    v_and_b32 v161, 0xffff0000, v131
    v_pk_mul_f32 v[160:161], v[160:161], s[20:21] op_sel_hi:[1,0]
    v_cvt_pk_bf16_f32 v131, v160, v161
    v_accvgpr_write_b32 a35, v131
    v_lshlrev_b32 v162, 16, v132
    v_and_b32 v163, 0xffff0000, v132
    v_pk_mul_f32 v[162:163], v[162:163], s[20:21] op_sel_hi:[1,0]
    v_cvt_pk_bf16_f32 v132, v162, v163
    v_accvgpr_write_b32 a36, v132
    v_lshlrev_b32 v162, 16, v133
    v_and_b32 v163, 0xffff0000, v133
    v_pk_mul_f32 v[162:163], v[162:163], s[20:21] op_sel_hi:[1,0]
    v_cvt_pk_bf16_f32 v133, v162, v163
    v_accvgpr_write_b32 a37, v133
    v_lshlrev_b32 v162, 16, v134
    v_and_b32 v163, 0xffff0000, v134
    v_pk_mul_f32 v[162:163], v[162:163], s[20:21] op_sel_hi:[1,0]
    v_cvt_pk_bf16_f32 v134, v162, v163
    v_accvgpr_write_b32 a38, v134
    v_lshlrev_b32 v162, 16, v135
    v_and_b32 v163, 0xffff0000, v135
    v_pk_mul_f32 v[162:163], v[162:163], s[20:21] op_sel_hi:[1,0]
    v_cvt_pk_bf16_f32 v135, v162, v163
    v_accvgpr_write_b32 a39, v135
    v_lshlrev_b32 v160, 16, v136
    v_and_b32 v161, 0xffff0000, v136
    v_pk_mul_f32 v[160:161], v[160:161], s[20:21] op_sel_hi:[1,0]
    v_cvt_pk_bf16_f32 v136, v160, v161
    v_accvgpr_write_b32 a40, v136
    v_lshlrev_b32 v160, 16, v137
    v_and_b32 v161, 0xffff0000, v137
    v_pk_mul_f32 v[160:161], v[160:161], s[20:21] op_sel_hi:[1,0]
    v_cvt_pk_bf16_f32 v137, v160, v161
    v_accvgpr_write_b32 a41, v137
    v_lshlrev_b32 v160, 16, v138
    v_and_b32 v161, 0xffff0000, v138
    v_pk_mul_f32 v[160:161], v[160:161], s[20:21] op_sel_hi:[1,0]
    v_cvt_pk_bf16_f32 v138, v160, v161
    v_accvgpr_write_b32 a42, v138
    v_lshlrev_b32 v160, 16, v139
    v_and_b32 v161, 0xffff0000, v139
    v_pk_mul_f32 v[160:161], v[160:161], s[20:21] op_sel_hi:[1,0]
    v_cvt_pk_bf16_f32 v139, v160, v161
    v_accvgpr_write_b32 a43, v139
    v_lshlrev_b32 v162, 16, v140
    v_and_b32 v163, 0xffff0000, v140
    v_pk_mul_f32 v[162:163], v[162:163], s[20:21] op_sel_hi:[1,0]
    v_cvt_pk_bf16_f32 v140, v162, v163
    v_accvgpr_write_b32 a44, v140
    v_lshlrev_b32 v162, 16, v141
    v_and_b32 v163, 0xffff0000, v141
    v_pk_mul_f32 v[162:163], v[162:163], s[20:21] op_sel_hi:[1,0]
    v_cvt_pk_bf16_f32 v141, v162, v163
    v_accvgpr_write_b32 a45, v141
    v_lshlrev_b32 v162, 16, v142
    v_and_b32 v163, 0xffff0000, v142
    v_pk_mul_f32 v[162:163], v[162:163], s[20:21] op_sel_hi:[1,0]
    v_cvt_pk_bf16_f32 v142, v162, v163
    v_accvgpr_write_b32 a46, v142
    v_lshlrev_b32 v162, 16, v143
    v_and_b32 v163, 0xffff0000, v143
    v_pk_mul_f32 v[162:163], v[162:163], s[20:21] op_sel_hi:[1,0]
    v_cvt_pk_bf16_f32 v143, v162, v163
    v_accvgpr_write_b32 a47, v143
    v_mfma_f32_16x16x32_bf16 v[96:99], a[96:99], a[32:35], 0
    v_mfma_f32_16x16x32_bf16 v[96:99], a[100:103], a[36:39], v[96:99]
    v_mfma_f32_16x16x32_bf16 v[96:99], a[104:107], a[40:43], v[96:99]
    v_mfma_f32_16x16x32_bf16 v[96:99], a[108:111], a[44:47], v[96:99]
    v_mfma_f32_16x16x32_bf16 v[100:103], a[124:127], a[44:47], 0
    v_mfma_f32_16x16x32_bf16 v[100:103], a[120:123], a[40:43], v[100:103]
    v_mfma_f32_16x16x32_bf16 v[100:103], a[116:119], a[36:39], v[100:103]
    v_mfma_f32_16x16x32_bf16 v[100:103], a[112:115], a[32:35], v[100:103]
    s_nop 3
    v_max3_f32 v23, v96, v97, v98
    s_nop 2
    v_max3_f32 v23, v23, v99, v100
    v_max3_f32 v23, v23, v101, v102
    v_max_f32 v23, v23, v103
    v_mov_b32 v28, v23
    s_nop 1
    v_permlane32_swap_b32 v28, v23
    v_max_f32 v23, v23, v28
    v_mov_b32 v28, v23
    s_nop 1
    v_permlane16_swap_b32 v28, v23
    v_max_f32 v23, v23, v28
    v_sub_f32 v20, 0, v23
    v_sub_f32 v21, 0, v23
    v_sub_f32 v22, 0, v23
    v_sub_f32 v23, 0, v23
    s_nop 1
    v_mfma_f32_16x16x32_bf16 v[104:107], a[128:131], a[32:35], v[20:23]
    v_add_f32 v96, v96, v20
    v_add_f32 v97, v97, v20
    v_exp_f32 v96, v96
    v_add_f32 v98, v98, v20
    v_add_f32 v99, v99, v20
    v_mfma_f32_16x16x32_bf16 v[104:107], a[132:135], a[36:39], v[104:107]
    v_exp_f32 v97, v97
    v_exp_f32 v98, v98
    v_add_f32 v100, v100, v20
    v_cvt_pk_bf16_f32 v48, v96, v97
    v_mfma_f32_16x16x32_bf16 v[104:107], a[136:139], a[40:43], v[104:107]
    v_exp_f32 v99, v99
    v_add_f32 v101, v101, v20
    v_exp_f32 v100, v100
    v_add_f32 v102, v102, v20
    v_mfma_f32_16x16x32_bf16 v[104:107], a[140:143], a[44:47], v[104:107]
    v_exp_f32 v101, v101
    v_cvt_pk_bf16_f32 v49, v98, v99
    v_add_f32 v103, v103, v20
    v_exp_f32 v102, v102
    v_mfma_f32_16x16x32_bf16 v[108:111], a[156:159], a[44:47], v[20:23]
    v_exp_f32 v103, v103
    v_cvt_pk_bf16_f32 v50, v100, v101
    v_exp_f32 v72, v72
    v_cvt_pk_bf16_f32 v51, v102, v103
    v_mfma_f32_16x16x32_bf16 v[108:111], a[152:155], a[40:43], v[108:111]
    v_exp_f32 v73, v73
    v_exp_f32 v74, v74
    v_exp_f32 v75, v75
    v_mfma_f32_16x16x32_bf16 v[108:111], a[148:151], a[36:39], v[108:111]
    v_cvt_pk_bf16_f32 v36, v72, v73
    v_exp_f32 v76, v76
    v_exp_f32 v77, v77
    v_cvt_pk_bf16_f32 v37, v74, v75
    v_mfma_f32_16x16x32_bf16 v[108:111], a[144:147], a[32:35], v[108:111]
    v_exp_f32 v78, v78
    v_exp_f32 v79, v79
    v_cvt_pk_bf16_f32 v38, v76, v77
    v_cvt_pk_bf16_f32 v39, v78, v79
    s_waitcnt vmcnt(6)
    ds_read_b128 v[144:147], v7 offset:4096
    ds_read_b128 v[148:151], v7 offset:4352
    ds_read_b128 v[152:155], v7 offset:4608
    ds_read_b128 v[156:159], v7 offset:4864
    s_add_u32 m0, s22, 73728
    s_nop 0
    buffer_load_dwordx4 v1, s[12:15], s33 offen offset:0 nt lds
    buffer_load_dwordx4 v1, s[12:15], s33 offen offset:1024 nt lds
    v_exp_f32 v88, v88
    v_exp_f32 v89, v89
    v_exp_f32 v90, v90
    v_exp_f32 v91, v91
    v_cvt_pk_bf16_f32 v44, v88, v89
    v_exp_f32 v92, v92
    v_exp_f32 v93, v93
    v_cvt_pk_bf16_f32 v45, v90, v91
    v_exp_f32 v94, v94
    v_exp_f32 v95, v95
    v_cvt_pk_bf16_f32 v46, v92, v93
    v_cvt_pk_bf16_f32 v47, v94, v95
    s_waitcnt lgkmcnt(0)
    v_lshlrev_b32 v160, 16, v144
    v_and_b32 v161, 0xffff0000, v144
    v_pk_mul_f32 v[160:161], v[160:161], s[20:21] op_sel_hi:[1,0]
    v_cvt_pk_bf16_f32 v144, v160, v161
    v_accvgpr_write_b32 a48, v144
    v_lshlrev_b32 v160, 16, v145
    v_and_b32 v161, 0xffff0000, v145
    v_pk_mul_f32 v[160:161], v[160:161], s[20:21] op_sel_hi:[1,0]
    v_cvt_pk_bf16_f32 v145, v160, v161
    v_accvgpr_write_b32 a49, v145
    v_lshlrev_b32 v160, 16, v146
    v_and_b32 v161, 0xffff0000, v146
    v_pk_mul_f32 v[160:161], v[160:161], s[20:21] op_sel_hi:[1,0]
    v_cvt_pk_bf16_f32 v146, v160, v161
    v_accvgpr_write_b32 a50, v146
    v_lshlrev_b32 v160, 16, v147
    v_and_b32 v161, 0xffff0000, v147
    v_pk_mul_f32 v[160:161], v[160:161], s[20:21] op_sel_hi:[1,0]
    v_cvt_pk_bf16_f32 v147, v160, v161
    v_accvgpr_write_b32 a51, v147
    v_lshlrev_b32 v162, 16, v148
    v_and_b32 v163, 0xffff0000, v148
    v_pk_mul_f32 v[162:163], v[162:163], s[20:21] op_sel_hi:[1,0]
    v_cvt_pk_bf16_f32 v148, v162, v163
    v_accvgpr_write_b32 a52, v148
    v_lshlrev_b32 v162, 16, v149
    v_and_b32 v163, 0xffff0000, v149
    v_pk_mul_f32 v[162:163], v[162:163], s[20:21] op_sel_hi:[1,0]
    v_cvt_pk_bf16_f32 v149, v162, v163
    v_accvgpr_write_b32 a53, v149
    v_lshlrev_b32 v162, 16, v150
    v_and_b32 v163, 0xffff0000, v150
    v_pk_mul_f32 v[162:163], v[162:163], s[20:21] op_sel_hi:[1,0]
    v_cvt_pk_bf16_f32 v150, v162, v163
    v_accvgpr_write_b32 a54, v150
    v_lshlrev_b32 v162, 16, v151
    v_and_b32 v163, 0xffff0000, v151
    v_pk_mul_f32 v[162:163], v[162:163], s[20:21] op_sel_hi:[1,0]
    v_cvt_pk_bf16_f32 v151, v162, v163
    v_accvgpr_write_b32 a55, v151
    v_lshlrev_b32 v160, 16, v152
    v_and_b32 v161, 0xffff0000, v152
    v_pk_mul_f32 v[160:161], v[160:161], s[20:21] op_sel_hi:[1,0]
    v_cvt_pk_bf16_f32 v152, v160, v161
    v_accvgpr_write_b32 a56, v152
    v_lshlrev_b32 v160, 16, v153
    v_and_b32 v161, 0xffff0000, v153
    v_pk_mul_f32 v[160:161], v[160:161], s[20:21] op_sel_hi:[1,0]
    v_cvt_pk_bf16_f32 v153, v160, v161
    v_accvgpr_write_b32 a57, v153
    v_lshlrev_b32 v160, 16, v154
    v_and_b32 v161, 0xffff0000, v154
    v_pk_mul_f32 v[160:161], v[160:161], s[20:21] op_sel_hi:[1,0]
    v_cvt_pk_bf16_f32 v154, v160, v161
    v_accvgpr_write_b32 a58, v154
    v_lshlrev_b32 v160, 16, v155
    v_and_b32 v161, 0xffff0000, v155
    v_pk_mul_f32 v[160:161], v[160:161], s[20:21] op_sel_hi:[1,0]
    v_cvt_pk_bf16_f32 v155, v160, v161
    v_accvgpr_write_b32 a59, v155
    v_lshlrev_b32 v162, 16, v156
    v_and_b32 v163, 0xffff0000, v156
    v_pk_mul_f32 v[162:163], v[162:163], s[20:21] op_sel_hi:[1,0]
    v_cvt_pk_bf16_f32 v156, v162, v163
    v_accvgpr_write_b32 a60, v156
    v_lshlrev_b32 v162, 16, v157
    v_and_b32 v163, 0xffff0000, v157
    v_pk_mul_f32 v[162:163], v[162:163], s[20:21] op_sel_hi:[1,0]
    v_cvt_pk_bf16_f32 v157, v162, v163
    v_accvgpr_write_b32 a61, v157
    v_lshlrev_b32 v162, 16, v158
    v_and_b32 v163, 0xffff0000, v158
    v_pk_mul_f32 v[162:163], v[162:163], s[20:21] op_sel_hi:[1,0]
    v_cvt_pk_bf16_f32 v158, v162, v163
    v_accvgpr_write_b32 a62, v158
    v_lshlrev_b32 v162, 16, v159
    v_and_b32 v163, 0xffff0000, v159
    v_pk_mul_f32 v[162:163], v[162:163], s[20:21] op_sel_hi:[1,0]
    v_cvt_pk_bf16_f32 v159, v162, v163
    v_accvgpr_write_b32 a63, v159
    v_mfma_f32_16x16x32_bf16 v[112:115], a[96:99], a[48:51], 0
    v_mfma_f32_16x16x32_bf16 v[112:115], a[100:103], a[52:55], v[112:115]
    v_mfma_f32_16x16x32_bf16 v[112:115], a[104:107], a[56:59], v[112:115]
    v_mfma_f32_16x16x32_bf16 v[112:115], a[108:111], a[60:63], v[112:115]
    v_mfma_f32_16x16x32_bf16 v[116:119], a[124:127], a[60:63], 0
    v_mfma_f32_16x16x32_bf16 v[116:119], a[120:123], a[56:59], v[116:119]
    v_mfma_f32_16x16x32_bf16 v[116:119], a[116:119], a[52:55], v[116:119]
    v_mfma_f32_16x16x32_bf16 v[116:119], a[112:115], a[48:51], v[116:119]
    s_waitcnt vmcnt(6)
    s_barrier
    ds_read_b128 a[96:99], v2 offset:16384
    ds_read_b128 a[100:103], v2 offset:16640
    ds_read_b128 a[104:107], v2 offset:16896
    ds_read_b128 a[108:111], v2 offset:17152
    ds_read_b128 a[112:115], v2 offset:20480
    ds_read_b128 a[116:119], v2 offset:20736
    ds_read_b128 a[120:123], v2 offset:20992
    ds_read_b128 a[124:127], v2 offset:21248
    v_mfma_f32_16x16x32_bf16 v[120:123], a[128:131], a[48:51], 0
L_pad0:
    s_cbranch_execz L_back0
    v_mfma_f32_16x16x32_bf16 v[120:123], a[132:135], a[52:55], v[120:123]
    v_mfma_f32_16x16x32_bf16 v[120:123], a[136:139], a[56:59], v[120:123]
    v_mfma_f32_16x16x32_bf16 v[120:123], a[140:143], a[60:63], v[120:123]
    v_mfma_f32_16x16x32_bf16 v[124:127], a[156:159], a[60:63], 0
    v_mfma_f32_16x16x32_bf16 v[124:127], a[152:155], a[56:59], v[124:127]
    v_mfma_f32_16x16x32_bf16 v[124:127], a[148:151], a[52:55], v[124:127]
    v_mfma_f32_16x16x32_bf16 v[124:127], a[144:147], a[48:51], v[124:127]
L_n1:
    s_waitcnt lgkmcnt(0)
    v_mfma_f32_16x16x32_bf16 v[64:67], a[96:99], a[0:3], v[12:15]
    v_max3_f32 v27, v112, v113, v114
    v_max3_f32 v27, v27, v115, v116
    v_mfma_f32_16x16x32_bf16 v[64:67], a[100:103], a[4:7], v[64:67]
    v_max3_f32 v27, v27, v117, v118
    v_max_f32 v27, v27, v119
    v_mfma_f32_16x16x32_bf16 v[64:67], a[104:107], a[8:11], v[64:67]
    s_waitcnt vmcnt(4)
    v_mov_b32 v28, v27
    s_nop 1
    v_permlane32_swap_b32 v28, v27
    v_mfma_f32_16x16x32_bf16 v[64:67], a[108:111], a[12:15], v[64:67]
    s_barrier
    v_max_f32 v27, v27, v28
    v_mov_b32 v28, v27
    v_mfma_f32_16x16x32_bf16 v[68:71], a[124:127], a[12:15], v[12:15]
    ds_read_b128 a[128:131], v2 offset:24576
    ds_read_b128 a[132:135], v2 offset:24832
    v_mfma_f32_16x16x32_bf16 v[68:71], a[120:123], a[8:11], v[68:71]
    s_add_u32 m0, s22, 32768
    ds_read_b128 a[136:139], v2 offset:25088
    ds_read_b128 a[140:143], v2 offset:25344
    v_mfma_f32_16x16x32_bf16 v[68:71], a[116:119], a[4:7], v[68:71]
    ds_read_b128 a[144:147], v2 offset:28672
    ds_read_b128 a[148:151], v2 offset:28928
    v_mfma_f32_16x16x32_bf16 v[68:71], a[112:115], a[0:3], v[68:71]
    buffer_load_dwordx4 v1, s[8:11], s36 offen offset:0 nt lds
    v_mfma_f32_16x16x32_bf16 v[80:83], a[96:99], a[16:19], v[16:19]
    s_waitcnt vmcnt(3)
    ds_read_b128 a[152:155], v2 offset:29184
    ds_read_b128 a[156:159], v2 offset:29440
    v_mfma_f32_16x16x32_bf16 v[80:83], a[100:103], a[20:23], v[80:83]
    s_barrier
    ds_read_b64_tr_b16 a[160:161], v3 offset:0
    ds_read_b64_tr_b16 a[162:163], v3 offset:4096
    v_mfma_f32_16x16x32_bf16 v[80:83], a[104:107], a[24:27], v[80:83]
    ds_read_b64_tr_b16 a[168:169], v4 offset:0
    v_permlane16_swap_b32 v28, v27
    v_mfma_f32_16x16x32_bf16 v[80:83], a[108:111], a[28:31], v[80:83]
    ds_read_b64_tr_b16 a[170:171], v4 offset:4096
    v_max_f32 v27, v27, v28
    v_sub_f32 v24, 0, v27
    v_mfma_f32_16x16x32_bf16 v[84:87], a[124:127], a[28:31], v[16:19]
    ds_read_b64_tr_b16 a[176:177], v3 offset:256
    v_sub_f32 v25, 0, v27
    v_mfma_f32_16x16x32_bf16 v[84:87], a[120:123], a[24:27], v[84:87]
    ds_read_b64_tr_b16 a[178:179], v3 offset:4352
    v_sub_f32 v26, 0, v27
    v_mfma_f32_16x16x32_bf16 v[84:87], a[116:119], a[20:23], v[84:87]
    s_waitcnt lgkmcnt(6)
    ds_read_b64_tr_b16 a[184:185], v4 offset:256
    v_sub_f32 v27, 0, v27
    v_mfma_f32_16x16x32_bf16 v[84:87], a[112:115], a[16:19], v[84:87]
    buffer_load_dwordx4 v1, s[8:11], s36 offen offset:1024 nt lds
    v_mfma_f32_16x16x32_bf16 v[72:75], a[128:131], a[0:3], v[12:15]
    ds_read_b64_tr_b16 a[186:187], v4 offset:4352
    ds_read_b64_tr_b16 a[192:193], v3 offset:512
    v_mfma_f32_16x16x32_bf16 v[72:75], a[132:135], a[4:7], v[72:75]
    v_exp_f32 v104, v104
    v_mfma_f32_16x16x32_bf16 v[72:75], a[136:139], a[8:11], v[72:75]
    ds_read_b64_tr_b16 a[194:195], v3 offset:4608
    ds_read_b64_tr_b16 a[200:201], v4 offset:512
    v_mfma_f32_16x16x32_bf16 v[72:75], a[140:143], a[12:15], v[72:75]
    v_exp_f32 v105, v105
    v_mfma_f32_16x16x32_bf16 v[76:79], a[156:159], a[12:15], v[12:15]
    ds_read_b64_tr_b16 a[202:203], v4 offset:4608
    ds_read_b64_tr_b16 a[208:209], v3 offset:768
    v_mfma_f32_16x16x32_bf16 v[76:79], a[152:155], a[8:11], v[76:79]
    s_add_u32 m0, s22, 40960
    v_exp_f32 v106, v106
    v_mfma_f32_16x16x32_bf16 v[76:79], a[148:151], a[4:7], v[76:79]
    ds_read_b64_tr_b16 a[210:211], v3 offset:4864
    v_exp_f32 v107, v107
    v_mfma_f32_16x16x32_bf16 v[76:79], a[144:147], a[0:3], v[76:79]
    ds_read_b64_tr_b16 a[216:217], v4 offset:768
    v_cvt_pk_bf16_f32 v52, v104, v105
    v_mfma_f32_16x16x32_bf16 v[88:91], a[128:131], a[16:19], v[16:19]
    buffer_load_dwordx4 v1, s[8:11], s37 offen offset:0 nt lds
    v_mfma_f32_16x16x32_bf16 v[88:91], a[132:135], a[20:23], v[88:91]
    ds_read_b64_tr_b16 a[218:219], v4 offset:4864
    v_mfma_f32_16x16x32_bf16 v[88:91], a[136:139], a[24:27], v[88:91]
    v_exp_f32 v108, v108
    v_mfma_f32_16x16x32_bf16 v[88:91], a[140:143], a[28:31], v[88:91]
    v_exp_f32 v109, v109
    v_mfma_f32_16x16x32_bf16 v[92:95], a[156:159], a[28:31], v[16:19]
    v_cvt_pk_bf16_f32 v53, v106, v107
    v_add_f32 v112, v112, v24
    v_mfma_f32_16x16x32_bf16 v[92:95], a[152:155], a[24:27], v[92:95]
    v_exp_f32 v110, v110
    v_mfma_f32_16x16x32_bf16 v[92:95], a[148:151], a[20:23], v[92:95]
    v_exp_f32 v111, v111
    v_mfma_f32_16x16x32_bf16 v[92:95], a[144:147], a[16:19], v[92:95]
    s_waitcnt lgkmcnt(0)
    buffer_load_dwordx4 v1, s[8:11], s37 offen offset:1024 nt lds
    v_mfma_f32_16x16x32_bf16 a[224:227], a[240:243], v[32:35], 0
    s_waitcnt vmcnt(4)
    v_cvt_pk_bf16_f32 v54, v108, v109
    v_add_f32 v113, v113, v24
    v_mfma_f32_16x16x32_bf16 v[128:131], a[160:163], v[32:35], 0
    s_barrier
    v_exp_f32 v112, v112
    v_add_f32 v114, v114, v24
    v_mfma_f32_16x16x32_bf16 v[132:135], a[168:171], v[32:35], 0
    v_exp_f32 v113, v113
    v_mfma_f32_16x16x32_bf16 v[136:139], a[176:179], v[32:35], 0
    ds_read_b64_tr_b16 a[164:165], v3 offset:8192
    ds_read_b64_tr_b16 a[166:167], v3 offset:12288
    v_mfma_f32_16x16x32_bf16 v[140:143], a[184:187], v[32:35], 0
    ds_read_b64_tr_b16 a[172:173], v4 offset:8192
    ds_read_b64_tr_b16 a[174:175], v4 offset:12288
    v_mfma_f32_16x16x32_bf16 v[144:147], a[192:195], v[32:35], 0
    ds_read_b64_tr_b16 a[180:181], v3 offset:8448
    ds_read_b64_tr_b16 a[182:183], v3 offset:12544
    v_mfma_f32_16x16x32_bf16 v[148:151], a[200:203], v[32:35], 0
    s_add_u32 m0, s22, 81920
    ds_read_b64_tr_b16 a[188:189], v4 offset:8448
    ds_read_b64_tr_b16 a[190:191], v4 offset:12544
    v_mfma_f32_16x16x32_bf16 v[152:155], a[208:211], v[32:35], 0
    ds_read_b64_tr_b16 a[196:197], v3 offset:8704
    ds_read_b64_tr_b16 a[198:199], v3 offset:12800
    v_mfma_f32_16x16x32_bf16 v[156:159], a[216:219], v[32:35], 0
    buffer_load_dwordx4 v1, s[12:15], s34 offen offset:0 nt lds
    v_mfma_f32_16x16x32_bf16 a[228:231], a[240:243], v[40:43], 0
    ds_read_b64_tr_b16 a[204:205], v4 offset:8704
    ds_read_b64_tr_b16 a[206:207], v4 offset:12800
    v_mfma_f32_16x16x32_bf16 v[160:163], a[160:163], v[40:43], 0
    ds_read_b64_tr_b16 a[212:213], v3 offset:8960
    ds_read_b64_tr_b16 a[214:215], v3 offset:13056
    v_mfma_f32_16x16x32_bf16 v[164:167], a[168:171], v[40:43], 0
    ds_read_b64_tr_b16 a[220:221], v4 offset:8960
    ds_read_b64_tr_b16 a[222:223], v4 offset:13056
    v_mfma_f32_16x16x32_bf16 v[168:171], a[176:179], v[40:43], 0
    v_cvt_pk_bf16_f32 v55, v110, v111
    v_add_f32 v115, v115, v24
    v_mfma_f32_16x16x32_bf16 v[172:175], a[184:187], v[40:43], 0
    v_exp_f32 v114, v114
    v_add_f32 v116, v116, v24
    v_mfma_f32_16x16x32_bf16 v[176:179], a[192:195], v[40:43], 0
    v_exp_f32 v115, v115
    v_mfma_f32_16x16x32_bf16 v[180:183], a[200:203], v[40:43], 0
    buffer_load_dwordx4 v1, s[12:15], s34 offen offset:1024 nt lds
    v_mfma_f32_16x16x32_bf16 v[184:187], a[208:211], v[40:43], 0
    v_cvt_pk_bf16_f32 v56, v112, v113
    v_add_f32 v117, v117, v24
    v_mfma_f32_16x16x32_bf16 v[188:191], a[216:219], v[40:43], 0
    s_waitcnt lgkmcnt(0)
    v_exp_f32 v116, v116
    v_mfma_f32_16x16x32_bf16 a[224:227], a[240:243], v[36:39], a[224:227]
    v_add_f32 v118, v118, v24
    v_cvt_pk_bf16_f32 v57, v114, v115
    v_mfma_f32_16x16x32_bf16 v[128:131], a[164:167], v[36:39], v[128:131]
    v_exp_f32 v117, v117
    v_mfma_f32_16x16x32_bf16 v[132:135], a[172:175], v[36:39], v[132:135]
    s_add_u32 m0, s22, 90112
    v_add_f32 v119, v119, v24
    v_add_f32 v120, v120, v24
    v_mfma_f32_16x16x32_bf16 v[136:139], a[180:183], v[36:39], v[136:139]
    v_exp_f32 v118, v118
    v_mfma_f32_16x16x32_bf16 v[140:143], a[188:191], v[36:39], v[140:143]
    v_exp_f32 v119, v119
    v_mfma_f32_16x16x32_bf16 v[144:147], a[196:199], v[36:39], v[144:147]
    buffer_load_dwordx4 v1, s[12:15], s35 offen offset:0 nt lds
    v_mfma_f32_16x16x32_bf16 v[148:151], a[204:207], v[36:39], v[148:151]
    v_cvt_pk_bf16_f32 v58, v116, v117
    v_add_f32 v121, v121, v24
    v_add_f32 v122, v122, v24
    v_mfma_f32_16x16x32_bf16 v[152:155], a[212:215], v[36:39], v[152:155]
    v_exp_f32 v120, v120
    v_mfma_f32_16x16x32_bf16 v[156:159], a[220:223], v[36:39], v[156:159]
    v_exp_f32 v121, v121
    v_mfma_f32_16x16x32_bf16 a[228:231], a[240:243], v[44:47], a[228:231]
    v_cvt_pk_bf16_f32 v59, v118, v119
    v_add_f32 v123, v123, v24
    v_mfma_f32_16x16x32_bf16 v[160:163], a[164:167], v[44:47], v[160:163]
    v_exp_f32 v122, v122
    v_mfma_f32_16x16x32_bf16 v[164:167], a[172:175], v[44:47], v[164:167]
    v_add_f32 v124, v124, v24
    v_cvt_pk_bf16_f32 v60, v120, v121
    v_mfma_f32_16x16x32_bf16 v[168:171], a[180:183], v[44:47], v[168:171]
    v_exp_f32 v123, v123
    v_mfma_f32_16x16x32_bf16 v[172:175], a[188:191], v[44:47], v[172:175]
    buffer_load_dwordx4 v1, s[12:15], s35 offen offset:1024 nt lds
    v_mfma_f32_16x16x32_bf16 v[176:179], a[196:199], v[44:47], v[176:179]
    v_add_f32 v125, v125, v24
    v_add_f32 v126, v126, v24
    v_mfma_f32_16x16x32_bf16 v[180:183], a[204:207], v[44:47], v[180:183]
    v_exp_f32 v124, v124
    v_mfma_f32_16x16x32_bf16 v[184:187], a[212:215], v[44:47], v[184:187]
    v_exp_f32 v125, v125
    v_mfma_f32_16x16x32_bf16 v[188:191], a[220:223], v[44:47], v[188:191]
    v_cvt_pk_bf16_f32 v61, v122, v123
    v_add_f32 v127, v127, v24
    v_exp_f32 v126, v126
L_n2:
    v_mfma_f32_16x16x32_bf16 v[96:99], a[96:99], a[32:35], v[20:23]
    v_exp_f32 v127, v127
    v_mfma_f32_16x16x32_bf16 v[96:99], a[100:103], a[36:39], v[96:99]
    v_cvt_pk_bf16_f32 v62, v124, v125
    v_cvt_pk_bf16_f32 v63, v126, v127
    v_mfma_f32_16x16x32_bf16 v[96:99], a[104:107], a[40:43], v[96:99]
    v_exp_f32 v64, v64
    v_mfma_f32_16x16x32_bf16 v[96:99], a[108:111], a[44:47], v[96:99]
    v_exp_f32 v65, v65
    v_mfma_f32_16x16x32_bf16 v[100:103], a[124:127], a[44:47], v[20:23]
    s_add_u32 m0, s22, 49152
    v_mfma_f32_16x16x32_bf16 v[100:103], a[120:123], a[40:43], v[100:103]
    v_exp_f32 v66, v66
    v_mfma_f32_16x16x32_bf16 v[100:103], a[116:119], a[36:39], v[100:103]
    v_exp_f32 v67, v67
    v_mfma_f32_16x16x32_bf16 v[100:103], a[112:115], a[32:35], v[100:103]
    buffer_load_dwordx4 v1, s[8:11], s38 offen offset:0 nt lds
    v_mfma_f32_16x16x32_bf16 v[104:107], a[128:131], a[32:35], v[20:23]
    v_cvt_pk_bf16_f32 v32, v64, v65
    v_mfma_f32_16x16x32_bf16 v[104:107], a[132:135], a[36:39], v[104:107]
    v_exp_f32 v68, v68
    v_mfma_f32_16x16x32_bf16 v[104:107], a[136:139], a[40:43], v[104:107]
    v_cvt_pk_bf16_f32 v33, v66, v67
    v_mfma_f32_16x16x32_bf16 v[104:107], a[140:143], a[44:47], v[104:107]
    v_exp_f32 v69, v69
    v_mfma_f32_16x16x32_bf16 v[108:111], a[156:159], a[44:47], v[20:23]
    v_mfma_f32_16x16x32_bf16 v[108:111], a[152:155], a[40:43], v[108:111]
    v_exp_f32 v70, v70
    v_mfma_f32_16x16x32_bf16 v[108:111], a[148:151], a[36:39], v[108:111]
    v_exp_f32 v71, v71
    v_mfma_f32_16x16x32_bf16 v[108:111], a[144:147], a[32:35], v[108:111]
    buffer_load_dwordx4 v1, s[8:11], s38 offen offset:1024 nt lds
    v_mfma_f32_16x16x32_bf16 v[112:115], a[96:99], a[48:51], v[24:27]
    v_cvt_pk_bf16_f32 v34, v68, v69
    v_mfma_f32_16x16x32_bf16 v[112:115], a[100:103], a[52:55], v[112:115]
    v_exp_f32 v72, v72
    v_mfma_f32_16x16x32_bf16 v[112:115], a[104:107], a[56:59], v[112:115]
    v_exp_f32 v73, v73
    v_mfma_f32_16x16x32_bf16 v[112:115], a[108:111], a[60:63], v[112:115]
    v_cvt_pk_bf16_f32 v35, v70, v71
    v_mfma_f32_16x16x32_bf16 v[116:119], a[124:127], a[60:63], v[24:27]
    s_add_u32 m0, s22, 57344
    v_exp_f32 v74, v74
    v_mfma_f32_16x16x32_bf16 v[116:119], a[120:123], a[56:59], v[116:119]
    v_cvt_pk_bf16_f32 v36, v72, v73
    v_mfma_f32_16x16x32_bf16 v[116:119], a[116:119], a[52:55], v[116:119]
    v_exp_f32 v75, v75
    v_mfma_f32_16x16x32_bf16 v[116:119], a[112:115], a[48:51], v[116:119]
    buffer_load_dwordx4 v1, s[8:11], s39 offen offset:0 nt lds
    v_mfma_f32_16x16x32_bf16 v[120:123], a[128:131], a[48:51], v[24:27]
    v_mfma_f32_16x16x32_bf16 v[120:123], a[132:135], a[52:55], v[120:123]
    v_exp_f32 v76, v76
    v_mfma_f32_16x16x32_bf16 v[120:123], a[136:139], a[56:59], v[120:123]
    v_exp_f32 v77, v77
    v_mfma_f32_16x16x32_bf16 v[120:123], a[140:143], a[60:63], v[120:123]
    v_cvt_pk_bf16_f32 v37, v74, v75
    v_mfma_f32_16x16x32_bf16 v[124:127], a[156:159], a[60:63], v[24:27]
    v_exp_f32 v78, v78
    v_mfma_f32_16x16x32_bf16 v[124:127], a[152:155], a[56:59], v[124:127]
    v_cvt_pk_bf16_f32 v38, v76, v77
    v_mfma_f32_16x16x32_bf16 v[124:127], a[148:151], a[52:55], v[124:127]
    v_exp_f32 v79, v79
    v_mfma_f32_16x16x32_bf16 v[124:127], a[144:147], a[48:51], v[124:127]
    buffer_load_dwordx4 v1, s[8:11], s39 offen offset:1024 nt lds
    v_mfma_f32_16x16x32_bf16 a[232:235], a[240:243], v[48:51], 0
    v_mfma_f32_16x16x32_bf16 a[232:235], a[240:243], v[52:55], a[232:235]
    v_exp_f32 v80, v80
    v_mfma_f32_16x16x32_bf16 v[192:195], a[164:167], v[52:55], 0
    v_exp_f32 v81, v81
    v_mfma_f32_16x16x32_bf16 v[192:195], a[160:163], v[48:51], v[192:195]
    v_cvt_pk_bf16_f32 v39, v78, v79
    v_mfma_f32_16x16x32_bf16 v[196:199], a[168:171], v[48:51], 0
    s_add_u32 m0, s22, 98304
    v_exp_f32 v82, v82
    v_mfma_f32_16x16x32_bf16 v[196:199], a[172:175], v[52:55], v[196:199]
    v_exp_f32 v83, v83
    v_mfma_f32_16x16x32_bf16 v[200:203], a[180:183], v[52:55], 0
    buffer_load_dwordx4 v1, s[12:15], s36 offen offset:0 nt lds
    v_mfma_f32_16x16x32_bf16 v[200:203], a[176:179], v[48:51], v[200:203]
    v_cvt_pk_bf16_f32 v40, v80, v81
    v_mfma_f32_16x16x32_bf16 v[204:207], a[184:187], v[48:51], 0
    v_mfma_f32_16x16x32_bf16 v[204:207], a[188:191], v[52:55], v[204:207]
    v_exp_f32 v84, v84
    v_mfma_f32_16x16x32_bf16 v[208:211], a[196:199], v[52:55], 0
    v_exp_f32 v85, v85
    v_mfma_f32_16x16x32_bf16 v[208:211], a[192:195], v[48:51], v[208:211]
    v_cvt_pk_bf16_f32 v41, v82, v83
    v_mfma_f32_16x16x32_bf16 v[212:215], a[200:203], v[48:51], 0
    v_exp_f32 v86, v86
    v_mfma_f32_16x16x32_bf16 v[212:215], a[204:207], v[52:55], v[212:215]
    v_exp_f32 v87, v87
    v_mfma_f32_16x16x32_bf16 v[216:219], a[212:215], v[52:55], 0
    buffer_load_dwordx4 v1, s[12:15], s36 offen offset:1024 nt lds
    v_mfma_f32_16x16x32_bf16 v[216:219], a[208:211], v[48:51], v[216:219]
    v_cvt_pk_bf16_f32 v42, v84, v85
    v_mfma_f32_16x16x32_bf16 v[220:223], a[216:219], v[48:51], 0
    v_mfma_f32_16x16x32_bf16 v[220:223], a[220:223], v[52:55], v[220:223]
    v_exp_f32 v88, v88
    v_mfma_f32_16x16x32_bf16 a[236:239], a[240:243], v[56:59], 0
    s_waitcnt vmcnt(12)
    v_exp_f32 v89, v89
    v_mfma_f32_16x16x32_bf16 a[236:239], a[240:243], v[60:63], a[236:239]
    s_barrier
    v_cvt_pk_bf16_f32 v43, v86, v87
    v_mfma_f32_16x16x32_bf16 v[224:227], a[164:167], v[60:63], 0
    v_exp_f32 v90, v90
    v_mfma_f32_16x16x32_bf16 v[224:227], a[160:163], v[56:59], v[224:227]
    ds_read_b128 a[96:99], v2 offset:32768
    v_cvt_pk_bf16_f32 v44, v88, v89
    v_mfma_f32_16x16x32_bf16 v[228:231], a[168:171], v[56:59], 0
    s_add_u32 m0, s22, 106496
    ds_read_b128 a[100:103], v2 offset:33024
    ds_read_b128 a[104:107], v2 offset:33280
    v_mfma_f32_16x16x32_bf16 v[228:231], a[172:175], v[60:63], v[228:231]
    buffer_load_dwordx4 v1, s[12:15], s37 offen offset:0 nt lds
    v_mfma_f32_16x16x32_bf16 v[232:235], a[180:183], v[60:63], 0
    ds_read_b128 a[108:111], v2 offset:33536
    ds_read_b128 a[112:115], v2 offset:36864
    v_mfma_f32_16x16x32_bf16 v[232:235], a[176:179], v[56:59], v[232:235]
    ds_read_b128 a[116:119], v2 offset:37120
    v_mfma_f32_16x16x32_bf16 v[236:239], a[184:187], v[56:59], 0
    ds_read_b128 a[120:123], v2 offset:37376
    v_mfma_f32_16x16x32_bf16 v[236:239], a[188:191], v[60:63], v[236:239]
    ds_read_b128 a[124:127], v2 offset:37632
    v_mfma_f32_16x16x32_bf16 v[240:243], a[196:199], v[60:63], 0
    v_exp_f32 v91, v91
    v_mfma_f32_16x16x32_bf16 v[240:243], a[192:195], v[56:59], v[240:243]
    v_mfma_f32_16x16x32_bf16 v[244:247], a[200:203], v[56:59], 0
    v_exp_f32 v92, v92
    v_mfma_f32_16x16x32_bf16 v[244:247], a[204:207], v[60:63], v[244:247]
    buffer_load_dwordx4 v1, s[12:15], s37 offen offset:1024 nt lds
    v_mfma_f32_16x16x32_bf16 v[248:251], a[212:215], v[60:63], 0
    v_exp_f32 v93, v93
    v_mfma_f32_16x16x32_bf16 v[248:251], a[208:211], v[56:59], v[248:251]
    v_cvt_pk_bf16_f32 v45, v90, v91
    v_mfma_f32_16x16x32_bf16 v[252:255], a[216:219], v[56:59], 0
    v_exp_f32 v94, v94
    v_mfma_f32_16x16x32_bf16 v[252:255], a[220:223], v[60:63], v[252:255]
    s_waitcnt lgkmcnt(0)
L_n3:
    v_mfma_f32_16x16x32_bf16 v[64:67], a[96:99], a[0:3], v[12:15]
    v_exp_f32 v95, v95
    v_mfma_f32_16x16x32_bf16 v[64:67], a[100:103], a[4:7], v[64:67]
    v_cvt_pk_bf16_f32 v46, v92, v93
    v_cvt_pk_bf16_f32 v47, v94, v95
    v_mfma_f32_16x16x32_bf16 v[64:67], a[104:107], a[8:11], v[64:67]
    s_waitcnt vmcnt(12)
    v_exp_f32 v96, v96
    v_mfma_f32_16x16x32_bf16 v[64:67], a[108:111], a[12:15], v[64:67]
    s_barrier
    v_exp_f32 v97, v97
    v_mfma_f32_16x16x32_bf16 v[68:71], a[124:127], a[12:15], v[12:15]
    v_exp_f32 v98, v98
    v_mfma_f32_16x16x32_bf16 v[68:71], a[120:123], a[8:11], v[68:71]
    ds_read_b128 a[128:131], v2 offset:40960
    ds_read_b128 a[132:135], v2 offset:41216
    v_mfma_f32_16x16x32_bf16 v[68:71], a[116:119], a[4:7], v[68:71]
    s_add_u32 m0, s22, 0
    ds_read_b128 a[136:139], v2 offset:41472
    ds_read_b128 a[140:143], v2 offset:41728
    v_mfma_f32_16x16x32_bf16 v[68:71], a[112:115], a[0:3], v[68:71]
    ds_read_b128 a[144:147], v2 offset:45056
    ds_read_b128 a[148:151], v2 offset:45312
    v_mfma_f32_16x16x32_bf16 v[80:83], a[96:99], a[16:19], v[16:19]
    buffer_load_dwordx4 v1, s[8:11], s40 offen offset:0 nt lds
    v_mfma_f32_16x16x32_bf16 v[80:83], a[100:103], a[20:23], v[80:83]
    s_waitcnt vmcnt(11)
    ds_read_b128 a[152:155], v2 offset:45568
    ds_read_b128 a[156:159], v2 offset:45824
    v_mfma_f32_16x16x32_bf16 v[80:83], a[104:107], a[24:27], v[80:83]
    s_barrier
    ds_read_b64_tr_b16 a[160:161], v3 offset:16384
    ds_read_b64_tr_b16 a[162:163], v3 offset:20480
    v_mfma_f32_16x16x32_bf16 v[80:83], a[108:111], a[28:31], v[80:83]
    ds_read_b64_tr_b16 a[168:169], v4 offset:16384
    ds_read_b64_tr_b16 a[170:171], v4 offset:20480
    v_mfma_f32_16x16x32_bf16 v[84:87], a[124:127], a[28:31], v[16:19]
    v_exp_f32 v99, v99
    v_mfma_f32_16x16x32_bf16 v[84:87], a[120:123], a[24:27], v[84:87]
    ds_read_b64_tr_b16 a[176:177], v3 offset:16640
    ds_read_b64_tr_b16 a[178:179], v3 offset:20736
    v_mfma_f32_16x16x32_bf16 v[84:87], a[116:119], a[20:23], v[84:87]
    s_waitcnt lgkmcnt(6)
    ds_read_b64_tr_b16 a[184:185], v4 offset:16640
    v_cvt_pk_bf16_f32 v48, v96, v97
    v_mfma_f32_16x16x32_bf16 v[84:87], a[112:115], a[16:19], v[84:87]
    buffer_load_dwordx4 v1, s[8:11], s40 offen offset:1024 nt lds
    v_mfma_f32_16x16x32_bf16 v[72:75], a[128:131], a[0:3], v[12:15]
    ds_read_b64_tr_b16 a[186:187], v4 offset:20736
    ds_read_b64_tr_b16 a[192:193], v3 offset:16896
    v_mfma_f32_16x16x32_bf16 v[72:75], a[132:135], a[4:7], v[72:75]
    v_exp_f32 v100, v100
    v_mfma_f32_16x16x32_bf16 v[72:75], a[136:139], a[8:11], v[72:75]
    ds_read_b64_tr_b16 a[194:195], v3 offset:20992
    ds_read_b64_tr_b16 a[200:201], v4 offset:16896
    v_mfma_f32_16x16x32_bf16 v[72:75], a[140:143], a[12:15], v[72:75]
    v_exp_f32 v101, v101
    v_mfma_f32_16x16x32_bf16 v[76:79], a[156:159], a[12:15], v[12:15]
    ds_read_b64_tr_b16 a[202:203], v4 offset:20992
    ds_read_b64_tr_b16 a[208:209], v3 offset:17152
    v_mfma_f32_16x16x32_bf16 v[76:79], a[152:155], a[8:11], v[76:79]
    s_add_u32 m0, s22, 8192
    ds_read_b64_tr_b16 a[210:211], v3 offset:21248
    v_cvt_pk_bf16_f32 v49, v98, v99
    v_mfma_f32_16x16x32_bf16 v[76:79], a[148:151], a[4:7], v[76:79]
    v_exp_f32 v102, v102
    v_mfma_f32_16x16x32_bf16 v[76:79], a[144:147], a[0:3], v[76:79]
    ds_read_b64_tr_b16 a[216:217], v4 offset:17152
    v_cvt_pk_bf16_f32 v50, v100, v101
    v_mfma_f32_16x16x32_bf16 v[88:91], a[128:131], a[16:19], v[16:19]
    buffer_load_dwordx4 v1, s[8:11], s41 offen offset:0 nt lds
    v_mfma_f32_16x16x32_bf16 v[88:91], a[132:135], a[20:23], v[88:91]
    ds_read_b64_tr_b16 a[218:219], v4 offset:21248
    v_mfma_f32_16x16x32_bf16 v[88:91], a[136:139], a[24:27], v[88:91]
    v_exp_f32 v103, v103
    v_mfma_f32_16x16x32_bf16 v[88:91], a[140:143], a[28:31], v[88:91]
    v_exp_f32 v104, v104
    v_mfma_f32_16x16x32_bf16 v[92:95], a[156:159], a[28:31], v[16:19]
    v_exp_f32 v105, v105
    v_mfma_f32_16x16x32_bf16 v[92:95], a[152:155], a[24:27], v[92:95]
    v_cvt_pk_bf16_f32 v51, v102, v103
    v_mfma_f32_16x16x32_bf16 v[92:95], a[148:151], a[20:23], v[92:95]
    v_exp_f32 v106, v106
    v_mfma_f32_16x16x32_bf16 v[92:95], a[144:147], a[16:19], v[92:95]
    s_waitcnt lgkmcnt(0)
    buffer_load_dwordx4 v1, s[8:11], s41 offen offset:1024 nt lds
    v_mfma_f32_16x16x32_bf16 a[224:227], a[240:243], v[32:35], a[224:227]
    s_waitcnt vmcnt(12)
    v_exp_f32 v107, v107
    v_mfma_f32_16x16x32_bf16 v[128:131], a[160:163], v[32:35], v[128:131]
    s_barrier
    v_cvt_pk_bf16_f32 v52, v104, v105
    v_mfma_f32_16x16x32_bf16 v[132:135], a[168:171], v[32:35], v[132:135]
    v_exp_f32 v108, v108
    v_mfma_f32_16x16x32_bf16 v[136:139], a[176:179], v[32:35], v[136:139]
    ds_read_b64_tr_b16 a[164:165], v3 offset:24576
    ds_read_b64_tr_b16 a[166:167], v3 offset:28672
    v_mfma_f32_16x16x32_bf16 v[140:143], a[184:187], v[32:35], v[140:143]
    ds_read_b64_tr_b16 a[172:173], v4 offset:24576
    ds_read_b64_tr_b16 a[174:175], v4 offset:28672
    v_mfma_f32_16x16x32_bf16 v[144:147], a[192:195], v[32:35], v[144:147]
    ds_read_b64_tr_b16 a[180:181], v3 offset:24832
    ds_read_b64_tr_b16 a[182:183], v3 offset:28928
    v_mfma_f32_16x16x32_bf16 v[148:151], a[200:203], v[32:35], v[148:151]
    s_add_u32 m0, s22, 114688
    ds_read_b64_tr_b16 a[188:189], v4 offset:24832
    ds_read_b64_tr_b16 a[190:191], v4 offset:28928
    v_mfma_f32_16x16x32_bf16 v[152:155], a[208:211], v[32:35], v[152:155]
    ds_read_b64_tr_b16 a[196:197], v3 offset:25088
    ds_read_b64_tr_b16 a[198:199], v3 offset:29184
    v_mfma_f32_16x16x32_bf16 v[156:159], a[216:219], v[32:35], v[156:159]
    buffer_load_dwordx4 v1, s[12:15], s38 offen offset:0 nt lds
    v_mfma_f32_16x16x32_bf16 a[228:231], a[240:243], v[40:43], a[228:231]
    ds_read_b64_tr_b16 a[204:205], v4 offset:25088
    ds_read_b64_tr_b16 a[206:207], v4 offset:29184
    v_mfma_f32_16x16x32_bf16 v[160:163], a[160:163], v[40:43], v[160:163]
    ds_read_b64_tr_b16 a[212:213], v3 offset:25344
    ds_read_b64_tr_b16 a[214:215], v3 offset:29440
    v_mfma_f32_16x16x32_bf16 v[164:167], a[168:171], v[40:43], v[164:167]
    ds_read_b64_tr_b16 a[220:221], v4 offset:25344
    ds_read_b64_tr_b16 a[222:223], v4 offset:29440
    v_mfma_f32_16x16x32_bf16 v[168:171], a[176:179], v[40:43], v[168:171]
    v_exp_f32 v109, v109
    v_mfma_f32_16x16x32_bf16 v[172:175], a[184:187], v[40:43], v[172:175]
    v_cvt_pk_bf16_f32 v53, v106, v107
    v_mfma_f32_16x16x32_bf16 v[176:179], a[192:195], v[40:43], v[176:179]
    v_exp_f32 v110, v110
    v_mfma_f32_16x16x32_bf16 v[180:183], a[200:203], v[40:43], v[180:183]
    buffer_load_dwordx4 v1, s[12:15], s38 offen offset:1024 nt lds
    v_mfma_f32_16x16x32_bf16 v[184:187], a[208:211], v[40:43], v[184:187]
    v_exp_f32 v111, v111
    v_mfma_f32_16x16x32_bf16 v[188:191], a[216:219], v[40:43], v[188:191]
    s_waitcnt lgkmcnt(0)
    v_cvt_pk_bf16_f32 v54, v108, v109
    v_mfma_f32_16x16x32_bf16 a[224:227], a[240:243], v[36:39], a[224:227]
    v_exp_f32 v112, v112
    v_mfma_f32_16x16x32_bf16 v[128:131], a[164:167], v[36:39], v[128:131]
    v_exp_f32 v113, v113
    v_mfma_f32_16x16x32_bf16 v[132:135], a[172:175], v[36:39], v[132:135]
    s_add_u32 m0, s22, 122880
    v_cvt_pk_bf16_f32 v55, v110, v111
    v_mfma_f32_16x16x32_bf16 v[136:139], a[180:183], v[36:39], v[136:139]
    v_exp_f32 v114, v114
    v_mfma_f32_16x16x32_bf16 v[140:143], a[188:191], v[36:39], v[140:143]
    v_exp_f32 v115, v115
    v_mfma_f32_16x16x32_bf16 v[144:147], a[196:199], v[36:39], v[144:147]
    buffer_load_dwordx4 v1, s[12:15], s39 offen offset:0 nt lds
    v_mfma_f32_16x16x32_bf16 v[148:151], a[204:207], v[36:39], v[148:151]
    v_cvt_pk_bf16_f32 v56, v112, v113
    v_mfma_f32_16x16x32_bf16 v[152:155], a[212:215], v[36:39], v[152:155]
    v_exp_f32 v116, v116
    v_mfma_f32_16x16x32_bf16 v[156:159], a[220:223], v[36:39], v[156:159]
    v_exp_f32 v117, v117
    v_mfma_f32_16x16x32_bf16 a[228:231], a[240:243], v[44:47], a[228:231]
    v_cvt_pk_bf16_f32 v57, v114, v115
    v_mfma_f32_16x16x32_bf16 v[160:163], a[164:167], v[44:47], v[160:163]
    v_exp_f32 v118, v118
    v_mfma_f32_16x16x32_bf16 v[164:167], a[172:175], v[44:47], v[164:167]
    v_exp_f32 v119, v119
    v_mfma_f32_16x16x32_bf16 v[168:171], a[180:183], v[44:47], v[168:171]
    buffer_load_dwordx4 v1, s[12:15], s39 offen offset:1024 nt lds
    v_mfma_f32_16x16x32_bf16 v[172:175], a[188:191], v[44:47], v[172:175]
    v_cvt_pk_bf16_f32 v58, v116, v117
    v_mfma_f32_16x16x32_bf16 v[176:179], a[196:199], v[44:47], v[176:179]
    v_exp_f32 v120, v120
    v_mfma_f32_16x16x32_bf16 v[180:183], a[204:207], v[44:47], v[180:183]
    v_exp_f32 v121, v121
    v_mfma_f32_16x16x32_bf16 v[184:187], a[212:215], v[44:47], v[184:187]
    v_cvt_pk_bf16_f32 v59, v118, v119
    v_mfma_f32_16x16x32_bf16 v[188:191], a[220:223], v[44:47], v[188:191]
    v_exp_f32 v122, v122
    v_exp_f32 v123, v123
    v_cvt_pk_bf16_f32 v60, v120, v121
    v_exp_f32 v124, v124
    v_exp_f32 v125, v125
    v_cvt_pk_bf16_f32 v61, v122, v123
    v_exp_f32 v126, v126
L_n4:
    v_mfma_f32_16x16x32_bf16 v[96:99], a[96:99], a[32:35], v[20:23]
    v_exp_f32 v127, v127
    v_mfma_f32_16x16x32_bf16 v[96:99], a[100:103], a[36:39], v[96:99]
    v_cvt_pk_bf16_f32 v62, v124, v125
    v_cvt_pk_bf16_f32 v63, v126, v127
    v_mfma_f32_16x16x32_bf16 v[96:99], a[104:107], a[40:43], v[96:99]
    v_exp_f32 v64, v64
    v_mfma_f32_16x16x32_bf16 v[96:99], a[108:111], a[44:47], v[96:99]
    v_exp_f32 v65, v65
    v_mfma_f32_16x16x32_bf16 v[100:103], a[124:127], a[44:47], v[20:23]
    s_add_u32 m0, s22, 16384
    v_exp_f32 v66, v66
    v_mfma_f32_16x16x32_bf16 v[100:103], a[120:123], a[40:43], v[100:103]
    v_exp_f32 v67, v67
    v_mfma_f32_16x16x32_bf16 v[100:103], a[116:119], a[36:39], v[100:103]
    buffer_load_dwordx4 v1, s[8:11], s42 offen offset:0 nt lds
    v_mfma_f32_16x16x32_bf16 v[100:103], a[112:115], a[32:35], v[100:103]
    v_cvt_pk_bf16_f32 v32, v64, v65
    v_mfma_f32_16x16x32_bf16 v[104:107], a[128:131], a[32:35], v[20:23]
    v_exp_f32 v68, v68
    v_mfma_f32_16x16x32_bf16 v[104:107], a[132:135], a[36:39], v[104:107]
    v_exp_f32 v69, v69
    v_mfma_f32_16x16x32_bf16 v[104:107], a[136:139], a[40:43], v[104:107]
    v_cvt_pk_bf16_f32 v33, v66, v67
    v_mfma_f32_16x16x32_bf16 v[104:107], a[140:143], a[44:47], v[104:107]
    v_exp_f32 v70, v70
    v_mfma_f32_16x16x32_bf16 v[108:111], a[156:159], a[44:47], v[20:23]
    v_exp_f32 v71, v71
    v_mfma_f32_16x16x32_bf16 v[108:111], a[152:155], a[40:43], v[108:111]
    v_cvt_pk_bf16_f32 v34, v68, v69
    v_mfma_f32_16x16x32_bf16 v[108:111], a[148:151], a[36:39], v[108:111]
    v_exp_f32 v72, v72
    v_mfma_f32_16x16x32_bf16 v[108:111], a[144:147], a[32:35], v[108:111]
    buffer_load_dwordx4 v1, s[8:11], s42 offen offset:1024 nt lds
    v_mfma_f32_16x16x32_bf16 v[112:115], a[96:99], a[48:51], v[24:27]
    v_exp_f32 v73, v73
    v_mfma_f32_16x16x32_bf16 v[112:115], a[100:103], a[52:55], v[112:115]
    v_cvt_pk_bf16_f32 v35, v70, v71
    v_mfma_f32_16x16x32_bf16 v[112:115], a[104:107], a[56:59], v[112:115]
    v_exp_f32 v74, v74
    v_mfma_f32_16x16x32_bf16 v[112:115], a[108:111], a[60:63], v[112:115]
    v_exp_f32 v75, v75
    v_mfma_f32_16x16x32_bf16 v[116:119], a[124:127], a[60:63], v[24:27]
    s_add_u32 m0, s22, 65536
    v_cvt_pk_bf16_f32 v36, v72, v73
    v_mfma_f32_16x16x32_bf16 v[116:119], a[120:123], a[56:59], v[116:119]
    v_exp_f32 v76, v76
    v_mfma_f32_16x16x32_bf16 v[116:119], a[116:119], a[52:55], v[116:119]
    v_exp_f32 v77, v77
    v_mfma_f32_16x16x32_bf16 v[116:119], a[112:115], a[48:51], v[116:119]
    buffer_load_dwordx4 v1, s[12:15], s40 offen offset:0 nt lds
    v_mfma_f32_16x16x32_bf16 v[120:123], a[128:131], a[48:51], v[24:27]
    s_waitcnt vmcnt(11)
    v_cvt_pk_bf16_f32 v37, v74, v75
    v_mfma_f32_16x16x32_bf16 v[120:123], a[132:135], a[52:55], v[120:123]
    s_barrier
    v_exp_f32 v78, v78
    v_mfma_f32_16x16x32_bf16 v[120:123], a[136:139], a[56:59], v[120:123]
    v_exp_f32 v79, v79
    v_mfma_f32_16x16x32_bf16 v[120:123], a[140:143], a[60:63], v[120:123]
    v_cvt_pk_bf16_f32 v38, v76, v77
    v_mfma_f32_16x16x32_bf16 v[124:127], a[156:159], a[60:63], v[24:27]
    v_exp_f32 v80, v80
    v_mfma_f32_16x16x32_bf16 v[124:127], a[152:155], a[56:59], v[124:127]
    v_exp_f32 v81, v81
    v_mfma_f32_16x16x32_bf16 v[124:127], a[148:151], a[52:55], v[124:127]
    buffer_load_dwordx4 v1, s[12:15], s40 offen offset:1024 nt lds
    v_mfma_f32_16x16x32_bf16 v[124:127], a[144:147], a[48:51], v[124:127]
    v_cvt_pk_bf16_f32 v39, v78, v79
    v_mfma_f32_16x16x32_bf16 a[232:235], a[240:243], v[48:51], a[232:235]
L_pad1:
    s_cbranch_execz L_back0
    v_exp_f32 v82, v82
    v_mfma_f32_16x16x32_bf16 a[232:235], a[240:243], v[52:55], a[232:235]
    ds_read_b128 a[96:99], v2 offset:49152
    ds_read_b128 a[100:103], v2 offset:49408
    v_mfma_f32_16x16x32_bf16 v[192:195], a[164:167], v[52:55], v[192:195]
    v_exp_f32 v83, v83
    v_mfma_f32_16x16x32_bf16 v[192:195], a[160:163], v[48:51], v[192:195]
    ds_read_b128 a[104:107], v2 offset:49664
    v_cvt_pk_bf16_f32 v40, v80, v81
    v_mfma_f32_16x16x32_bf16 v[196:199], a[168:171], v[48:51], v[196:199]
    v_exp_f32 v84, v84
    v_mfma_f32_16x16x32_bf16 v[196:199], a[172:175], v[52:55], v[196:199]
    ds_read_b128 a[108:111], v2 offset:49920
    v_cvt_pk_bf16_f32 v41, v82, v83
    v_mfma_f32_16x16x32_bf16 v[200:203], a[180:183], v[52:55], v[200:203]
    s_add_u32 m0, s26, 131072
    v_exp_f32 v85, v85
    v_mfma_f32_16x16x32_bf16 v[200:203], a[176:179], v[48:51], v[200:203]
    s_xor_b32 s27, s25, 0
    ds_read_b128 a[112:115], v2 offset:53248
    v_mfma_f32_16x16x32_bf16 v[204:207], a[184:187], v[48:51], v[204:207]
    buffer_load_dwordx4 v5, s[4:7], s27 offen offset:0 nt lds
    v_mfma_f32_16x16x32_bf16 v[204:207], a[188:191], v[52:55], v[204:207]
    ds_read_b128 a[116:119], v2 offset:53504
    ds_read_b128 a[120:123], v2 offset:53760
    v_mfma_f32_16x16x32_bf16 v[208:211], a[196:199], v[52:55], v[208:211]
    v_exp_f32 v86, v86
    v_mfma_f32_16x16x32_bf16 v[208:211], a[192:195], v[48:51], v[208:211]
    ds_read_b128 a[124:127], v2 offset:54016
    v_cvt_pk_bf16_f32 v42, v84, v85
    v_mfma_f32_16x16x32_bf16 v[212:215], a[200:203], v[48:51], v[212:215]
    v_exp_f32 v87, v87
    v_mfma_f32_16x16x32_bf16 v[212:215], a[204:207], v[52:55], v[212:215]
    ds_read_b128 a[128:131], v2 offset:57344
    ds_read_b128 a[132:135], v2 offset:57600
    v_mfma_f32_16x16x32_bf16 v[216:219], a[212:215], v[52:55], v[216:219]
    buffer_load_dwordx4 v5, s[4:7], s27 offen offset:1024 nt lds
    v_mfma_f32_16x16x32_bf16 v[216:219], a[208:211], v[48:51], v[216:219]
    ds_read_b128 a[136:139], v2 offset:57856
    v_mfma_f32_16x16x32_bf16 v[220:223], a[216:219], v[48:51], v[220:223]
    v_exp_f32 v88, v88
    v_mfma_f32_16x16x32_bf16 v[220:223], a[220:223], v[52:55], v[220:223]
    ds_read_b128 a[140:143], v2 offset:58112
    v_cvt_pk_bf16_f32 v43, v86, v87
    v_mfma_f32_16x16x32_bf16 a[236:239], a[240:243], v[56:59], a[236:239]
    v_exp_f32 v89, v89
    v_mfma_f32_16x16x32_bf16 a[236:239], a[240:243], v[60:63], a[236:239]
    ds_read_b128 a[144:147], v2 offset:61440
    ds_read_b128 a[148:151], v2 offset:61696
    v_mfma_f32_16x16x32_bf16 v[224:227], a[164:167], v[60:63], v[224:227]
    v_mfma_f32_16x16x32_bf16 v[224:227], a[160:163], v[56:59], v[224:227]
    v_exp_f32 v90, v90
    v_mfma_f32_16x16x32_bf16 v[228:231], a[168:171], v[56:59], v[228:231]
    ds_read_b128 a[152:155], v2 offset:61952
    ds_read_b128 a[156:159], v2 offset:62208
    v_mfma_f32_16x16x32_bf16 v[228:231], a[172:175], v[60:63], v[228:231]
    buffer_load_dwordx4 v6, s[4:7], s27 offen offset:2048 nt lds
    v_mfma_f32_16x16x32_bf16 v[232:235], a[180:183], v[60:63], v[232:235]
    ds_read_b64_tr_b16 a[160:161], v3 offset:32768
    ds_read_b64_tr_b16 a[162:163], v3 offset:36864
    v_mfma_f32_16x16x32_bf16 v[232:235], a[176:179], v[56:59], v[232:235]
    v_exp_f32 v91, v91
    v_mfma_f32_16x16x32_bf16 v[236:239], a[184:187], v[56:59], v[236:239]
    ds_read_b64_tr_b16 a[164:165], v3 offset:40960
    v_cvt_pk_bf16_f32 v44, v88, v89
    v_mfma_f32_16x16x32_bf16 v[236:239], a[188:191], v[60:63], v[236:239]
    ds_read_b64_tr_b16 a[166:167], v3 offset:45056
    v_mfma_f32_16x16x32_bf16 v[240:243], a[196:199], v[60:63], v[240:243]
    v_exp_f32 v92, v92
    v_mfma_f32_16x16x32_bf16 v[240:243], a[192:195], v[56:59], v[240:243]
    v_exp_f32 v93, v93
    v_mfma_f32_16x16x32_bf16 v[244:247], a[200:203], v[56:59], v[244:247]
    ds_read_b64_tr_b16 a[168:169], v4 offset:32768
    ds_read_b64_tr_b16 a[170:171], v4 offset:36864
    v_mfma_f32_16x16x32_bf16 v[244:247], a[204:207], v[60:63], v[244:247]
    buffer_load_dwordx4 v6, s[4:7], s27 offen offset:3072 nt lds
    v_mfma_f32_16x16x32_bf16 v[248:251], a[212:215], v[60:63], v[248:251]
    ds_read_b64_tr_b16 a[172:173], v4 offset:40960
    v_mfma_f32_16x16x32_bf16 v[248:251], a[208:211], v[56:59], v[248:251]
    ds_read_b64_tr_b16 a[174:175], v4 offset:45056
    v_cvt_pk_bf16_f32 v45, v90, v91
    v_mfma_f32_16x16x32_bf16 v[252:255], a[216:219], v[56:59], v[252:255]
    v_exp_f32 v94, v94
    v_mfma_f32_16x16x32_bf16 v[252:255], a[220:223], v[60:63], v[252:255]
    s_waitcnt lgkmcnt(8)
L_n5:
    v_mfma_f32_16x16x32_bf16 v[64:67], a[96:99], a[0:3], v[12:15]
    v_exp_f32 v95, v95
    v_mfma_f32_16x16x32_bf16 v[64:67], a[100:103], a[4:7], v[64:67]
    ds_read_b64_tr_b16 a[176:177], v3 offset:33024
    ds_read_b64_tr_b16 a[178:179], v3 offset:37120
    v_mfma_f32_16x16x32_bf16 v[64:67], a[104:107], a[8:11], v[64:67]
    ds_read_b64_tr_b16 a[180:181], v3 offset:41216
    v_cvt_pk_bf16_f32 v46, v92, v93
    v_mfma_f32_16x16x32_bf16 v[64:67], a[108:111], a[12:15], v[64:67]
    ds_read_b64_tr_b16 a[182:183], v3 offset:45312
    v_cvt_pk_bf16_f32 v47, v94, v95
    v_mfma_f32_16x16x32_bf16 v[68:71], a[124:127], a[12:15], v[12:15]
    v_exp_f32 v96, v96
    v_mfma_f32_16x16x32_bf16 v[68:71], a[120:123], a[8:11], v[68:71]
    ds_read_b64_tr_b16 a[184:185], v4 offset:33024
    v_mfma_f32_16x16x32_bf16 v[68:71], a[116:119], a[4:7], v[68:71]
    s_add_u32 m0, s22, 24576
    ds_read_b64_tr_b16 a[186:187], v4 offset:37120
    ds_read_b64_tr_b16 a[188:189], v4 offset:41216
    v_mfma_f32_16x16x32_bf16 v[68:71], a[112:115], a[0:3], v[68:71]
    buffer_load_dwordx4 v1, s[8:11], s43 offen offset:0 nt lds
    v_mfma_f32_16x16x32_bf16 v[72:75], a[128:131], a[0:3], v[12:15]
    ds_read_b64_tr_b16 a[190:191], v4 offset:45312
    ds_read_b64_tr_b16 a[192:193], v3 offset:33280
    v_mfma_f32_16x16x32_bf16 v[72:75], a[132:135], a[4:7], v[72:75]
    v_exp_f32 v97, v97
    v_mfma_f32_16x16x32_bf16 v[72:75], a[136:139], a[8:11], v[72:75]
    ds_read_b64_tr_b16 a[194:195], v3 offset:37376
    ds_read_b64_tr_b16 a[196:197], v3 offset:41472
    v_mfma_f32_16x16x32_bf16 v[72:75], a[140:143], a[12:15], v[72:75]
    v_exp_f32 v98, v98
    v_mfma_f32_16x16x32_bf16 v[76:79], a[156:159], a[12:15], v[12:15]
    ds_read_b64_tr_b16 a[198:199], v3 offset:45568
    v_mfma_f32_16x16x32_bf16 v[76:79], a[152:155], a[8:11], v[76:79]
    v_exp_f32 v99, v99
    v_mfma_f32_16x16x32_bf16 v[76:79], a[148:151], a[4:7], v[76:79]
    ds_read_b64_tr_b16 a[200:201], v4 offset:33280
    ds_read_b64_tr_b16 a[202:203], v4 offset:37376
    v_mfma_f32_16x16x32_bf16 v[76:79], a[144:147], a[0:3], v[76:79]
    buffer_load_dwordx4 v1, s[8:11], s43 offen offset:1024 nt lds
    v_mfma_f32_16x16x32_bf16 v[80:83], a[96:99], a[16:19], v[16:19]
    ds_read_b64_tr_b16 a[204:205], v4 offset:41472
    ds_read_b64_tr_b16 a[206:207], v4 offset:45568
    v_mfma_f32_16x16x32_bf16 v[80:83], a[100:103], a[20:23], v[80:83]
    ds_read_b64_tr_b16 a[208:209], v3 offset:33536
    v_mfma_f32_16x16x32_bf16 v[80:83], a[104:107], a[24:27], v[80:83]
    ds_read_b64_tr_b16 a[210:211], v3 offset:37632
    v_cvt_pk_bf16_f32 v48, v96, v97
    v_mfma_f32_16x16x32_bf16 v[80:83], a[108:111], a[28:31], v[80:83]
    v_exp_f32 v100, v100
    v_mfma_f32_16x16x32_bf16 v[84:87], a[124:127], a[28:31], v[16:19]
    ds_read_b64_tr_b16 a[212:213], v3 offset:41728
    ds_read_b64_tr_b16 a[214:215], v3 offset:45824
    v_mfma_f32_16x16x32_bf16 v[84:87], a[120:123], a[24:27], v[84:87]
    s_add_u32 m0, s22, 73728
    ds_read_b64_tr_b16 a[216:217], v4 offset:33536
    v_mfma_f32_16x16x32_bf16 v[84:87], a[116:119], a[20:23], v[84:87]
    v_exp_f32 v101, v101
    v_mfma_f32_16x16x32_bf16 v[84:87], a[112:115], a[16:19], v[84:87]
    ds_read_b64_tr_b16 a[218:219], v4 offset:37632
    v_cvt_pk_bf16_f32 v49, v98, v99
    v_mfma_f32_16x16x32_bf16 v[88:91], a[128:131], a[16:19], v[16:19]
    buffer_load_dwordx4 v1, s[12:15], s41 offen offset:0 nt lds
    v_mfma_f32_16x16x32_bf16 v[88:91], a[132:135], a[20:23], v[88:91]
    ds_read_b64_tr_b16 a[220:221], v4 offset:41728
    ds_read_b64_tr_b16 a[222:223], v4 offset:45824
    v_mfma_f32_16x16x32_bf16 v[88:91], a[136:139], a[24:27], v[88:91]
    v_mfma_f32_16x16x32_bf16 v[88:91], a[140:143], a[28:31], v[88:91]
    v_exp_f32 v102, v102
    v_mfma_f32_16x16x32_bf16 v[92:95], a[156:159], a[28:31], v[16:19]
    v_exp_f32 v103, v103
    v_mfma_f32_16x16x32_bf16 v[92:95], a[152:155], a[24:27], v[92:95]
    v_cvt_pk_bf16_f32 v50, v100, v101
    v_mfma_f32_16x16x32_bf16 v[92:95], a[148:151], a[20:23], v[92:95]
    v_exp_f32 v104, v104
    v_mfma_f32_16x16x32_bf16 v[92:95], a[144:147], a[16:19], v[92:95]
    s_waitcnt lgkmcnt(0)
    buffer_load_dwordx4 v1, s[12:15], s41 offen offset:1024 nt lds
    v_mfma_f32_16x16x32_bf16 a[224:227], a[240:243], v[32:35], a[224:227]
    v_exp_f32 v105, v105
    v_mfma_f32_16x16x32_bf16 a[224:227], a[240:243], v[36:39], a[224:227]
    v_cvt_pk_bf16_f32 v51, v102, v103
    v_mfma_f32_16x16x32_bf16 v[128:131], a[164:167], v[36:39], v[128:131]
    v_exp_f32 v106, v106
    v_mfma_f32_16x16x32_bf16 v[128:131], a[160:163], v[32:35], v[128:131]
    v_exp_f32 v107, v107
    v_mfma_f32_16x16x32_bf16 v[132:135], a[168:171], v[32:35], v[132:135]
    s_add_u32 m0, s26, 135168
    v_cvt_pk_bf16_f32 v52, v104, v105
    v_mfma_f32_16x16x32_bf16 v[132:135], a[172:175], v[36:39], v[132:135]
    s_xor_b32 s27, s25, 4096
    v_exp_f32 v108, v108
    v_mfma_f32_16x16x32_bf16 v[136:139], a[180:183], v[36:39], v[136:139]
    v_exp_f32 v109, v109
    v_mfma_f32_16x16x32_bf16 v[136:139], a[176:179], v[32:35], v[136:139]
    buffer_load_dwordx4 v5, s[4:7], s27 offen offset:0 nt lds
    v_mfma_f32_16x16x32_bf16 v[140:143], a[184:187], v[32:35], v[140:143]
    v_cvt_pk_bf16_f32 v53, v106, v107
    v_mfma_f32_16x16x32_bf16 v[140:143], a[188:191], v[36:39], v[140:143]
    v_exp_f32 v110, v110
    v_mfma_f32_16x16x32_bf16 v[144:147], a[196:199], v[36:39], v[144:147]
    v_exp_f32 v111, v111
    v_mfma_f32_16x16x32_bf16 v[144:147], a[192:195], v[32:35], v[144:147]
    v_cvt_pk_bf16_f32 v54, v108, v109
    v_mfma_f32_16x16x32_bf16 v[148:151], a[200:203], v[32:35], v[148:151]
    v_exp_f32 v112, v112
    v_mfma_f32_16x16x32_bf16 v[148:151], a[204:207], v[36:39], v[148:151]
    v_exp_f32 v113, v113
    v_mfma_f32_16x16x32_bf16 v[152:155], a[212:215], v[36:39], v[152:155]
    buffer_load_dwordx4 v5, s[4:7], s27 offen offset:1024 nt lds
    v_mfma_f32_16x16x32_bf16 v[152:155], a[208:211], v[32:35], v[152:155]
    v_cvt_pk_bf16_f32 v55, v110, v111
    v_mfma_f32_16x16x32_bf16 v[156:159], a[216:219], v[32:35], v[156:159]
    v_exp_f32 v114, v114
    v_mfma_f32_16x16x32_bf16 v[156:159], a[220:223], v[36:39], v[156:159]
    v_exp_f32 v115, v115
    v_mfma_f32_16x16x32_bf16 a[228:231], a[240:243], v[40:43], a[228:231]
    v_cvt_pk_bf16_f32 v56, v112, v113
    v_mfma_f32_16x16x32_bf16 a[228:231], a[240:243], v[44:47], a[228:231]
    v_exp_f32 v116, v116
    v_mfma_f32_16x16x32_bf16 v[160:163], a[164:167], v[44:47], v[160:163]
    v_exp_f32 v117, v117
    v_mfma_f32_16x16x32_bf16 v[160:163], a[160:163], v[40:43], v[160:163]
    v_cvt_pk_bf16_f32 v57, v114, v115
    v_mfma_f32_16x16x32_bf16 v[164:167], a[168:171], v[40:43], v[164:167]
    v_exp_f32 v118, v118
    v_mfma_f32_16x16x32_bf16 v[164:167], a[172:175], v[44:47], v[164:167]
    buffer_load_dwordx4 v6, s[4:7], s27 offen offset:2048 nt lds
    v_mfma_f32_16x16x32_bf16 v[168:171], a[180:183], v[44:47], v[168:171]
    v_exp_f32 v119, v119
    v_mfma_f32_16x16x32_bf16 v[168:171], a[176:179], v[40:43], v[168:171]
    v_cvt_pk_bf16_f32 v58, v116, v117
    v_mfma_f32_16x16x32_bf16 v[172:175], a[184:187], v[40:43], v[172:175]
    v_exp_f32 v120, v120
    v_mfma_f32_16x16x32_bf16 v[172:175], a[188:191], v[44:47], v[172:175]
    v_exp_f32 v121, v121
    v_mfma_f32_16x16x32_bf16 v[176:179], a[196:199], v[44:47], v[176:179]
    v_cvt_pk_bf16_f32 v59, v118, v119
    v_mfma_f32_16x16x32_bf16 v[176:179], a[192:195], v[40:43], v[176:179]
    v_exp_f32 v122, v122
    v_mfma_f32_16x16x32_bf16 v[180:183], a[200:203], v[40:43], v[180:183]
    v_exp_f32 v123, v123
    v_mfma_f32_16x16x32_bf16 v[180:183], a[204:207], v[44:47], v[180:183]
    buffer_load_dwordx4 v6, s[4:7], s27 offen offset:3072 nt lds
    v_mfma_f32_16x16x32_bf16 v[184:187], a[212:215], v[44:47], v[184:187]
    v_cvt_pk_bf16_f32 v60, v120, v121
    v_mfma_f32_16x16x32_bf16 v[184:187], a[208:211], v[40:43], v[184:187]
    v_exp_f32 v124, v124
    v_mfma_f32_16x16x32_bf16 v[188:191], a[216:219], v[40:43], v[188:191]
    v_exp_f32 v125, v125
    v_mfma_f32_16x16x32_bf16 v[188:191], a[220:223], v[44:47], v[188:191]
    v_cvt_pk_bf16_f32 v61, v122, v123
    v_exp_f32 v126, v126
L_n6:
    v_mfma_f32_16x16x32_bf16 v[96:99], a[96:99], a[32:35], v[20:23]
    v_exp_f32 v127, v127
    v_mfma_f32_16x16x32_bf16 v[96:99], a[100:103], a[36:39], v[96:99]
    v_cvt_pk_bf16_f32 v62, v124, v125
    v_cvt_pk_bf16_f32 v63, v126, v127
    v_mfma_f32_16x16x32_bf16 v[96:99], a[104:107], a[40:43], v[96:99]
    v_exp_f32 v64, v64
    v_mfma_f32_16x16x32_bf16 v[96:99], a[108:111], a[44:47], v[96:99]
    v_exp_f32 v65, v65
    v_mfma_f32_16x16x32_bf16 v[100:103], a[124:127], a[44:47], v[20:23]
    v_exp_f32 v66, v66
    v_mfma_f32_16x16x32_bf16 v[100:103], a[120:123], a[40:43], v[100:103]
    v_cvt_pk_bf16_f32 v32, v64, v65
    v_mfma_f32_16x16x32_bf16 v[100:103], a[116:119], a[36:39], v[100:103]
    v_exp_f32 v67, v67
    v_mfma_f32_16x16x32_bf16 v[100:103], a[112:115], a[32:35], v[100:103]
    v_exp_f32 v68, v68
    v_mfma_f32_16x16x32_bf16 v[104:107], a[128:131], a[32:35], v[20:23]
    s_add_u32 m0, s22, 32768
    v_cvt_pk_bf16_f32 v33, v66, v67
    v_mfma_f32_16x16x32_bf16 v[104:107], a[132:135], a[36:39], v[104:107]
    v_exp_f32 v69, v69
    v_mfma_f32_16x16x32_bf16 v[104:107], a[136:139], a[40:43], v[104:107]
    v_exp_f32 v70, v70
    v_mfma_f32_16x16x32_bf16 v[104:107], a[140:143], a[44:47], v[104:107]
    buffer_load_dwordx4 v1, s[8:11], s44 offen offset:0 nt lds
    v_mfma_f32_16x16x32_bf16 v[108:111], a[156:159], a[44:47], v[20:23]
    v_cvt_pk_bf16_f32 v34, v68, v69
    v_mfma_f32_16x16x32_bf16 v[108:111], a[152:155], a[40:43], v[108:111]
    v_exp_f32 v71, v71
    v_mfma_f32_16x16x32_bf16 v[108:111], a[148:151], a[36:39], v[108:111]
    v_mfma_f32_16x16x32_bf16 v[108:111], a[144:147], a[32:35], v[108:111]
    v_exp_f32 v72, v72
    v_mfma_f32_16x16x32_bf16 v[112:115], a[96:99], a[48:51], v[24:27]
    v_exp_f32 v73, v73
    v_mfma_f32_16x16x32_bf16 v[112:115], a[100:103], a[52:55], v[112:115]
    v_cvt_pk_bf16_f32 v35, v70, v71
    v_mfma_f32_16x16x32_bf16 v[112:115], a[104:107], a[56:59], v[112:115]
    v_exp_f32 v74, v74
    v_mfma_f32_16x16x32_bf16 v[112:115], a[108:111], a[60:63], v[112:115]
    v_exp_f32 v75, v75
    v_mfma_f32_16x16x32_bf16 v[116:119], a[124:127], a[60:63], v[24:27]
    v_cvt_pk_bf16_f32 v36, v72, v73
    v_mfma_f32_16x16x32_bf16 v[116:119], a[120:123], a[56:59], v[116:119]
    v_exp_f32 v76, v76
    v_mfma_f32_16x16x32_bf16 v[116:119], a[116:119], a[52:55], v[116:119]
    v_exp_f32 v77, v77
    v_mfma_f32_16x16x32_bf16 v[116:119], a[112:115], a[48:51], v[116:119]
    s_waitcnt vmcnt(17)
    v_cvt_pk_bf16_f32 v37, v74, v75
    v_mfma_f32_16x16x32_bf16 v[120:123], a[128:131], a[48:51], v[24:27]
    s_barrier
    v_exp_f32 v78, v78
    v_mfma_f32_16x16x32_bf16 v[120:123], a[132:135], a[52:55], v[120:123]
    v_exp_f32 v79, v79
    v_mfma_f32_16x16x32_bf16 v[120:123], a[136:139], a[56:59], v[120:123]
    buffer_load_dwordx4 v1, s[8:11], s44 offen offset:1024 nt lds
    v_mfma_f32_16x16x32_bf16 v[120:123], a[140:143], a[60:63], v[120:123]
    v_cvt_pk_bf16_f32 v38, v76, v77
    v_mfma_f32_16x16x32_bf16 v[124:127], a[156:159], a[60:63], v[24:27]
    v_exp_f32 v80, v80
    v_mfma_f32_16x16x32_bf16 v[124:127], a[152:155], a[56:59], v[124:127]
    v_exp_f32 v81, v81
    v_mfma_f32_16x16x32_bf16 v[124:127], a[148:151], a[52:55], v[124:127]
    v_cvt_pk_bf16_f32 v39, v78, v79
    v_mfma_f32_16x16x32_bf16 v[124:127], a[144:147], a[48:51], v[124:127]
    v_exp_f32 v82, v82
    v_mfma_f32_16x16x32_bf16 a[232:235], a[240:243], v[48:51], a[232:235]
    v_exp_f32 v83, v83
    v_mfma_f32_16x16x32_bf16 a[232:235], a[240:243], v[52:55], a[232:235]
    ds_read_b128 a[96:99], v2 offset:0
    ds_read_b128 a[100:103], v2 offset:256
    v_mfma_f32_16x16x32_bf16 v[192:195], a[164:167], v[52:55], v[192:195]
    v_cvt_pk_bf16_f32 v40, v80, v81
    v_mfma_f32_16x16x32_bf16 v[192:195], a[160:163], v[48:51], v[192:195]
    v_exp_f32 v84, v84
    v_mfma_f32_16x16x32_bf16 v[196:199], a[168:171], v[48:51], v[196:199]
    ds_read_b128 a[104:107], v2 offset:512
    ds_read_b128 a[108:111], v2 offset:768
    v_mfma_f32_16x16x32_bf16 v[196:199], a[172:175], v[52:55], v[196:199]
    v_cvt_pk_bf16_f32 v41, v82, v83
    v_mfma_f32_16x16x32_bf16 v[200:203], a[180:183], v[52:55], v[200:203]
    v_exp_f32 v85, v85
    v_mfma_f32_16x16x32_bf16 v[200:203], a[176:179], v[48:51], v[200:203]
    ds_read_b128 a[112:115], v2 offset:4096
    ds_read_b128 a[116:119], v2 offset:4352
    v_mfma_f32_16x16x32_bf16 v[204:207], a[184:187], v[48:51], v[204:207]
    s_add_u32 m0, s22, 81920
    v_mfma_f32_16x16x32_bf16 v[204:207], a[188:191], v[52:55], v[204:207]
    v_exp_f32 v86, v86
    v_mfma_f32_16x16x32_bf16 v[208:211], a[196:199], v[52:55], v[208:211]
    ds_read_b128 a[120:123], v2 offset:4608
    ds_read_b128 a[124:127], v2 offset:4864
    v_mfma_f32_16x16x32_bf16 v[208:211], a[192:195], v[48:51], v[208:211]
    buffer_load_dwordx4 v1, s[12:15], s42 offen offset:0 nt lds
    v_mfma_f32_16x16x32_bf16 v[212:215], a[200:203], v[48:51], v[212:215]
    v_exp_f32 v87, v87
    v_mfma_f32_16x16x32_bf16 v[212:215], a[204:207], v[52:55], v[212:215]
    ds_read_b128 a[128:131], v2 offset:8192
    ds_read_b128 a[132:135], v2 offset:8448
    v_mfma_f32_16x16x32_bf16 v[216:219], a[212:215], v[52:55], v[216:219]
    v_cvt_pk_bf16_f32 v42, v84, v85
    v_mfma_f32_16x16x32_bf16 v[216:219], a[208:211], v[48:51], v[216:219]
    v_exp_f32 v88, v88
    v_mfma_f32_16x16x32_bf16 v[220:223], a[216:219], v[48:51], v[220:223]
    ds_read_b128 a[136:139], v2 offset:8704
    ds_read_b128 a[140:143], v2 offset:8960
    v_mfma_f32_16x16x32_bf16 v[220:223], a[220:223], v[52:55], v[220:223]
    v_cvt_pk_bf16_f32 v43, v86, v87
    v_mfma_f32_16x16x32_bf16 a[236:239], a[240:243], v[56:59], a[236:239]
    v_exp_f32 v89, v89
    v_mfma_f32_16x16x32_bf16 a[236:239], a[240:243], v[60:63], a[236:239]
    ds_read_b128 a[144:147], v2 offset:12288
    ds_read_b128 a[148:151], v2 offset:12544
    v_mfma_f32_16x16x32_bf16 v[224:227], a[164:167], v[60:63], v[224:227]
    v_mfma_f32_16x16x32_bf16 v[224:227], a[160:163], v[56:59], v[224:227]
    v_exp_f32 v90, v90
    v_mfma_f32_16x16x32_bf16 v[228:231], a[168:171], v[56:59], v[228:231]
    ds_read_b128 a[152:155], v2 offset:12800
    ds_read_b128 a[156:159], v2 offset:13056
    v_mfma_f32_16x16x32_bf16 v[228:231], a[172:175], v[60:63], v[228:231]
    v_exp_f32 v91, v91
    v_mfma_f32_16x16x32_bf16 v[232:235], a[180:183], v[60:63], v[232:235]
    ds_read_b64_tr_b16 a[160:161], v3 offset:49152
    ds_read_b64_tr_b16 a[162:163], v3 offset:53248
    v_mfma_f32_16x16x32_bf16 v[232:235], a[176:179], v[56:59], v[232:235]
    v_cvt_pk_bf16_f32 v44, v88, v89
    v_mfma_f32_16x16x32_bf16 v[236:239], a[184:187], v[56:59], v[236:239]
    v_exp_f32 v92, v92
    v_mfma_f32_16x16x32_bf16 v[236:239], a[188:191], v[60:63], v[236:239]
    ds_read_b64_tr_b16 a[164:165], v3 offset:57344
    v_mfma_f32_16x16x32_bf16 v[240:243], a[196:199], v[60:63], v[240:243]
    buffer_load_dwordx4 v1, s[12:15], s42 offen offset:1024 nt lds
    v_mfma_f32_16x16x32_bf16 v[240:243], a[192:195], v[56:59], v[240:243]
    ds_read_b64_tr_b16 a[166:167], v3 offset:61440
    ds_read_b64_tr_b16 a[168:169], v4 offset:49152
    v_mfma_f32_16x16x32_bf16 v[244:247], a[200:203], v[56:59], v[244:247]
    ds_read_b64_tr_b16 a[170:171], v4 offset:53248
    v_mfma_f32_16x16x32_bf16 v[244:247], a[204:207], v[60:63], v[244:247]
    v_exp_f32 v93, v93
    v_mfma_f32_16x16x32_bf16 v[248:251], a[212:215], v[60:63], v[248:251]
    ds_read_b64_tr_b16 a[172:173], v4 offset:57344
    v_cvt_pk_bf16_f32 v45, v90, v91
    v_mfma_f32_16x16x32_bf16 v[248:251], a[208:211], v[56:59], v[248:251]
    ds_read_b64_tr_b16 a[174:175], v4 offset:61440
    v_mfma_f32_16x16x32_bf16 v[252:255], a[216:219], v[56:59], v[252:255]
    v_exp_f32 v94, v94
    v_mfma_f32_16x16x32_bf16 v[252:255], a[220:223], v[60:63], v[252:255]
    s_waitcnt lgkmcnt(8)
L_n7:
    v_mfma_f32_16x16x32_bf16 v[64:67], a[96:99], a[0:3], v[12:15]
    v_exp_f32 v95, v95
    v_mfma_f32_16x16x32_bf16 v[64:67], a[100:103], a[4:7], v[64:67]
    ds_read_b64_tr_b16 a[176:177], v3 offset:49408
    ds_read_b64_tr_b16 a[178:179], v3 offset:53504
    v_mfma_f32_16x16x32_bf16 v[64:67], a[104:107], a[8:11], v[64:67]
    ds_read_b64_tr_b16 a[180:181], v3 offset:57600
    v_cvt_pk_bf16_f32 v46, v92, v93
    v_mfma_f32_16x16x32_bf16 v[64:67], a[108:111], a[12:15], v[64:67]
    ds_read_b64_tr_b16 a[182:183], v3 offset:61696
    v_cvt_pk_bf16_f32 v47, v94, v95
    v_mfma_f32_16x16x32_bf16 v[68:71], a[124:127], a[12:15], v[12:15]
    v_exp_f32 v96, v96
    v_mfma_f32_16x16x32_bf16 v[68:71], a[120:123], a[8:11], v[68:71]
    ds_read_b64_tr_b16 a[184:185], v4 offset:49408
    ds_read_b64_tr_b16 a[186:187], v4 offset:53504
    v_mfma_f32_16x16x32_bf16 v[68:71], a[116:119], a[4:7], v[68:71]
    ds_read_b64_tr_b16 a[188:189], v4 offset:57600
    v_mfma_f32_16x16x32_bf16 v[68:71], a[112:115], a[0:3], v[68:71]
    v_exp_f32 v97, v97
    v_mfma_f32_16x16x32_bf16 v[72:75], a[128:131], a[0:3], v[12:15]
    ds_read_b64_tr_b16 a[190:191], v4 offset:61696
    v_mfma_f32_16x16x32_bf16 v[72:75], a[132:135], a[4:7], v[72:75]
    s_add_u32 m0, s22, 40960
    ds_read_b64_tr_b16 a[192:193], v3 offset:49664
    ds_read_b64_tr_b16 a[194:195], v3 offset:53760
    v_mfma_f32_16x16x32_bf16 v[72:75], a[136:139], a[8:11], v[72:75]
    buffer_load_dwordx4 v1, s[8:11], s45 offen offset:0 nt lds
    v_mfma_f32_16x16x32_bf16 v[72:75], a[140:143], a[12:15], v[72:75]
    ds_read_b64_tr_b16 a[196:197], v3 offset:57856
    ds_read_b64_tr_b16 a[198:199], v3 offset:61952
    v_mfma_f32_16x16x32_bf16 v[76:79], a[156:159], a[12:15], v[12:15]
    v_mfma_f32_16x16x32_bf16 v[76:79], a[152:155], a[8:11], v[76:79]
    v_exp_f32 v98, v98
    v_mfma_f32_16x16x32_bf16 v[76:79], a[148:151], a[4:7], v[76:79]
    ds_read_b64_tr_b16 a[200:201], v4 offset:49664
    ds_read_b64_tr_b16 a[202:203], v4 offset:53760
    v_mfma_f32_16x16x32_bf16 v[76:79], a[144:147], a[0:3], v[76:79]
    v_exp_f32 v99, v99
    v_mfma_f32_16x16x32_bf16 v[80:83], a[96:99], a[16:19], v[16:19]
    ds_read_b64_tr_b16 a[204:205], v4 offset:57856
    ds_read_b64_tr_b16 a[206:207], v4 offset:61952
    v_mfma_f32_16x16x32_bf16 v[80:83], a[100:103], a[20:23], v[80:83]
    ds_read_b64_tr_b16 a[208:209], v3 offset:49920
    v_cvt_pk_bf16_f32 v48, v96, v97
    v_mfma_f32_16x16x32_bf16 v[80:83], a[104:107], a[24:27], v[80:83]
    ds_read_b64_tr_b16 a[210:211], v3 offset:54016
    v_mfma_f32_16x16x32_bf16 v[80:83], a[108:111], a[28:31], v[80:83]
    v_exp_f32 v100, v100
    v_mfma_f32_16x16x32_bf16 v[84:87], a[124:127], a[28:31], v[16:19]
    ds_read_b64_tr_b16 a[212:213], v3 offset:58112
    ds_read_b64_tr_b16 a[214:215], v3 offset:62208
    v_mfma_f32_16x16x32_bf16 v[84:87], a[120:123], a[24:27], v[84:87]
    ds_read_b64_tr_b16 a[216:217], v4 offset:49920
    v_mfma_f32_16x16x32_bf16 v[84:87], a[116:119], a[20:23], v[84:87]
    buffer_load_dwordx4 v1, s[8:11], s45 offen offset:1024 nt lds
    v_mfma_f32_16x16x32_bf16 v[84:87], a[112:115], a[16:19], v[84:87]
    ds_read_b64_tr_b16 a[218:219], v4 offset:54016
    ds_read_b64_tr_b16 a[220:221], v4 offset:58112
    v_mfma_f32_16x16x32_bf16 v[88:91], a[128:131], a[16:19], v[16:19]
    ds_read_b64_tr_b16 a[222:223], v4 offset:62208
    v_mfma_f32_16x16x32_bf16 v[88:91], a[132:135], a[20:23], v[88:91]
    v_exp_f32 v101, v101
    v_mfma_f32_16x16x32_bf16 v[88:91], a[136:139], a[24:27], v[88:91]
    v_cvt_pk_bf16_f32 v49, v98, v99
    v_mfma_f32_16x16x32_bf16 v[88:91], a[140:143], a[28:31], v[88:91]
    v_exp_f32 v102, v102
    v_mfma_f32_16x16x32_bf16 v[92:95], a[156:159], a[28:31], v[16:19]
    v_exp_f32 v103, v103
    v_mfma_f32_16x16x32_bf16 v[92:95], a[152:155], a[24:27], v[92:95]
    v_cvt_pk_bf16_f32 v50, v100, v101
    v_mfma_f32_16x16x32_bf16 v[92:95], a[148:151], a[20:23], v[92:95]
    v_exp_f32 v104, v104
    v_mfma_f32_16x16x32_bf16 v[92:95], a[144:147], a[16:19], v[92:95]
    s_waitcnt lgkmcnt(0)
    v_exp_f32 v105, v105
    v_mfma_f32_16x16x32_bf16 a[224:227], a[240:243], v[32:35], a[224:227]
    s_add_u32 m0, s22, 90112
    v_cvt_pk_bf16_f32 v51, v102, v103
    v_mfma_f32_16x16x32_bf16 a[224:227], a[240:243], v[36:39], a[224:227]
    v_exp_f32 v106, v106
    v_mfma_f32_16x16x32_bf16 v[128:131], a[164:167], v[36:39], v[128:131]
    v_exp_f32 v107, v107
    v_mfma_f32_16x16x32_bf16 v[128:131], a[160:163], v[32:35], v[128:131]
    buffer_load_dwordx4 v1, s[12:15], s43 offen offset:0 nt lds
    v_mfma_f32_16x16x32_bf16 v[132:135], a[168:171], v[32:35], v[132:135]
    v_cvt_pk_bf16_f32 v52, v104, v105
    v_mfma_f32_16x16x32_bf16 v[132:135], a[172:175], v[36:39], v[132:135]
    v_exp_f32 v108, v108
    v_mfma_f32_16x16x32_bf16 v[136:139], a[180:183], v[36:39], v[136:139]
    v_exp_f32 v109, v109
    v_mfma_f32_16x16x32_bf16 v[136:139], a[176:179], v[32:35], v[136:139]
    v_cvt_pk_bf16_f32 v53, v106, v107
    v_mfma_f32_16x16x32_bf16 v[140:143], a[184:187], v[32:35], v[140:143]
    v_exp_f32 v110, v110
    v_mfma_f32_16x16x32_bf16 v[140:143], a[188:191], v[36:39], v[140:143]
    v_exp_f32 v111, v111
    v_mfma_f32_16x16x32_bf16 v[144:147], a[196:199], v[36:39], v[144:147]
    v_cvt_pk_bf16_f32 v54, v108, v109
    v_mfma_f32_16x16x32_bf16 v[144:147], a[192:195], v[32:35], v[144:147]
    v_exp_f32 v112, v112
    v_mfma_f32_16x16x32_bf16 v[148:151], a[200:203], v[32:35], v[148:151]
    v_exp_f32 v113, v113
    v_mfma_f32_16x16x32_bf16 v[148:151], a[204:207], v[36:39], v[148:151]
    v_cvt_pk_bf16_f32 v55, v110, v111
    v_mfma_f32_16x16x32_bf16 v[152:155], a[212:215], v[36:39], v[152:155]
    v_exp_f32 v114, v114
    v_mfma_f32_16x16x32_bf16 v[152:155], a[208:211], v[32:35], v[152:155]
    v_exp_f32 v115, v115
    v_mfma_f32_16x16x32_bf16 v[156:159], a[216:219], v[32:35], v[156:159]
    buffer_load_dwordx4 v1, s[12:15], s43 offen offset:1024 nt lds
    v_mfma_f32_16x16x32_bf16 v[156:159], a[220:223], v[36:39], v[156:159]
    v_cvt_pk_bf16_f32 v56, v112, v113
    v_mfma_f32_16x16x32_bf16 a[228:231], a[240:243], v[40:43], a[228:231]
    v_exp_f32 v116, v116
    v_mfma_f32_16x16x32_bf16 a[228:231], a[240:243], v[44:47], a[228:231]
    v_exp_f32 v117, v117
    v_mfma_f32_16x16x32_bf16 v[160:163], a[164:167], v[44:47], v[160:163]
    v_cvt_pk_bf16_f32 v57, v114, v115
    v_mfma_f32_16x16x32_bf16 v[160:163], a[160:163], v[40:43], v[160:163]
    v_exp_f32 v118, v118
    v_mfma_f32_16x16x32_bf16 v[164:167], a[168:171], v[40:43], v[164:167]
    v_exp_f32 v119, v119
    v_mfma_f32_16x16x32_bf16 v[164:167], a[172:175], v[44:47], v[164:167]
    v_cvt_pk_bf16_f32 v58, v116, v117
    v_mfma_f32_16x16x32_bf16 v[168:171], a[180:183], v[44:47], v[168:171]
    v_exp_f32 v120, v120
    v_mfma_f32_16x16x32_bf16 v[168:171], a[176:179], v[40:43], v[168:171]
    s_add_u32 s23, s0, L_n10-L_pc
    v_exp_f32 v121, v121
    v_mfma_f32_16x16x32_bf16 v[172:175], a[184:187], v[40:43], v[172:175]
    v_cvt_pk_bf16_f32 v59, v118, v119
    v_mfma_f32_16x16x32_bf16 v[172:175], a[188:191], v[44:47], v[172:175]
    v_exp_f32 v122, v122
    v_mfma_f32_16x16x32_bf16 v[176:179], a[196:199], v[44:47], v[176:179]
    buffer_load_dword a247, off, s[96:99], s23
    v_mfma_f32_16x16x32_bf16 v[176:179], a[192:195], v[40:43], v[176:179]
    v_cvt_pk_bf16_f32 v60, v120, v121
    v_mfma_f32_16x16x32_bf16 v[180:183], a[200:203], v[40:43], v[180:183]
    v_exp_f32 v123, v123
    v_mfma_f32_16x16x32_bf16 v[180:183], a[204:207], v[44:47], v[180:183]
    v_exp_f32 v124, v124
    v_mfma_f32_16x16x32_bf16 v[184:187], a[212:215], v[44:47], v[184:187]
    v_cvt_pk_bf16_f32 v61, v122, v123
    v_mfma_f32_16x16x32_bf16 v[184:187], a[208:211], v[40:43], v[184:187]
    v_exp_f32 v125, v125
    v_mfma_f32_16x16x32_bf16 v[188:191], a[216:219], v[40:43], v[188:191]
    v_exp_f32 v126, v126
    v_mfma_f32_16x16x32_bf16 v[188:191], a[220:223], v[44:47], v[188:191]
    s_waitcnt vmcnt(17)
L_n8:
    v_mfma_f32_16x16x32_bf16 v[96:99], a[96:99], a[32:35], v[20:23]
    v_exp_f32 v127, v127
    v_mfma_f32_16x16x32_bf16 v[96:99], a[100:103], a[36:39], v[96:99]
    v_cvt_pk_bf16_f32 v62, v124, v125
    v_cvt_pk_bf16_f32 v63, v126, v127
    v_mfma_f32_16x16x32_bf16 v[96:99], a[104:107], a[40:43], v[96:99]
    v_exp_f32 v64, v64
    v_mfma_f32_16x16x32_bf16 v[96:99], a[108:111], a[44:47], v[96:99]
    v_exp_f32 v65, v65
    v_mfma_f32_16x16x32_bf16 v[100:103], a[124:127], a[44:47], v[20:23]
    v_exp_f32 v66, v66
    v_mfma_f32_16x16x32_bf16 v[100:103], a[120:123], a[40:43], v[100:103]
    v_exp_f32 v67, v67
    v_mfma_f32_16x16x32_bf16 v[100:103], a[116:119], a[36:39], v[100:103]
    v_cvt_pk_bf16_f32 v32, v64, v65
    v_mfma_f32_16x16x32_bf16 v[100:103], a[112:115], a[32:35], v[100:103]
    v_exp_f32 v68, v68
    v_mfma_f32_16x16x32_bf16 v[104:107], a[128:131], a[32:35], v[20:23]
    s_add_u32 m0, s22, 49152
    v_exp_f32 v69, v69
    v_mfma_f32_16x16x32_bf16 v[104:107], a[132:135], a[36:39], v[104:107]
    v_cvt_pk_bf16_f32 v33, v66, v67
    v_mfma_f32_16x16x32_bf16 v[104:107], a[136:139], a[40:43], v[104:107]
    v_exp_f32 v70, v70
    v_mfma_f32_16x16x32_bf16 v[104:107], a[140:143], a[44:47], v[104:107]
    buffer_load_dwordx4 v1, s[8:11], s46 offen offset:0 nt lds
    v_mfma_f32_16x16x32_bf16 v[108:111], a[156:159], a[44:47], v[20:23]
    v_exp_f32 v71, v71
    v_mfma_f32_16x16x32_bf16 v[108:111], a[152:155], a[40:43], v[108:111]
    v_cvt_pk_bf16_f32 v34, v68, v69
    v_mfma_f32_16x16x32_bf16 v[108:111], a[148:151], a[36:39], v[108:111]
    v_exp_f32 v72, v72
    v_mfma_f32_16x16x32_bf16 v[108:111], a[144:147], a[32:35], v[108:111]
    v_exp_f32 v73, v73
    v_mfma_f32_16x16x32_bf16 v[112:115], a[96:99], a[48:51], v[24:27]
    v_cvt_pk_bf16_f32 v35, v70, v71
    v_mfma_f32_16x16x32_bf16 v[112:115], a[100:103], a[52:55], v[112:115]
    v_exp_f32 v74, v74
    v_mfma_f32_16x16x32_bf16 v[112:115], a[104:107], a[56:59], v[112:115]
L_pad2:
    s_cbranch_execz L_back0
    v_exp_f32 v75, v75
    v_mfma_f32_16x16x32_bf16 v[112:115], a[108:111], a[60:63], v[112:115]
    v_cvt_pk_bf16_f32 v36, v72, v73
    v_mfma_f32_16x16x32_bf16 v[116:119], a[124:127], a[60:63], v[24:27]
    v_exp_f32 v76, v76
    v_mfma_f32_16x16x32_bf16 v[116:119], a[120:123], a[56:59], v[116:119]
    v_exp_f32 v77, v77
    v_mfma_f32_16x16x32_bf16 v[116:119], a[116:119], a[52:55], v[116:119]
    v_cvt_pk_bf16_f32 v37, v74, v75
    v_mfma_f32_16x16x32_bf16 v[116:119], a[112:115], a[48:51], v[116:119]
    s_waitcnt vmcnt(14)
    v_exp_f32 v78, v78
    v_mfma_f32_16x16x32_bf16 v[120:123], a[128:131], a[48:51], v[24:27]
    s_barrier
    v_exp_f32 v79, v79
    v_mfma_f32_16x16x32_bf16 v[120:123], a[132:135], a[52:55], v[120:123]
    v_cvt_pk_bf16_f32 v38, v76, v77
    v_mfma_f32_16x16x32_bf16 v[120:123], a[136:139], a[56:59], v[120:123]
    v_exp_f32 v80, v80
    v_mfma_f32_16x16x32_bf16 v[120:123], a[140:143], a[60:63], v[120:123]
    buffer_load_dwordx4 v1, s[8:11], s46 offen offset:1024 nt lds
    v_mfma_f32_16x16x32_bf16 v[124:127], a[156:159], a[60:63], v[24:27]
    v_exp_f32 v81, v81
    v_mfma_f32_16x16x32_bf16 v[124:127], a[152:155], a[56:59], v[124:127]
    v_cvt_pk_bf16_f32 v39, v78, v79
    v_mfma_f32_16x16x32_bf16 v[124:127], a[148:151], a[52:55], v[124:127]
    v_exp_f32 v82, v82
    v_mfma_f32_16x16x32_bf16 v[124:127], a[144:147], a[48:51], v[124:127]
    v_exp_f32 v83, v83
    v_mfma_f32_16x16x32_bf16 a[232:235], a[240:243], v[48:51], a[232:235]
    ds_read_b128 a[96:99], v2 offset:16384
    v_cvt_pk_bf16_f32 v40, v80, v81
    v_mfma_f32_16x16x32_bf16 a[232:235], a[240:243], v[52:55], a[232:235]
    v_exp_f32 v84, v84
    v_mfma_f32_16x16x32_bf16 v[192:195], a[164:167], v[52:55], v[192:195]
    ds_read_b128 a[100:103], v2 offset:16640
    ds_read_b128 a[104:107], v2 offset:16896
    v_mfma_f32_16x16x32_bf16 v[192:195], a[160:163], v[48:51], v[192:195]
    ds_read_b128 a[108:111], v2 offset:17152
    v_mfma_f32_16x16x32_bf16 v[196:199], a[168:171], v[48:51], v[196:199]
    v_exp_f32 v85, v85
    v_mfma_f32_16x16x32_bf16 v[196:199], a[172:175], v[52:55], v[196:199]
    ds_read_b128 a[112:115], v2 offset:20480
    v_mfma_f32_16x16x32_bf16 v[200:203], a[180:183], v[52:55], v[200:203]
    ds_read_b128 a[116:119], v2 offset:20736
    v_cvt_pk_bf16_f32 v41, v82, v83
    v_mfma_f32_16x16x32_bf16 v[200:203], a[176:179], v[48:51], v[200:203]
    v_exp_f32 v86, v86
    v_mfma_f32_16x16x32_bf16 v[204:207], a[184:187], v[48:51], v[204:207]
    ds_read_b128 a[120:123], v2 offset:20992
    ds_read_b128 a[124:127], v2 offset:21248
    v_mfma_f32_16x16x32_bf16 v[204:207], a[188:191], v[52:55], v[204:207]
    s_add_u32 m0, s22, 98304
    ds_read_b128 a[128:131], v2 offset:24576
    v_mfma_f32_16x16x32_bf16 v[208:211], a[196:199], v[52:55], v[208:211]
    v_exp_f32 v87, v87
    v_mfma_f32_16x16x32_bf16 v[208:211], a[192:195], v[48:51], v[208:211]
    ds_read_b128 a[132:135], v2 offset:24832
    v_cvt_pk_bf16_f32 v42, v84, v85
    v_mfma_f32_16x16x32_bf16 v[212:215], a[200:203], v[48:51], v[212:215]
    buffer_load_dwordx4 v1, s[12:15], s44 offen offset:0 nt lds
    v_mfma_f32_16x16x32_bf16 v[212:215], a[204:207], v[52:55], v[212:215]
    ds_read_b128 a[136:139], v2 offset:25088
    ds_read_b128 a[140:143], v2 offset:25344
    v_mfma_f32_16x16x32_bf16 v[216:219], a[212:215], v[52:55], v[216:219]
    ds_read_b128 a[144:147], v2 offset:28672
    v_mfma_f32_16x16x32_bf16 v[216:219], a[208:211], v[48:51], v[216:219]
    ds_read_b128 a[148:151], v2 offset:28928
    v_mfma_f32_16x16x32_bf16 v[220:223], a[216:219], v[48:51], v[220:223]
    v_exp_f32 v88, v88
    v_mfma_f32_16x16x32_bf16 v[220:223], a[220:223], v[52:55], v[220:223]
    ds_read_b128 a[152:155], v2 offset:29184
    v_cvt_pk_bf16_f32 v43, v86, v87
    v_mfma_f32_16x16x32_bf16 a[236:239], a[240:243], v[56:59], a[236:239]
    v_exp_f32 v89, v89
    v_mfma_f32_16x16x32_bf16 a[236:239], a[240:243], v[60:63], a[236:239]
    ds_read_b128 a[156:159], v2 offset:29440
    ds_read_b128 a[64:67], v7 offset:32768
    v_mfma_f32_16x16x32_bf16 v[224:227], a[164:167], v[60:63], v[224:227]
    ds_read_b128 a[68:71], v7 offset:33024
    v_mfma_f32_16x16x32_bf16 v[224:227], a[160:163], v[56:59], v[224:227]
    v_exp_f32 v90, v90
    v_mfma_f32_16x16x32_bf16 v[228:231], a[168:171], v[56:59], v[228:231]
    ds_read_b128 a[72:75], v7 offset:33280
    ds_read_b128 a[76:79], v7 offset:33536
    v_mfma_f32_16x16x32_bf16 v[228:231], a[172:175], v[60:63], v[228:231]
    ds_read_b64_tr_b16 a[160:161], v3 offset:0
    v_mfma_f32_16x16x32_bf16 v[232:235], a[180:183], v[60:63], v[232:235]
    v_exp_f32 v91, v91
    v_mfma_f32_16x16x32_bf16 v[232:235], a[176:179], v[56:59], v[232:235]
    ds_read_b64_tr_b16 a[162:163], v3 offset:4096
    v_mfma_f32_16x16x32_bf16 v[236:239], a[184:187], v[56:59], v[236:239]
    ds_read_b64_tr_b16 a[164:165], v3 offset:8192
    v_cvt_pk_bf16_f32 v44, v88, v89
    v_mfma_f32_16x16x32_bf16 v[236:239], a[188:191], v[60:63], v[236:239]
    buffer_load_dwordx4 v1, s[12:15], s44 offen offset:1024 nt lds
    v_mfma_f32_16x16x32_bf16 v[240:243], a[196:199], v[60:63], v[240:243]
    ds_read_b64_tr_b16 a[166:167], v3 offset:12288
    v_mfma_f32_16x16x32_bf16 v[240:243], a[192:195], v[56:59], v[240:243]
    v_exp_f32 v92, v92
    v_mfma_f32_16x16x32_bf16 v[244:247], a[200:203], v[56:59], v[244:247]
    ds_read_b64_tr_b16 a[168:169], v4 offset:0
    ds_read_b64_tr_b16 a[170:171], v4 offset:4096
    v_mfma_f32_16x16x32_bf16 v[244:247], a[204:207], v[60:63], v[244:247]
    v_exp_f32 v93, v93
    v_mfma_f32_16x16x32_bf16 v[248:251], a[212:215], v[60:63], v[248:251]
    ds_read_b64_tr_b16 a[172:173], v4 offset:8192
    v_mfma_f32_16x16x32_bf16 v[248:251], a[208:211], v[56:59], v[248:251]
    ds_read_b64_tr_b16 a[174:175], v4 offset:12288
    v_cvt_pk_bf16_f32 v45, v90, v91
    v_mfma_f32_16x16x32_bf16 v[252:255], a[216:219], v[56:59], v[252:255]
    v_exp_f32 v94, v94
    v_mfma_f32_16x16x32_bf16 v[252:255], a[220:223], v[60:63], v[252:255]
    s_waitcnt vmcnt(13) lgkmcnt(8)
L_n9:
    v_mfma_f32_16x16x32_bf16 v[64:67], a[96:99], a[0:3], v[12:15]
    v_exp_f32 v95, v95
    v_mfma_f32_16x16x32_bf16 v[64:67], a[100:103], a[4:7], v[64:67]
    ds_read_b64_tr_b16 a[176:177], v3 offset:256
    ds_read_b64_tr_b16 a[178:179], v3 offset:4352
    v_mfma_f32_16x16x32_bf16 v[64:67], a[104:107], a[8:11], v[64:67]
    ds_read_b64_tr_b16 a[180:181], v3 offset:8448
    v_cvt_pk_bf16_f32 v46, v92, v93
    v_mfma_f32_16x16x32_bf16 v[64:67], a[108:111], a[12:15], v[64:67]
    ds_read_b64_tr_b16 a[182:183], v3 offset:12544
    v_cvt_pk_bf16_f32 v47, v94, v95
    v_mfma_f32_16x16x32_bf16 v[68:71], a[124:127], a[12:15], v[12:15]
    v_exp_f32 v96, v96
    v_mfma_f32_16x16x32_bf16 v[68:71], a[120:123], a[8:11], v[68:71]
    ds_read_b64_tr_b16 a[184:185], v4 offset:256
    v_mfma_f32_16x16x32_bf16 v[68:71], a[116:119], a[4:7], v[68:71]
    s_add_u32 m0, s22, 57344
    ds_read_b64_tr_b16 a[186:187], v4 offset:4352
    ds_read_b64_tr_b16 a[188:189], v4 offset:8448
    v_mfma_f32_16x16x32_bf16 v[68:71], a[112:115], a[0:3], v[68:71]
    buffer_load_dwordx4 v1, s[8:11], s47 offen offset:0 nt lds
    v_mfma_f32_16x16x32_bf16 v[72:75], a[128:131], a[0:3], v[12:15]
    ds_read_b64_tr_b16 a[190:191], v4 offset:12544
    ds_read_b64_tr_b16 a[192:193], v3 offset:512
    v_mfma_f32_16x16x32_bf16 v[72:75], a[132:135], a[4:7], v[72:75]
    v_exp_f32 v97, v97
    v_mfma_f32_16x16x32_bf16 v[72:75], a[136:139], a[8:11], v[72:75]
    ds_read_b64_tr_b16 a[194:195], v3 offset:4608
    ds_read_b64_tr_b16 a[196:197], v3 offset:8704
    v_mfma_f32_16x16x32_bf16 v[72:75], a[140:143], a[12:15], v[72:75]
    v_exp_f32 v98, v98
    v_mfma_f32_16x16x32_bf16 v[76:79], a[156:159], a[12:15], v[12:15]
    ds_read_b64_tr_b16 a[198:199], v3 offset:12800
    v_cvt_pk_bf16_f32 v48, v96, v97
    v_mfma_f32_16x16x32_bf16 v[76:79], a[152:155], a[8:11], v[76:79]
    v_exp_f32 v99, v99
    v_mfma_f32_16x16x32_bf16 v[76:79], a[148:151], a[4:7], v[76:79]
    ds_read_b64_tr_b16 a[200:201], v4 offset:512
    ds_read_b64_tr_b16 a[202:203], v4 offset:4608
    v_mfma_f32_16x16x32_bf16 v[76:79], a[144:147], a[0:3], v[76:79]
    buffer_load_dwordx4 v1, s[8:11], s47 offen offset:1024 nt lds
    v_mfma_f32_16x16x32_bf16 v[80:83], a[96:99], a[16:19], v[16:19]
    ds_read_b64_tr_b16 a[204:205], v4 offset:8704
    ds_read_b64_tr_b16 a[206:207], v4 offset:12800
    v_mfma_f32_16x16x32_bf16 v[80:83], a[100:103], a[20:23], v[80:83]
    ds_read_b64_tr_b16 a[208:209], v3 offset:768
    v_mfma_f32_16x16x32_bf16 v[80:83], a[104:107], a[24:27], v[80:83]
    v_exp_f32 v100, v100
    v_mfma_f32_16x16x32_bf16 v[80:83], a[108:111], a[28:31], v[80:83]
    ds_read_b64_tr_b16 a[210:211], v3 offset:4864
    ds_read_b64_tr_b16 a[212:213], v3 offset:8960
    v_mfma_f32_16x16x32_bf16 v[84:87], a[124:127], a[28:31], v[16:19]
    v_exp_f32 v101, v101
    v_mfma_f32_16x16x32_bf16 v[84:87], a[120:123], a[24:27], v[84:87]
    ds_read_b64_tr_b16 a[214:215], v3 offset:13056
    v_cvt_pk_bf16_f32 v49, v98, v99
    v_mfma_f32_16x16x32_bf16 v[84:87], a[116:119], a[20:23], v[84:87]
    s_add_u32 m0, s22, 106496
    ds_read_b64_tr_b16 a[216:217], v4 offset:768
    ds_read_b64_tr_b16 a[218:219], v4 offset:4864
    v_mfma_f32_16x16x32_bf16 v[84:87], a[112:115], a[16:19], v[84:87]
    buffer_load_dwordx4 v1, s[12:15], s45 offen offset:0 nt lds
    v_mfma_f32_16x16x32_bf16 v[88:91], a[128:131], a[16:19], v[16:19]
    ds_read_b64_tr_b16 a[220:221], v4 offset:8960
    ds_read_b64_tr_b16 a[222:223], v4 offset:13056
    v_mfma_f32_16x16x32_bf16 v[88:91], a[132:135], a[20:23], v[88:91]
    v_mfma_f32_16x16x32_bf16 v[88:91], a[136:139], a[24:27], v[88:91]
    v_exp_f32 v102, v102
    v_mfma_f32_16x16x32_bf16 v[88:91], a[140:143], a[28:31], v[88:91]
    v_exp_f32 v103, v103
    v_mfma_f32_16x16x32_bf16 v[92:95], a[156:159], a[28:31], v[16:19]
    v_cvt_pk_bf16_f32 v50, v100, v101
    v_mfma_f32_16x16x32_bf16 v[92:95], a[152:155], a[24:27], v[92:95]
    v_exp_f32 v104, v104
    v_mfma_f32_16x16x32_bf16 v[92:95], a[148:151], a[20:23], v[92:95]
    v_exp_f32 v105, v105
    v_mfma_f32_16x16x32_bf16 v[92:95], a[144:147], a[16:19], v[92:95]
    s_waitcnt lgkmcnt(0)
    buffer_load_dwordx4 v1, s[12:15], s45 offen offset:1024 nt lds
    v_mfma_f32_16x16x32_bf16 a[224:227], a[240:243], v[32:35], a[224:227]
    ds_read_b128 a[80:83], v7 offset:36864
    v_cvt_pk_bf16_f32 v51, v102, v103
    v_mfma_f32_16x16x32_bf16 a[224:227], a[240:243], v[36:39], a[224:227]
    v_exp_f32 v106, v106
    v_mfma_f32_16x16x32_bf16 v[128:131], a[164:167], v[36:39], v[128:131]
    v_exp_f32 v107, v107
    v_mfma_f32_16x16x32_bf16 v[128:131], a[160:163], v[32:35], v[128:131]
    v_cvt_pk_bf16_f32 v52, v104, v105
    v_mfma_f32_16x16x32_bf16 v[132:135], a[168:171], v[32:35], v[132:135]
    s_add_u32 m0, s26, 131072
    v_exp_f32 v108, v108
    v_mfma_f32_16x16x32_bf16 v[132:135], a[172:175], v[36:39], v[132:135]
    s_xor_b32 s27, s25, 8192
    v_exp_f32 v109, v109
    v_mfma_f32_16x16x32_bf16 v[136:139], a[180:183], v[36:39], v[136:139]
    ds_read_b128 a[84:87], v7 offset:37120
    v_cvt_pk_bf16_f32 v53, v106, v107
    v_mfma_f32_16x16x32_bf16 v[136:139], a[176:179], v[32:35], v[136:139]
    buffer_load_dwordx4 v5, s[4:7], s27 offen offset:0 nt lds
    v_mfma_f32_16x16x32_bf16 v[140:143], a[184:187], v[32:35], v[140:143]
    v_exp_f32 v110, v110
    v_mfma_f32_16x16x32_bf16 v[140:143], a[188:191], v[36:39], v[140:143]
    v_exp_f32 v111, v111
    v_mfma_f32_16x16x32_bf16 v[144:147], a[196:199], v[36:39], v[144:147]
    v_cvt_pk_bf16_f32 v54, v108, v109
    v_mfma_f32_16x16x32_bf16 v[144:147], a[192:195], v[32:35], v[144:147]
    v_exp_f32 v112, v112
    v_mfma_f32_16x16x32_bf16 v[148:151], a[200:203], v[32:35], v[148:151]
    v_exp_f32 v113, v113
    v_mfma_f32_16x16x32_bf16 v[148:151], a[204:207], v[36:39], v[148:151]
    ds_read_b128 a[88:91], v7 offset:37376
    v_cvt_pk_bf16_f32 v55, v110, v111
    v_mfma_f32_16x16x32_bf16 v[152:155], a[212:215], v[36:39], v[152:155]
    v_exp_f32 v114, v114
    v_mfma_f32_16x16x32_bf16 v[152:155], a[208:211], v[32:35], v[152:155]
    buffer_load_dwordx4 v5, s[4:7], s27 offen offset:1024 nt lds
    v_mfma_f32_16x16x32_bf16 v[156:159], a[216:219], v[32:35], v[156:159]
    v_exp_f32 v115, v115
    v_mfma_f32_16x16x32_bf16 v[156:159], a[220:223], v[36:39], v[156:159]
    v_cvt_pk_bf16_f32 v56, v112, v113
    v_mfma_f32_16x16x32_bf16 a[228:231], a[240:243], v[40:43], a[228:231]
    v_exp_f32 v116, v116
    v_mfma_f32_16x16x32_bf16 a[228:231], a[240:243], v[44:47], a[228:231]
    ds_read_b128 a[92:95], v7 offset:37632
    v_cvt_pk_bf16_f32 v57, v114, v115
    v_mfma_f32_16x16x32_bf16 v[160:163], a[164:167], v[44:47], v[160:163]
    v_exp_f32 v117, v117
    v_mfma_f32_16x16x32_bf16 v[160:163], a[160:163], v[40:43], v[160:163]
    v_exp_f32 v118, v118
    v_mfma_f32_16x16x32_bf16 v[164:167], a[168:171], v[40:43], v[164:167]
    v_exp_f32 v119, v119
    v_mfma_f32_16x16x32_bf16 v[164:167], a[172:175], v[44:47], v[164:167]
    buffer_load_dwordx4 v6, s[4:7], s27 offen offset:2048 nt lds
    v_mfma_f32_16x16x32_bf16 v[168:171], a[180:183], v[44:47], v[168:171]
    v_cvt_pk_bf16_f32 v58, v116, v117
    v_mfma_f32_16x16x32_bf16 v[168:171], a[176:179], v[40:43], v[168:171]
    v_exp_f32 v120, v120
    v_mfma_f32_16x16x32_bf16 v[172:175], a[184:187], v[40:43], v[172:175]
    v_exp_f32 v121, v121
    v_mfma_f32_16x16x32_bf16 v[172:175], a[188:191], v[44:47], v[172:175]
    v_cvt_pk_bf16_f32 v59, v118, v119
    v_mfma_f32_16x16x32_bf16 v[176:179], a[196:199], v[44:47], v[176:179]
    v_exp_f32 v122, v122
    v_mfma_f32_16x16x32_bf16 v[176:179], a[192:195], v[40:43], v[176:179]
    v_exp_f32 v123, v123
    v_mfma_f32_16x16x32_bf16 v[180:183], a[200:203], v[40:43], v[180:183]
    buffer_load_dwordx4 v6, s[4:7], s27 offen offset:3072 nt lds
    v_mfma_f32_16x16x32_bf16 v[180:183], a[204:207], v[44:47], v[180:183]
    v_cvt_pk_bf16_f32 v60, v120, v121
    v_mfma_f32_16x16x32_bf16 v[184:187], a[212:215], v[44:47], v[184:187]
    v_exp_f32 v124, v124
    v_mfma_f32_16x16x32_bf16 v[184:187], a[208:211], v[40:43], v[184:187]
    v_exp_f32 v125, v125
    v_mfma_f32_16x16x32_bf16 v[188:191], a[216:219], v[40:43], v[188:191]
    v_cvt_pk_bf16_f32 v61, v122, v123
    v_mfma_f32_16x16x32_bf16 v[188:191], a[220:223], v[44:47], v[188:191]
    s_waitcnt lgkmcnt(0)
    v_exp_f32 v126, v126
L_n10:
    v_mfma_f32_16x16x32_bf16 v[96:99], a[96:99], a[32:35], v[20:23]
    v_exp_f32 v127, v127
    v_mfma_f32_16x16x32_bf16 v[96:99], a[100:103], a[36:39], v[96:99]
    v_cvt_pk_bf16_f32 v62, v124, v125
    v_cvt_pk_bf16_f32 v63, v126, v127
    v_mfma_f32_16x16x32_bf16 v[96:99], a[104:107], a[40:43], v[96:99]
    v_exp_f32 v64, v64
    v_mfma_f32_16x16x32_bf16 v[96:99], a[108:111], a[44:47], v[96:99]
    v_exp_f32 v65, v65
    v_mfma_f32_16x16x32_bf16 v[100:103], a[124:127], a[44:47], v[20:23]
    s_add_u32 m0, s22, 0
    v_exp_f32 v66, v66
    v_mfma_f32_16x16x32_bf16 v[100:103], a[120:123], a[40:43], v[100:103]
    v_exp_f32 v67, v67
    v_mfma_f32_16x16x32_bf16 v[100:103], a[116:119], a[36:39], v[100:103]
    buffer_load_dwordx4 v1, s[8:11], s48 offen offset:0 nt lds
    v_mfma_f32_16x16x32_bf16 v[100:103], a[112:115], a[32:35], v[100:103]
    v_cvt_pk_bf16_f32 v32, v64, v65
    v_mfma_f32_16x16x32_bf16 v[104:107], a[128:131], a[32:35], v[20:23]
    v_exp_f32 v68, v68
    v_mfma_f32_16x16x32_bf16 v[104:107], a[132:135], a[36:39], v[104:107]
    v_exp_f32 v69, v69
    v_mfma_f32_16x16x32_bf16 v[104:107], a[136:139], a[40:43], v[104:107]
    v_cvt_pk_bf16_f32 v33, v66, v67
    v_mfma_f32_16x16x32_bf16 v[104:107], a[140:143], a[44:47], v[104:107]
    v_exp_f32 v70, v70
    v_mfma_f32_16x16x32_bf16 v[108:111], a[156:159], a[44:47], v[20:23]
    v_exp_f32 v71, v71
    v_mfma_f32_16x16x32_bf16 v[108:111], a[152:155], a[40:43], v[108:111]
    v_cvt_pk_bf16_f32 v34, v68, v69
    v_mfma_f32_16x16x32_bf16 v[108:111], a[148:151], a[36:39], v[108:111]
    v_exp_f32 v72, v72
    v_mfma_f32_16x16x32_bf16 v[108:111], a[144:147], a[32:35], v[108:111]
    buffer_load_dwordx4 v1, s[8:11], s48 offen offset:1024 nt lds
    v_mfma_f32_16x16x32_bf16 v[112:115], a[96:99], a[48:51], v[24:27]
    v_exp_f32 v73, v73
    v_mfma_f32_16x16x32_bf16 v[112:115], a[100:103], a[52:55], v[112:115]
    v_cvt_pk_bf16_f32 v35, v70, v71
    v_mfma_f32_16x16x32_bf16 v[112:115], a[104:107], a[56:59], v[112:115]
    v_exp_f32 v74, v74
    v_mfma_f32_16x16x32_bf16 v[112:115], a[108:111], a[60:63], v[112:115]
    v_exp_f32 v75, v75
    v_mfma_f32_16x16x32_bf16 v[116:119], a[124:127], a[60:63], v[24:27]
    s_add_u32 m0, s22, 114688
    v_cvt_pk_bf16_f32 v36, v72, v73
    v_mfma_f32_16x16x32_bf16 v[116:119], a[120:123], a[56:59], v[116:119]
    v_exp_f32 v76, v76
    v_mfma_f32_16x16x32_bf16 v[116:119], a[116:119], a[52:55], v[116:119]
    v_exp_f32 v77, v77
    v_mfma_f32_16x16x32_bf16 v[116:119], a[112:115], a[48:51], v[116:119]
    buffer_load_dwordx4 v1, s[12:15], s46 offen offset:0 nt lds
    v_mfma_f32_16x16x32_bf16 v[120:123], a[128:131], a[48:51], v[24:27]
    s_waitcnt vmcnt(16)
    v_cvt_pk_bf16_f32 v37, v74, v75
    v_mfma_f32_16x16x32_bf16 v[120:123], a[132:135], a[52:55], v[120:123]
    s_barrier
    v_exp_f32 v78, v78
    v_mfma_f32_16x16x32_bf16 v[120:123], a[136:139], a[56:59], v[120:123]
    v_exp_f32 v79, v79
    v_mfma_f32_16x16x32_bf16 v[120:123], a[140:143], a[60:63], v[120:123]
    v_cvt_pk_bf16_f32 v38, v76, v77
    v_mfma_f32_16x16x32_bf16 v[124:127], a[156:159], a[60:63], v[24:27]
    v_exp_f32 v80, v80
    v_mfma_f32_16x16x32_bf16 v[124:127], a[152:155], a[56:59], v[124:127]
    v_exp_f32 v81, v81
    v_mfma_f32_16x16x32_bf16 v[124:127], a[148:151], a[52:55], v[124:127]
    buffer_load_dwordx4 v1, s[12:15], s46 offen offset:1024 nt lds
    v_mfma_f32_16x16x32_bf16 v[124:127], a[144:147], a[48:51], v[124:127]
    v_cvt_pk_bf16_f32 v39, v78, v79
    v_mfma_f32_16x16x32_bf16 a[232:235], a[240:243], v[48:51], a[232:235]
    v_exp_f32 v82, v82
    v_mfma_f32_16x16x32_bf16 a[232:235], a[240:243], v[52:55], a[232:235]
    ds_read_b128 a[96:99], v2 offset:32768
    ds_read_b128 a[100:103], v2 offset:33024
    v_mfma_f32_16x16x32_bf16 v[192:195], a[164:167], v[52:55], v[192:195]
    v_exp_f32 v83, v83
    v_mfma_f32_16x16x32_bf16 v[192:195], a[160:163], v[48:51], v[192:195]
    ds_read_b128 a[104:107], v2 offset:33280
    v_cvt_pk_bf16_f32 v40, v80, v81
    v_mfma_f32_16x16x32_bf16 v[196:199], a[168:171], v[48:51], v[196:199]
    v_exp_f32 v84, v84
    v_mfma_f32_16x16x32_bf16 v[196:199], a[172:175], v[52:55], v[196:199]
    ds_read_b128 a[108:111], v2 offset:33536
    v_cvt_pk_bf16_f32 v41, v82, v83
    v_mfma_f32_16x16x32_bf16 v[200:203], a[180:183], v[52:55], v[200:203]
    s_add_u32 m0, s26, 135168
    v_exp_f32 v85, v85
    v_mfma_f32_16x16x32_bf16 v[200:203], a[176:179], v[48:51], v[200:203]
    s_xor_b32 s27, s25, 12288
    ds_read_b128 a[112:115], v2 offset:36864
    v_mfma_f32_16x16x32_bf16 v[204:207], a[184:187], v[48:51], v[204:207]
    buffer_load_dwordx4 v5, s[4:7], s27 offen offset:0 nt lds
    v_mfma_f32_16x16x32_bf16 v[204:207], a[188:191], v[52:55], v[204:207]
    ds_read_b128 a[116:119], v2 offset:37120
    ds_read_b128 a[120:123], v2 offset:37376
    v_mfma_f32_16x16x32_bf16 v[208:211], a[196:199], v[52:55], v[208:211]
    v_exp_f32 v86, v86
    v_mfma_f32_16x16x32_bf16 v[208:211], a[192:195], v[48:51], v[208:211]
    ds_read_b128 a[124:127], v2 offset:37632
    v_cvt_pk_bf16_f32 v42, v84, v85
    v_mfma_f32_16x16x32_bf16 v[212:215], a[200:203], v[48:51], v[212:215]
    v_exp_f32 v87, v87
    v_mfma_f32_16x16x32_bf16 v[212:215], a[204:207], v[52:55], v[212:215]
    ds_read_b128 a[128:131], v2 offset:40960
    ds_read_b128 a[132:135], v2 offset:41216
    v_mfma_f32_16x16x32_bf16 v[216:219], a[212:215], v[52:55], v[216:219]
    buffer_load_dwordx4 v5, s[4:7], s27 offen offset:1024 nt lds
    v_mfma_f32_16x16x32_bf16 v[216:219], a[208:211], v[48:51], v[216:219]
    ds_read_b128 a[136:139], v2 offset:41472
    v_mfma_f32_16x16x32_bf16 v[220:223], a[216:219], v[48:51], v[220:223]
    v_exp_f32 v88, v88
    v_mfma_f32_16x16x32_bf16 v[220:223], a[220:223], v[52:55], v[220:223]
    ds_read_b128 a[140:143], v2 offset:41728
    v_cvt_pk_bf16_f32 v43, v86, v87
    v_mfma_f32_16x16x32_bf16 a[236:239], a[240:243], v[56:59], a[236:239]
    v_exp_f32 v89, v89
    v_mfma_f32_16x16x32_bf16 a[236:239], a[240:243], v[60:63], a[236:239]
    ds_read_b128 a[144:147], v2 offset:45056
    ds_read_b128 a[148:151], v2 offset:45312
    v_mfma_f32_16x16x32_bf16 v[224:227], a[164:167], v[60:63], v[224:227]
    v_mfma_f32_16x16x32_bf16 v[224:227], a[160:163], v[56:59], v[224:227]
    v_exp_f32 v90, v90
    v_mfma_f32_16x16x32_bf16 v[228:231], a[168:171], v[56:59], v[228:231]
    ds_read_b128 a[152:155], v2 offset:45568
    ds_read_b128 a[156:159], v2 offset:45824
    v_mfma_f32_16x16x32_bf16 v[228:231], a[172:175], v[60:63], v[228:231]
    buffer_load_dwordx4 v6, s[4:7], s27 offen offset:2048 nt lds
    v_mfma_f32_16x16x32_bf16 v[232:235], a[180:183], v[60:63], v[232:235]
    ds_read_b64_tr_b16 a[160:161], v3 offset:16384
    ds_read_b64_tr_b16 a[162:163], v3 offset:20480
    v_mfma_f32_16x16x32_bf16 v[232:235], a[176:179], v[56:59], v[232:235]
    v_exp_f32 v91, v91
    v_mfma_f32_16x16x32_bf16 v[236:239], a[184:187], v[56:59], v[236:239]
    ds_read_b64_tr_b16 a[164:165], v3 offset:24576
    v_cvt_pk_bf16_f32 v44, v88, v89
    v_mfma_f32_16x16x32_bf16 v[236:239], a[188:191], v[60:63], v[236:239]
    ds_read_b64_tr_b16 a[166:167], v3 offset:28672
    v_mfma_f32_16x16x32_bf16 v[240:243], a[196:199], v[60:63], v[240:243]
    v_exp_f32 v92, v92
    v_mfma_f32_16x16x32_bf16 v[240:243], a[192:195], v[56:59], v[240:243]
    v_exp_f32 v93, v93
    v_mfma_f32_16x16x32_bf16 v[244:247], a[200:203], v[56:59], v[244:247]
    ds_read_b64_tr_b16 a[168:169], v4 offset:16384
    ds_read_b64_tr_b16 a[170:171], v4 offset:20480
    v_mfma_f32_16x16x32_bf16 v[244:247], a[204:207], v[60:63], v[244:247]
    buffer_load_dwordx4 v6, s[4:7], s27 offen offset:3072 nt lds
    v_mfma_f32_16x16x32_bf16 v[248:251], a[212:215], v[60:63], v[248:251]
    ds_read_b64_tr_b16 a[172:173], v4 offset:24576
    v_mfma_f32_16x16x32_bf16 v[248:251], a[208:211], v[56:59], v[248:251]
    ds_read_b64_tr_b16 a[174:175], v4 offset:28672
    v_cvt_pk_bf16_f32 v45, v90, v91
    v_mfma_f32_16x16x32_bf16 v[252:255], a[216:219], v[56:59], v[252:255]
    v_exp_f32 v94, v94
    v_mfma_f32_16x16x32_bf16 v[252:255], a[220:223], v[60:63], v[252:255]
    s_waitcnt lgkmcnt(8)
L_n11:
    v_mfma_f32_16x16x32_bf16 v[64:67], a[96:99], a[0:3], v[12:15]
    v_exp_f32 v95, v95
    v_mfma_f32_16x16x32_bf16 v[64:67], a[100:103], a[4:7], v[64:67]
    ds_read_b64_tr_b16 a[176:177], v3 offset:16640
    ds_read_b64_tr_b16 a[178:179], v3 offset:20736
    v_mfma_f32_16x16x32_bf16 v[64:67], a[104:107], a[8:11], v[64:67]
    ds_read_b64_tr_b16 a[180:181], v3 offset:24832
    v_cvt_pk_bf16_f32 v46, v92, v93
    v_mfma_f32_16x16x32_bf16 v[64:67], a[108:111], a[12:15], v[64:67]
    ds_read_b64_tr_b16 a[182:183], v3 offset:28928
    v_cvt_pk_bf16_f32 v47, v94, v95
    v_mfma_f32_16x16x32_bf16 v[68:71], a[124:127], a[12:15], v[12:15]
    v_exp_f32 v96, v96
    v_mfma_f32_16x16x32_bf16 v[68:71], a[120:123], a[8:11], v[68:71]
    ds_read_b64_tr_b16 a[184:185], v4 offset:16640
    ds_read_b64_tr_b16 a[186:187], v4 offset:20736
    v_mfma_f32_16x16x32_bf16 v[68:71], a[116:119], a[4:7], v[68:71]
    ds_read_b64_tr_b16 a[188:189], v4 offset:24832
    v_mfma_f32_16x16x32_bf16 v[68:71], a[112:115], a[0:3], v[68:71]
    v_exp_f32 v97, v97
    v_mfma_f32_16x16x32_bf16 v[72:75], a[128:131], a[0:3], v[12:15]
    ds_read_b64_tr_b16 a[190:191], v4 offset:28928
    ds_read_b64_tr_b16 a[192:193], v3 offset:16896
    v_mfma_f32_16x16x32_bf16 v[72:75], a[132:135], a[4:7], v[72:75]
    s_add_u32 m0, s22, 8192
    ds_read_b64_tr_b16 a[194:195], v3 offset:20992
    v_mfma_f32_16x16x32_bf16 v[72:75], a[136:139], a[8:11], v[72:75]
    v_exp_f32 v98, v98
    v_mfma_f32_16x16x32_bf16 v[72:75], a[140:143], a[12:15], v[72:75]
    ds_read_b64_tr_b16 a[196:197], v3 offset:25088
    v_mfma_f32_16x16x32_bf16 v[76:79], a[156:159], a[12:15], v[12:15]
    buffer_load_dwordx4 v1, s[8:11], s49 offen offset:0 nt lds
    v_mfma_f32_16x16x32_bf16 v[76:79], a[152:155], a[8:11], v[76:79]
    ds_read_b64_tr_b16 a[198:199], v3 offset:29184
    ds_read_b64_tr_b16 a[200:201], v4 offset:16896
    v_mfma_f32_16x16x32_bf16 v[76:79], a[148:151], a[4:7], v[76:79]
    ds_read_b64_tr_b16 a[202:203], v4 offset:20992
    v_mfma_f32_16x16x32_bf16 v[76:79], a[144:147], a[0:3], v[76:79]
    v_exp_f32 v99, v99
    v_mfma_f32_16x16x32_bf16 v[80:83], a[96:99], a[16:19], v[16:19]
    ds_read_b64_tr_b16 a[204:205], v4 offset:25088
    ds_read_b64_tr_b16 a[206:207], v4 offset:29184
    v_mfma_f32_16x16x32_bf16 v[80:83], a[100:103], a[20:23], v[80:83]
    ds_read_b64_tr_b16 a[208:209], v3 offset:17152
    v_mfma_f32_16x16x32_bf16 v[80:83], a[104:107], a[24:27], v[80:83]
    ds_read_b64_tr_b16 a[210:211], v3 offset:21248
    v_cvt_pk_bf16_f32 v48, v96, v97
    v_mfma_f32_16x16x32_bf16 v[80:83], a[108:111], a[28:31], v[80:83]
    ds_read_b64_tr_b16 a[212:213], v3 offset:25344
    v_mfma_f32_16x16x32_bf16 v[84:87], a[124:127], a[28:31], v[16:19]
    v_exp_f32 v100, v100
    v_mfma_f32_16x16x32_bf16 v[84:87], a[120:123], a[24:27], v[84:87]
    ds_read_b64_tr_b16 a[214:215], v3 offset:29440
    ds_read_b64_tr_b16 a[216:217], v4 offset:17152
    v_mfma_f32_16x16x32_bf16 v[84:87], a[116:119], a[20:23], v[84:87]
    ds_read_b64_tr_b16 a[218:219], v4 offset:21248
    v_mfma_f32_16x16x32_bf16 v[84:87], a[112:115], a[16:19], v[84:87]
    v_exp_f32 v101, v101
    v_mfma_f32_16x16x32_bf16 v[88:91], a[128:131], a[16:19], v[16:19]
    ds_read_b64_tr_b16 a[220:221], v4 offset:25344
    ds_read_b64_tr_b16 a[222:223], v4 offset:29440
    v_mfma_f32_16x16x32_bf16 v[88:91], a[132:135], a[20:23], v[88:91]
    v_cvt_pk_bf16_f32 v49, v98, v99
    v_mfma_f32_16x16x32_bf16 v[88:91], a[136:139], a[24:27], v[88:91]
    v_exp_f32 v102, v102
    v_mfma_f32_16x16x32_bf16 v[88:91], a[140:143], a[28:31], v[88:91]
    buffer_load_dwordx4 v1, s[8:11], s49 offen offset:1024 nt lds
    v_mfma_f32_16x16x32_bf16 v[92:95], a[156:159], a[28:31], v[16:19]
    v_cvt_pk_bf16_f32 v50, v100, v101
    v_mfma_f32_16x16x32_bf16 v[92:95], a[152:155], a[24:27], v[92:95]
    v_exp_f32 v103, v103
    v_mfma_f32_16x16x32_bf16 v[92:95], a[148:151], a[20:23], v[92:95]
    v_exp_f32 v104, v104
    v_mfma_f32_16x16x32_bf16 v[92:95], a[144:147], a[16:19], v[92:95]
    s_waitcnt lgkmcnt(0)
    v_cvt_pk_bf16_f32 v51, v102, v103
    v_mfma_f32_16x16x32_bf16 a[224:227], a[240:243], v[32:35], a[224:227]
    v_exp_f32 v105, v105
    v_mfma_f32_16x16x32_bf16 a[224:227], a[240:243], v[36:39], a[224:227]
    v_exp_f32 v106, v106
    v_mfma_f32_16x16x32_bf16 v[128:131], a[164:167], v[36:39], v[128:131]
    v_cvt_pk_bf16_f32 v52, v104, v105
    v_mfma_f32_16x16x32_bf16 v[128:131], a[160:163], v[32:35], v[128:131]
    v_exp_f32 v107, v107
    v_mfma_f32_16x16x32_bf16 v[132:135], a[168:171], v[32:35], v[132:135]
    v_mfma_f32_16x16x32_bf16 v[132:135], a[172:175], v[36:39], v[132:135]
    v_exp_f32 v108, v108
    v_mfma_f32_16x16x32_bf16 v[136:139], a[180:183], v[36:39], v[136:139]
    v_exp_f32 v109, v109
    v_mfma_f32_16x16x32_bf16 v[136:139], a[176:179], v[32:35], v[136:139]
    v_cvt_pk_bf16_f32 v53, v106, v107
    v_mfma_f32_16x16x32_bf16 v[140:143], a[184:187], v[32:35], v[140:143]
    s_add_u32 m0, s22, 122880
    v_exp_f32 v110, v110
    v_mfma_f32_16x16x32_bf16 v[140:143], a[188:191], v[36:39], v[140:143]
    v_exp_f32 v111, v111
    v_mfma_f32_16x16x32_bf16 v[144:147], a[196:199], v[36:39], v[144:147]
    buffer_load_dwordx4 v1, s[12:15], s47 offen offset:0 nt lds
    v_mfma_f32_16x16x32_bf16 v[144:147], a[192:195], v[32:35], v[144:147]
    v_cvt_pk_bf16_f32 v54, v108, v109
    v_mfma_f32_16x16x32_bf16 v[148:151], a[200:203], v[32:35], v[148:151]
    v_exp_f32 v112, v112
    v_mfma_f32_16x16x32_bf16 v[148:151], a[204:207], v[36:39], v[148:151]
    v_exp_f32 v113, v113
    v_mfma_f32_16x16x32_bf16 v[152:155], a[212:215], v[36:39], v[152:155]
    v_cvt_pk_bf16_f32 v55, v110, v111
    v_mfma_f32_16x16x32_bf16 v[152:155], a[208:211], v[32:35], v[152:155]
    v_exp_f32 v114, v114
    v_mfma_f32_16x16x32_bf16 v[156:159], a[216:219], v[32:35], v[156:159]
    v_exp_f32 v115, v115
    v_mfma_f32_16x16x32_bf16 v[156:159], a[220:223], v[36:39], v[156:159]
    v_cvt_pk_bf16_f32 v56, v112, v113
    v_mfma_f32_16x16x32_bf16 a[228:231], a[240:243], v[40:43], a[228:231]
    v_exp_f32 v116, v116
    v_mfma_f32_16x16x32_bf16 a[228:231], a[240:243], v[44:47], a[228:231]
    v_exp_f32 v117, v117
    v_mfma_f32_16x16x32_bf16 v[160:163], a[164:167], v[44:47], v[160:163]
    v_cvt_pk_bf16_f32 v57, v114, v115
    v_mfma_f32_16x16x32_bf16 v[160:163], a[160:163], v[40:43], v[160:163]
    v_exp_f32 v118, v118
    v_mfma_f32_16x16x32_bf16 v[164:167], a[168:171], v[40:43], v[164:167]
    v_exp_f32 v119, v119
    v_mfma_f32_16x16x32_bf16 v[164:167], a[172:175], v[44:47], v[164:167]
    v_cvt_pk_bf16_f32 v58, v116, v117
    v_mfma_f32_16x16x32_bf16 v[168:171], a[180:183], v[44:47], v[168:171]
    v_exp_f32 v120, v120
    v_mfma_f32_16x16x32_bf16 v[168:171], a[176:179], v[40:43], v[168:171]
    v_exp_f32 v121, v121
    v_mfma_f32_16x16x32_bf16 v[172:175], a[184:187], v[40:43], v[172:175]
    buffer_load_dwordx4 v1, s[12:15], s47 offen offset:1024 nt lds
    v_mfma_f32_16x16x32_bf16 v[172:175], a[188:191], v[44:47], v[172:175]
    v_cvt_pk_bf16_f32 v59, v118, v119
    v_mfma_f32_16x16x32_bf16 v[176:179], a[196:199], v[44:47], v[176:179]
    v_exp_f32 v122, v122
    v_mfma_f32_16x16x32_bf16 v[176:179], a[192:195], v[40:43], v[176:179]
    v_exp_f32 v123, v123
    v_mfma_f32_16x16x32_bf16 v[180:183], a[200:203], v[40:43], v[180:183]
    v_cvt_pk_bf16_f32 v60, v120, v121
    v_mfma_f32_16x16x32_bf16 v[180:183], a[204:207], v[44:47], v[180:183]
    v_exp_f32 v124, v124
    v_mfma_f32_16x16x32_bf16 v[184:187], a[212:215], v[44:47], v[184:187]
    v_exp_f32 v125, v125
    v_mfma_f32_16x16x32_bf16 v[184:187], a[208:211], v[40:43], v[184:187]
    v_cvt_pk_bf16_f32 v61, v122, v123
    v_mfma_f32_16x16x32_bf16 v[188:191], a[216:219], v[40:43], v[188:191]
    v_exp_f32 v126, v126
    v_mfma_f32_16x16x32_bf16 v[188:191], a[220:223], v[44:47], v[188:191]
L_n12:
    v_mfma_f32_16x16x32_bf16 v[96:99], a[96:99], a[32:35], v[20:23]
L_pad3:
    s_cbranch_execz L_back0
    v_exp_f32 v127, v127
    v_mfma_f32_16x16x32_bf16 v[96:99], a[100:103], a[36:39], v[96:99]
    v_cvt_pk_bf16_f32 v62, v124, v125
    v_cvt_pk_bf16_f32 v63, v126, v127
    v_mfma_f32_16x16x32_bf16 v[96:99], a[104:107], a[40:43], v[96:99]
    v_exp_f32 v64, v64
    v_mfma_f32_16x16x32_bf16 v[96:99], a[108:111], a[44:47], v[96:99]
    v_exp_f32 v65, v65
    v_mfma_f32_16x16x32_bf16 v[100:103], a[124:127], a[44:47], v[20:23]
    v_exp_f32 v66, v66
    v_mfma_f32_16x16x32_bf16 v[100:103], a[120:123], a[40:43], v[100:103]
    v_cvt_pk_bf16_f32 v32, v64, v65
    v_mfma_f32_16x16x32_bf16 v[100:103], a[116:119], a[36:39], v[100:103]
    v_exp_f32 v67, v67
    v_mfma_f32_16x16x32_bf16 v[100:103], a[112:115], a[32:35], v[100:103]
    v_exp_f32 v68, v68
    v_mfma_f32_16x16x32_bf16 v[104:107], a[128:131], a[32:35], v[20:23]
    s_add_u32 m0, s22, 16384
    v_cvt_pk_bf16_f32 v33, v66, v67
    v_mfma_f32_16x16x32_bf16 v[104:107], a[132:135], a[36:39], v[104:107]
    v_exp_f32 v69, v69
    v_mfma_f32_16x16x32_bf16 v[104:107], a[136:139], a[40:43], v[104:107]
    v_exp_f32 v70, v70
    v_mfma_f32_16x16x32_bf16 v[104:107], a[140:143], a[44:47], v[104:107]
    buffer_load_dwordx4 v1, s[8:11], s50 offen offset:0 nt lds
    v_mfma_f32_16x16x32_bf16 v[108:111], a[156:159], a[44:47], v[20:23]
    v_cvt_pk_bf16_f32 v34, v68, v69
    v_mfma_f32_16x16x32_bf16 v[108:111], a[152:155], a[40:43], v[108:111]
    v_exp_f32 v71, v71
    v_mfma_f32_16x16x32_bf16 v[108:111], a[148:151], a[36:39], v[108:111]
    v_mfma_f32_16x16x32_bf16 v[108:111], a[144:147], a[32:35], v[108:111]
    v_exp_f32 v72, v72
    v_mfma_f32_16x16x32_bf16 v[112:115], a[96:99], a[48:51], v[24:27]
    v_exp_f32 v73, v73
    v_mfma_f32_16x16x32_bf16 v[112:115], a[100:103], a[52:55], v[112:115]
    v_cvt_pk_bf16_f32 v35, v70, v71
    v_mfma_f32_16x16x32_bf16 v[112:115], a[104:107], a[56:59], v[112:115]
    v_exp_f32 v74, v74
    v_mfma_f32_16x16x32_bf16 v[112:115], a[108:111], a[60:63], v[112:115]
    v_exp_f32 v75, v75
    v_mfma_f32_16x16x32_bf16 v[116:119], a[124:127], a[60:63], v[24:27]
    v_cvt_pk_bf16_f32 v36, v72, v73
    v_mfma_f32_16x16x32_bf16 v[116:119], a[120:123], a[56:59], v[116:119]
    v_exp_f32 v76, v76
    v_mfma_f32_16x16x32_bf16 v[116:119], a[116:119], a[52:55], v[116:119]
    v_exp_f32 v77, v77
    v_mfma_f32_16x16x32_bf16 v[116:119], a[112:115], a[48:51], v[116:119]
    s_waitcnt vmcnt(17)
    v_cvt_pk_bf16_f32 v37, v74, v75
    v_mfma_f32_16x16x32_bf16 v[120:123], a[128:131], a[48:51], v[24:27]
    s_barrier
    v_exp_f32 v78, v78
    v_mfma_f32_16x16x32_bf16 v[120:123], a[132:135], a[52:55], v[120:123]
    v_exp_f32 v79, v79
    v_mfma_f32_16x16x32_bf16 v[120:123], a[136:139], a[56:59], v[120:123]
    buffer_load_dwordx4 v1, s[8:11], s50 offen offset:1024 nt lds
    v_mfma_f32_16x16x32_bf16 v[120:123], a[140:143], a[60:63], v[120:123]
    v_cvt_pk_bf16_f32 v38, v76, v77
    v_mfma_f32_16x16x32_bf16 v[124:127], a[156:159], a[60:63], v[24:27]
    v_exp_f32 v80, v80
    v_mfma_f32_16x16x32_bf16 v[124:127], a[152:155], a[56:59], v[124:127]
    v_exp_f32 v81, v81
    v_mfma_f32_16x16x32_bf16 v[124:127], a[148:151], a[52:55], v[124:127]
    v_cvt_pk_bf16_f32 v39, v78, v79
    v_mfma_f32_16x16x32_bf16 v[124:127], a[144:147], a[48:51], v[124:127]
    v_exp_f32 v82, v82
    v_mfma_f32_16x16x32_bf16 a[232:235], a[240:243], v[48:51], a[232:235]
    v_exp_f32 v83, v83
    v_mfma_f32_16x16x32_bf16 a[232:235], a[240:243], v[52:55], a[232:235]
    ds_read_b128 a[96:99], v2 offset:49152
    ds_read_b128 a[100:103], v2 offset:49408
    v_mfma_f32_16x16x32_bf16 v[192:195], a[164:167], v[52:55], v[192:195]
    v_cvt_pk_bf16_f32 v40, v80, v81
    v_mfma_f32_16x16x32_bf16 v[192:195], a[160:163], v[48:51], v[192:195]
    v_exp_f32 v84, v84
    v_mfma_f32_16x16x32_bf16 v[196:199], a[168:171], v[48:51], v[196:199]
    ds_read_b128 a[104:107], v2 offset:49664
    ds_read_b128 a[108:111], v2 offset:49920
    v_mfma_f32_16x16x32_bf16 v[196:199], a[172:175], v[52:55], v[196:199]
    v_cvt_pk_bf16_f32 v41, v82, v83
    v_mfma_f32_16x16x32_bf16 v[200:203], a[180:183], v[52:55], v[200:203]
    v_exp_f32 v85, v85
    v_mfma_f32_16x16x32_bf16 v[200:203], a[176:179], v[48:51], v[200:203]
    ds_read_b128 a[112:115], v2 offset:53248
    ds_read_b128 a[116:119], v2 offset:53504
    v_mfma_f32_16x16x32_bf16 v[204:207], a[184:187], v[48:51], v[204:207]
    s_add_u32 m0, s22, 65536
    v_mfma_f32_16x16x32_bf16 v[204:207], a[188:191], v[52:55], v[204:207]
    v_exp_f32 v86, v86
    v_mfma_f32_16x16x32_bf16 v[208:211], a[196:199], v[52:55], v[208:211]
    ds_read_b128 a[120:123], v2 offset:53760
    ds_read_b128 a[124:127], v2 offset:54016
    v_mfma_f32_16x16x32_bf16 v[208:211], a[192:195], v[48:51], v[208:211]
    buffer_load_dwordx4 v1, s[12:15], s48 offen offset:0 nt lds
    v_mfma_f32_16x16x32_bf16 v[212:215], a[200:203], v[48:51], v[212:215]
    v_exp_f32 v87, v87
    v_mfma_f32_16x16x32_bf16 v[212:215], a[204:207], v[52:55], v[212:215]
    ds_read_b128 a[128:131], v2 offset:57344
    ds_read_b128 a[132:135], v2 offset:57600
    v_mfma_f32_16x16x32_bf16 v[216:219], a[212:215], v[52:55], v[216:219]
    v_cvt_pk_bf16_f32 v42, v84, v85
    v_mfma_f32_16x16x32_bf16 v[216:219], a[208:211], v[48:51], v[216:219]
    v_exp_f32 v88, v88
    v_mfma_f32_16x16x32_bf16 v[220:223], a[216:219], v[48:51], v[220:223]
    ds_read_b128 a[136:139], v2 offset:57856
    ds_read_b128 a[140:143], v2 offset:58112
    v_mfma_f32_16x16x32_bf16 v[220:223], a[220:223], v[52:55], v[220:223]
    v_cvt_pk_bf16_f32 v43, v86, v87
    v_mfma_f32_16x16x32_bf16 a[236:239], a[240:243], v[56:59], a[236:239]
    v_exp_f32 v89, v89
    v_mfma_f32_16x16x32_bf16 a[236:239], a[240:243], v[60:63], a[236:239]
    ds_read_b128 a[144:147], v2 offset:61440
    ds_read_b128 a[148:151], v2 offset:61696
    v_mfma_f32_16x16x32_bf16 v[224:227], a[164:167], v[60:63], v[224:227]
    v_mfma_f32_16x16x32_bf16 v[224:227], a[160:163], v[56:59], v[224:227]
    v_exp_f32 v90, v90
    v_mfma_f32_16x16x32_bf16 v[228:231], a[168:171], v[56:59], v[228:231]
    ds_read_b128 a[152:155], v2 offset:61952
    ds_read_b128 a[156:159], v2 offset:62208
    v_mfma_f32_16x16x32_bf16 v[228:231], a[172:175], v[60:63], v[228:231]
    v_exp_f32 v91, v91
    v_mfma_f32_16x16x32_bf16 v[232:235], a[180:183], v[60:63], v[232:235]
    ds_read_b64_tr_b16 a[160:161], v3 offset:32768
    ds_read_b64_tr_b16 a[162:163], v3 offset:36864
    v_mfma_f32_16x16x32_bf16 v[232:235], a[176:179], v[56:59], v[232:235]
    v_cvt_pk_bf16_f32 v44, v88, v89
    v_mfma_f32_16x16x32_bf16 v[236:239], a[184:187], v[56:59], v[236:239]
    v_exp_f32 v92, v92
    v_mfma_f32_16x16x32_bf16 v[236:239], a[188:191], v[60:63], v[236:239]
    ds_read_b64_tr_b16 a[164:165], v3 offset:40960
    v_mfma_f32_16x16x32_bf16 v[240:243], a[196:199], v[60:63], v[240:243]
    buffer_load_dwordx4 v1, s[12:15], s48 offen offset:1024 nt lds
    v_mfma_f32_16x16x32_bf16 v[240:243], a[192:195], v[56:59], v[240:243]
    ds_read_b64_tr_b16 a[166:167], v3 offset:45056
    ds_read_b64_tr_b16 a[168:169], v4 offset:32768
    v_mfma_f32_16x16x32_bf16 v[244:247], a[200:203], v[56:59], v[244:247]
    ds_read_b64_tr_b16 a[170:171], v4 offset:36864
    v_mfma_f32_16x16x32_bf16 v[244:247], a[204:207], v[60:63], v[244:247]
    v_exp_f32 v93, v93
    v_mfma_f32_16x16x32_bf16 v[248:251], a[212:215], v[60:63], v[248:251]
    ds_read_b64_tr_b16 a[172:173], v4 offset:40960
    v_cvt_pk_bf16_f32 v45, v90, v91
    v_mfma_f32_16x16x32_bf16 v[248:251], a[208:211], v[56:59], v[248:251]
    ds_read_b64_tr_b16 a[174:175], v4 offset:45056
    v_mfma_f32_16x16x32_bf16 v[252:255], a[216:219], v[56:59], v[252:255]
    v_exp_f32 v94, v94
    v_mfma_f32_16x16x32_bf16 v[252:255], a[220:223], v[60:63], v[252:255]
    s_waitcnt vmcnt(16) lgkmcnt(8)
L_n13:
    v_mfma_f32_16x16x32_bf16 v[64:67], a[96:99], a[0:3], v[12:15]
    v_exp_f32 v95, v95
    v_mfma_f32_16x16x32_bf16 v[64:67], a[100:103], a[4:7], v[64:67]
    ds_read_b64_tr_b16 a[176:177], v3 offset:33024
    ds_read_b64_tr_b16 a[178:179], v3 offset:37120
    v_mfma_f32_16x16x32_bf16 v[64:67], a[104:107], a[8:11], v[64:67]
    ds_read_b64_tr_b16 a[180:181], v3 offset:41216
    v_cvt_pk_bf16_f32 v46, v92, v93
    v_mfma_f32_16x16x32_bf16 v[64:67], a[108:111], a[12:15], v[64:67]
    ds_read_b64_tr_b16 a[182:183], v3 offset:45312
    v_cvt_pk_bf16_f32 v47, v94, v95
    v_mfma_f32_16x16x32_bf16 v[68:71], a[124:127], a[12:15], v[12:15]
    v_exp_f32 v96, v96
    v_mfma_f32_16x16x32_bf16 v[68:71], a[120:123], a[8:11], v[68:71]
    ds_read_b64_tr_b16 a[184:185], v4 offset:33024
    ds_read_b64_tr_b16 a[186:187], v4 offset:37120
    v_mfma_f32_16x16x32_bf16 v[68:71], a[116:119], a[4:7], v[68:71]
    ds_read_b64_tr_b16 a[188:189], v4 offset:41216
    v_mfma_f32_16x16x32_bf16 v[68:71], a[112:115], a[0:3], v[68:71]
    v_exp_f32 v97, v97
    v_mfma_f32_16x16x32_bf16 v[72:75], a[128:131], a[0:3], v[12:15]
    ds_read_b64_tr_b16 a[190:191], v4 offset:45312
    ds_read_b64_tr_b16 a[192:193], v3 offset:33280
    v_mfma_f32_16x16x32_bf16 v[72:75], a[132:135], a[4:7], v[72:75]
    s_add_u32 m0, s22, 24576
    ds_read_b64_tr_b16 a[194:195], v3 offset:37376
    v_mfma_f32_16x16x32_bf16 v[72:75], a[136:139], a[8:11], v[72:75]
    v_exp_f32 v98, v98
    v_mfma_f32_16x16x32_bf16 v[72:75], a[140:143], a[12:15], v[72:75]
    ds_read_b64_tr_b16 a[196:197], v3 offset:41472
    v_mfma_f32_16x16x32_bf16 v[76:79], a[156:159], a[12:15], v[12:15]
    buffer_load_dwordx4 v1, s[8:11], s51 offen offset:0 nt lds
    v_mfma_f32_16x16x32_bf16 v[76:79], a[152:155], a[8:11], v[76:79]
    ds_read_b64_tr_b16 a[198:199], v3 offset:45568
    ds_read_b64_tr_b16 a[200:201], v4 offset:33280
    v_mfma_f32_16x16x32_bf16 v[76:79], a[148:151], a[4:7], v[76:79]
    ds_read_b64_tr_b16 a[202:203], v4 offset:37376
    v_mfma_f32_16x16x32_bf16 v[76:79], a[144:147], a[0:3], v[76:79]
    v_exp_f32 v99, v99
    v_mfma_f32_16x16x32_bf16 v[80:83], a[96:99], a[16:19], v[16:19]
    ds_read_b64_tr_b16 a[204:205], v4 offset:41472
    ds_read_b64_tr_b16 a[206:207], v4 offset:45568
    v_mfma_f32_16x16x32_bf16 v[80:83], a[100:103], a[20:23], v[80:83]
    ds_read_b64_tr_b16 a[208:209], v3 offset:33536
    v_mfma_f32_16x16x32_bf16 v[80:83], a[104:107], a[24:27], v[80:83]
    ds_read_b64_tr_b16 a[210:211], v3 offset:37632
    v_cvt_pk_bf16_f32 v48, v96, v97
    v_mfma_f32_16x16x32_bf16 v[80:83], a[108:111], a[28:31], v[80:83]
    ds_read_b64_tr_b16 a[212:213], v3 offset:41728
    v_mfma_f32_16x16x32_bf16 v[84:87], a[124:127], a[28:31], v[16:19]
    v_exp_f32 v100, v100
    v_mfma_f32_16x16x32_bf16 v[84:87], a[120:123], a[24:27], v[84:87]
    ds_read_b64_tr_b16 a[214:215], v3 offset:45824
    ds_read_b64_tr_b16 a[216:217], v4 offset:33536
    v_mfma_f32_16x16x32_bf16 v[84:87], a[116:119], a[20:23], v[84:87]
    ds_read_b64_tr_b16 a[218:219], v4 offset:37632
    v_mfma_f32_16x16x32_bf16 v[84:87], a[112:115], a[16:19], v[84:87]
    v_exp_f32 v101, v101
    v_mfma_f32_16x16x32_bf16 v[88:91], a[128:131], a[16:19], v[16:19]
    ds_read_b64_tr_b16 a[220:221], v4 offset:41728
    ds_read_b64_tr_b16 a[222:223], v4 offset:45824
    v_mfma_f32_16x16x32_bf16 v[88:91], a[132:135], a[20:23], v[88:91]
    v_cvt_pk_bf16_f32 v49, v98, v99
    v_mfma_f32_16x16x32_bf16 v[88:91], a[136:139], a[24:27], v[88:91]
    v_exp_f32 v102, v102
    v_mfma_f32_16x16x32_bf16 v[88:91], a[140:143], a[28:31], v[88:91]
    buffer_load_dwordx4 v1, s[8:11], s51 offen offset:1024 nt lds
    v_mfma_f32_16x16x32_bf16 v[92:95], a[156:159], a[28:31], v[16:19]
    v_cvt_pk_bf16_f32 v50, v100, v101
    v_mfma_f32_16x16x32_bf16 v[92:95], a[152:155], a[24:27], v[92:95]
    v_exp_f32 v103, v103
    v_mfma_f32_16x16x32_bf16 v[92:95], a[148:151], a[20:23], v[92:95]
    v_exp_f32 v104, v104
    v_mfma_f32_16x16x32_bf16 v[92:95], a[144:147], a[16:19], v[92:95]
    s_waitcnt lgkmcnt(0)
    v_cvt_pk_bf16_f32 v51, v102, v103
    v_mfma_f32_16x16x32_bf16 a[224:227], a[240:243], v[32:35], a[224:227]
    v_exp_f32 v105, v105
    v_mfma_f32_16x16x32_bf16 a[224:227], a[240:243], v[36:39], a[224:227]
    v_exp_f32 v106, v106
    v_mfma_f32_16x16x32_bf16 v[128:131], a[164:167], v[36:39], v[128:131]
    v_cvt_pk_bf16_f32 v52, v104, v105
    v_mfma_f32_16x16x32_bf16 v[128:131], a[160:163], v[32:35], v[128:131]
    v_exp_f32 v107, v107
    v_mfma_f32_16x16x32_bf16 v[132:135], a[168:171], v[32:35], v[132:135]
    v_mfma_f32_16x16x32_bf16 v[132:135], a[172:175], v[36:39], v[132:135]
    v_exp_f32 v108, v108
    v_mfma_f32_16x16x32_bf16 v[136:139], a[180:183], v[36:39], v[136:139]
    v_exp_f32 v109, v109
    v_mfma_f32_16x16x32_bf16 v[136:139], a[176:179], v[32:35], v[136:139]
    v_cvt_pk_bf16_f32 v53, v106, v107
    v_mfma_f32_16x16x32_bf16 v[140:143], a[184:187], v[32:35], v[140:143]
    s_add_u32 m0, s22, 73728
    v_exp_f32 v110, v110
    v_mfma_f32_16x16x32_bf16 v[140:143], a[188:191], v[36:39], v[140:143]
    v_exp_f32 v111, v111
    v_mfma_f32_16x16x32_bf16 v[144:147], a[196:199], v[36:39], v[144:147]
    buffer_load_dwordx4 v1, s[12:15], s49 offen offset:0 nt lds
    v_mfma_f32_16x16x32_bf16 v[144:147], a[192:195], v[32:35], v[144:147]
    v_cvt_pk_bf16_f32 v54, v108, v109
    v_mfma_f32_16x16x32_bf16 v[148:151], a[200:203], v[32:35], v[148:151]
    v_exp_f32 v112, v112
    v_mfma_f32_16x16x32_bf16 v[148:151], a[204:207], v[36:39], v[148:151]
    v_exp_f32 v113, v113
    v_mfma_f32_16x16x32_bf16 v[152:155], a[212:215], v[36:39], v[152:155]
    v_cvt_pk_bf16_f32 v55, v110, v111
    v_mfma_f32_16x16x32_bf16 v[152:155], a[208:211], v[32:35], v[152:155]
    v_exp_f32 v114, v114
    v_mfma_f32_16x16x32_bf16 v[156:159], a[216:219], v[32:35], v[156:159]
    v_exp_f32 v115, v115
    v_mfma_f32_16x16x32_bf16 v[156:159], a[220:223], v[36:39], v[156:159]
    v_cvt_pk_bf16_f32 v56, v112, v113
    v_mfma_f32_16x16x32_bf16 a[228:231], a[240:243], v[40:43], a[228:231]
    v_exp_f32 v116, v116
    v_mfma_f32_16x16x32_bf16 a[228:231], a[240:243], v[44:47], a[228:231]
    v_exp_f32 v117, v117
    v_mfma_f32_16x16x32_bf16 v[160:163], a[164:167], v[44:47], v[160:163]
    v_cvt_pk_bf16_f32 v57, v114, v115
    v_mfma_f32_16x16x32_bf16 v[160:163], a[160:163], v[40:43], v[160:163]
    v_exp_f32 v118, v118
    v_mfma_f32_16x16x32_bf16 v[164:167], a[168:171], v[40:43], v[164:167]
    v_exp_f32 v119, v119
    v_mfma_f32_16x16x32_bf16 v[164:167], a[172:175], v[44:47], v[164:167]
    v_cvt_pk_bf16_f32 v58, v116, v117
    v_mfma_f32_16x16x32_bf16 v[168:171], a[180:183], v[44:47], v[168:171]
    v_exp_f32 v120, v120
    v_mfma_f32_16x16x32_bf16 v[168:171], a[176:179], v[40:43], v[168:171]
    v_exp_f32 v121, v121
    v_mfma_f32_16x16x32_bf16 v[172:175], a[184:187], v[40:43], v[172:175]
    buffer_load_dwordx4 v1, s[12:15], s49 offen offset:1024 nt lds
    v_mfma_f32_16x16x32_bf16 v[172:175], a[188:191], v[44:47], v[172:175]
    v_cvt_pk_bf16_f32 v59, v118, v119
    v_mfma_f32_16x16x32_bf16 v[176:179], a[196:199], v[44:47], v[176:179]
    v_exp_f32 v122, v122
    v_mfma_f32_16x16x32_bf16 v[176:179], a[192:195], v[40:43], v[176:179]
    v_exp_f32 v123, v123
    v_mfma_f32_16x16x32_bf16 v[180:183], a[200:203], v[40:43], v[180:183]
    v_cvt_pk_bf16_f32 v60, v120, v121
    v_mfma_f32_16x16x32_bf16 v[180:183], a[204:207], v[44:47], v[180:183]
    v_exp_f32 v124, v124
    v_mfma_f32_16x16x32_bf16 v[184:187], a[212:215], v[44:47], v[184:187]
    v_exp_f32 v125, v125
    v_mfma_f32_16x16x32_bf16 v[184:187], a[208:211], v[40:43], v[184:187]
    v_cvt_pk_bf16_f32 v61, v122, v123
    v_mfma_f32_16x16x32_bf16 v[188:191], a[216:219], v[40:43], v[188:191]
    v_exp_f32 v126, v126
    v_mfma_f32_16x16x32_bf16 v[188:191], a[220:223], v[44:47], v[188:191]
    s_waitcnt vmcnt(12)
L_n14:
    v_mfma_f32_16x16x32_bf16 v[96:99], a[96:99], a[32:35], v[20:23]
    v_exp_f32 v127, v127
    v_mfma_f32_16x16x32_bf16 v[96:99], a[100:103], a[36:39], v[96:99]
    v_cvt_pk_bf16_f32 v62, v124, v125
    v_cvt_pk_bf16_f32 v63, v126, v127
    v_mfma_f32_16x16x32_bf16 v[96:99], a[104:107], a[40:43], v[96:99]
    v_exp_f32 v64, v64
    v_mfma_f32_16x16x32_bf16 v[96:99], a[108:111], a[44:47], v[96:99]
    v_exp_f32 v65, v65
    v_mfma_f32_16x16x32_bf16 v[100:103], a[124:127], a[44:47], v[20:23]
    v_exp_f32 v66, v66
    v_mfma_f32_16x16x32_bf16 v[100:103], a[120:123], a[40:43], v[100:103]
    v_exp_f32 v67, v67
    v_mfma_f32_16x16x32_bf16 v[100:103], a[116:119], a[36:39], v[100:103]
    v_cvt_pk_bf16_f32 v32, v64, v65
    v_mfma_f32_16x16x32_bf16 v[100:103], a[112:115], a[32:35], v[100:103]
    v_exp_f32 v68, v68
    v_mfma_f32_16x16x32_bf16 v[104:107], a[128:131], a[32:35], v[20:23]
    s_add_u32 m0, s22, 32768
    v_exp_f32 v69, v69
    v_mfma_f32_16x16x32_bf16 v[104:107], a[132:135], a[36:39], v[104:107]
    v_cvt_pk_bf16_f32 v33, v66, v67
    v_mfma_f32_16x16x32_bf16 v[104:107], a[136:139], a[40:43], v[104:107]
    v_exp_f32 v70, v70
    v_mfma_f32_16x16x32_bf16 v[104:107], a[140:143], a[44:47], v[104:107]
    buffer_load_dwordx4 v1, s[8:11], s52 offen offset:0 nt lds
    v_mfma_f32_16x16x32_bf16 v[108:111], a[156:159], a[44:47], v[20:23]
    v_exp_f32 v71, v71
    v_mfma_f32_16x16x32_bf16 v[108:111], a[152:155], a[40:43], v[108:111]
    v_cvt_pk_bf16_f32 v34, v68, v69
    v_mfma_f32_16x16x32_bf16 v[108:111], a[148:151], a[36:39], v[108:111]
    v_exp_f32 v72, v72
    v_mfma_f32_16x16x32_bf16 v[108:111], a[144:147], a[32:35], v[108:111]
    v_exp_f32 v73, v73
    v_mfma_f32_16x16x32_bf16 v[112:115], a[96:99], a[48:51], v[24:27]
    v_cvt_pk_bf16_f32 v35, v70, v71
    v_mfma_f32_16x16x32_bf16 v[112:115], a[100:103], a[52:55], v[112:115]
    v_exp_f32 v74, v74
    v_mfma_f32_16x16x32_bf16 v[112:115], a[104:107], a[56:59], v[112:115]
    v_exp_f32 v75, v75
    v_mfma_f32_16x16x32_bf16 v[112:115], a[108:111], a[60:63], v[112:115]
    v_cvt_pk_bf16_f32 v36, v72, v73
    v_mfma_f32_16x16x32_bf16 v[116:119], a[124:127], a[60:63], v[24:27]
    v_exp_f32 v76, v76
    v_mfma_f32_16x16x32_bf16 v[116:119], a[120:123], a[56:59], v[116:119]
    v_exp_f32 v77, v77
    v_mfma_f32_16x16x32_bf16 v[116:119], a[116:119], a[52:55], v[116:119]
    v_cvt_pk_bf16_f32 v37, v74, v75
    v_mfma_f32_16x16x32_bf16 v[116:119], a[112:115], a[48:51], v[116:119]
    s_waitcnt vmcnt(9)
    v_exp_f32 v78, v78
    v_mfma_f32_16x16x32_bf16 v[120:123], a[128:131], a[48:51], v[24:27]
    s_barrier
    v_exp_f32 v79, v79
    v_mfma_f32_16x16x32_bf16 v[120:123], a[132:135], a[52:55], v[120:123]
    v_cvt_pk_bf16_f32 v38, v76, v77
    v_mfma_f32_16x16x32_bf16 v[120:123], a[136:139], a[56:59], v[120:123]
    v_exp_f32 v80, v80
    v_mfma_f32_16x16x32_bf16 v[120:123], a[140:143], a[60:63], v[120:123]
    buffer_load_dwordx4 v1, s[8:11], s52 offen offset:1024 nt lds
    v_mfma_f32_16x16x32_bf16 v[124:127], a[156:159], a[60:63], v[24:27]
    v_exp_f32 v81, v81
    v_mfma_f32_16x16x32_bf16 v[124:127], a[152:155], a[56:59], v[124:127]
    v_cvt_pk_bf16_f32 v39, v78, v79
    v_mfma_f32_16x16x32_bf16 v[124:127], a[148:151], a[52:55], v[124:127]
    v_exp_f32 v82, v82
    v_mfma_f32_16x16x32_bf16 v[124:127], a[144:147], a[48:51], v[124:127]
    v_exp_f32 v83, v83
    v_mfma_f32_16x16x32_bf16 a[232:235], a[240:243], v[48:51], a[232:235]
    ds_read_b128 a[96:99], v2 offset:0
    v_cvt_pk_bf16_f32 v40, v80, v81
    v_mfma_f32_16x16x32_bf16 a[232:235], a[240:243], v[52:55], a[232:235]
    v_exp_f32 v84, v84
    v_mfma_f32_16x16x32_bf16 v[192:195], a[164:167], v[52:55], v[192:195]
    ds_read_b128 a[100:103], v2 offset:256
    ds_read_b128 a[104:107], v2 offset:512
    v_mfma_f32_16x16x32_bf16 v[192:195], a[160:163], v[48:51], v[192:195]
    v_exp_f32 v85, v85
    v_mfma_f32_16x16x32_bf16 v[196:199], a[168:171], v[48:51], v[196:199]
    ds_read_b128 a[108:111], v2 offset:768
    ds_read_b128 a[112:115], v2 offset:4096
    v_mfma_f32_16x16x32_bf16 v[196:199], a[172:175], v[52:55], v[196:199]
    ds_read_b128 a[116:119], v2 offset:4352
    v_cvt_pk_bf16_f32 v41, v82, v83
    v_mfma_f32_16x16x32_bf16 v[200:203], a[180:183], v[52:55], v[200:203]
    v_exp_f32 v86, v86
    v_mfma_f32_16x16x32_bf16 v[200:203], a[176:179], v[48:51], v[200:203]
    ds_read_b128 a[120:123], v2 offset:4608
    ds_read_b128 a[124:127], v2 offset:4864
    v_mfma_f32_16x16x32_bf16 v[204:207], a[184:187], v[48:51], v[204:207]
    v_exp_f32 v87, v87
    v_mfma_f32_16x16x32_bf16 v[204:207], a[188:191], v[52:55], v[204:207]
    ds_read_b128 a[128:131], v2 offset:8192
    v_cvt_pk_bf16_f32 v42, v84, v85
    v_mfma_f32_16x16x32_bf16 v[208:211], a[196:199], v[52:55], v[208:211]
    s_add_u32 m0, s22, 81920
    ds_read_b128 a[132:135], v2 offset:8448
    ds_read_b128 a[136:139], v2 offset:8704
    v_mfma_f32_16x16x32_bf16 v[208:211], a[192:195], v[48:51], v[208:211]
    buffer_load_dwordx4 v1, s[12:15], s50 offen offset:0 nt lds
    v_mfma_f32_16x16x32_bf16 v[212:215], a[200:203], v[48:51], v[212:215]
    ds_read_b128 a[140:143], v2 offset:8960
    ds_read_b128 a[144:147], v2 offset:12288
    v_mfma_f32_16x16x32_bf16 v[212:215], a[204:207], v[52:55], v[212:215]
    ds_read_b128 a[148:151], v2 offset:12544
    v_mfma_f32_16x16x32_bf16 v[216:219], a[212:215], v[52:55], v[216:219]
    ds_read_b128 a[152:155], v2 offset:12800
    v_mfma_f32_16x16x32_bf16 v[216:219], a[208:211], v[48:51], v[216:219]
    v_exp_f32 v88, v88
    v_mfma_f32_16x16x32_bf16 v[220:223], a[216:219], v[48:51], v[220:223]
    ds_read_b128 a[156:159], v2 offset:13056
    ds_read_b128 a[0:3], v7 offset:32768
    v_mfma_f32_16x16x32_bf16 v[220:223], a[220:223], v[52:55], v[220:223]
    v_exp_f32 v89, v89
    v_mfma_f32_16x16x32_bf16 a[236:239], a[240:243], v[56:59], a[236:239]
    ds_read_b128 a[4:7], v7 offset:33024
    ds_read_b128 a[8:11], v7 offset:33280
    v_mfma_f32_16x16x32_bf16 a[236:239], a[240:243], v[60:63], a[236:239]
    ds_read_b128 a[12:15], v7 offset:33536
    v_mfma_f32_16x16x32_bf16 v[224:227], a[164:167], v[60:63], v[224:227]
    ds_read_b128 a[16:19], v7 offset:36864
    v_cvt_pk_bf16_f32 v43, v86, v87
    v_mfma_f32_16x16x32_bf16 v[224:227], a[160:163], v[56:59], v[224:227]
    v_exp_f32 v90, v90
    v_mfma_f32_16x16x32_bf16 v[228:231], a[168:171], v[56:59], v[228:231]
    ds_read_b128 a[20:23], v7 offset:37120
    ds_read_b128 a[24:27], v7 offset:37376
    v_mfma_f32_16x16x32_bf16 v[228:231], a[172:175], v[60:63], v[228:231]
    ds_read_b128 a[28:31], v7 offset:37632
    ds_read_b64_tr_b16 a[160:161], v3 offset:49152
    v_mfma_f32_16x16x32_bf16 v[232:235], a[180:183], v[60:63], v[232:235]
    ds_read_b64_tr_b16 a[162:163], v3 offset:53248
    v_mfma_f32_16x16x32_bf16 v[232:235], a[176:179], v[56:59], v[232:235]
    v_exp_f32 v91, v91
    v_mfma_f32_16x16x32_bf16 v[236:239], a[184:187], v[56:59], v[236:239]
    ds_read_b64_tr_b16 a[164:165], v3 offset:57344
    v_cvt_pk_bf16_f32 v44, v88, v89
    v_mfma_f32_16x16x32_bf16 v[236:239], a[188:191], v[60:63], v[236:239]
    buffer_load_dwordx4 v1, s[12:15], s50 offen offset:1024 nt lds
    v_mfma_f32_16x16x32_bf16 v[240:243], a[196:199], v[60:63], v[240:243]
    ds_read_b64_tr_b16 a[166:167], v3 offset:61440
    v_mfma_f32_16x16x32_bf16 v[240:243], a[192:195], v[56:59], v[240:243]
    v_exp_f32 v92, v92
    v_mfma_f32_16x16x32_bf16 v[244:247], a[200:203], v[56:59], v[244:247]
    ds_read_b64_tr_b16 a[168:169], v4 offset:49152
    ds_read_b64_tr_b16 a[170:171], v4 offset:53248
    v_mfma_f32_16x16x32_bf16 v[244:247], a[204:207], v[60:63], v[244:247]
    v_cvt_pk_bf16_f32 v45, v90, v91
    v_mfma_f32_16x16x32_bf16 v[248:251], a[212:215], v[60:63], v[248:251]
    v_exp_f32 v93, v93
    v_mfma_f32_16x16x32_bf16 v[248:251], a[208:211], v[56:59], v[248:251]
    ds_read_b64_tr_b16 a[172:173], v4 offset:57344
    ds_read_b64_tr_b16 a[174:175], v4 offset:61440
    v_mfma_f32_16x16x32_bf16 v[252:255], a[216:219], v[56:59], v[252:255]
    v_exp_f32 v94, v94
    v_mfma_f32_16x16x32_bf16 v[252:255], a[220:223], v[60:63], v[252:255]
    s_waitcnt lgkmcnt(8)
L_n15:
    v_mfma_f32_16x16x32_bf16 v[64:67], a[96:99], a[64:67], 0
    v_exp_f32 v95, v95
    v_mfma_f32_16x16x32_bf16 v[64:67], a[100:103], a[68:71], v[64:67]
    ds_read_b64_tr_b16 a[176:177], v3 offset:49408
    ds_read_b64_tr_b16 a[178:179], v3 offset:53504
    v_mfma_f32_16x16x32_bf16 v[64:67], a[104:107], a[72:75], v[64:67]
    ds_read_b64_tr_b16 a[180:181], v3 offset:57600
    v_cvt_pk_bf16_f32 v46, v92, v93
    v_mfma_f32_16x16x32_bf16 v[64:67], a[108:111], a[76:79], v[64:67]
    ds_read_b64_tr_b16 a[182:183], v3 offset:61696
    v_cvt_pk_bf16_f32 v47, v94, v95
    v_mfma_f32_16x16x32_bf16 v[68:71], a[124:127], a[76:79], 0
    v_exp_f32 v96, v96
    v_mfma_f32_16x16x32_bf16 v[68:71], a[120:123], a[72:75], v[68:71]
    ds_read_b64_tr_b16 a[184:185], v4 offset:49408
    ds_read_b64_tr_b16 a[186:187], v4 offset:53504
    v_mfma_f32_16x16x32_bf16 v[68:71], a[116:119], a[68:71], v[68:71]
    ds_read_b64_tr_b16 a[188:189], v4 offset:57600
    v_mfma_f32_16x16x32_bf16 v[68:71], a[112:115], a[64:67], v[68:71]
    v_exp_f32 v97, v97
    v_mfma_f32_16x16x32_bf16 v[72:75], a[128:131], a[64:67], 0
    ds_read_b64_tr_b16 a[190:191], v4 offset:61696
    v_mfma_f32_16x16x32_bf16 v[72:75], a[132:135], a[68:71], v[72:75]
    s_add_u32 m0, s22, 40960
    ds_read_b64_tr_b16 a[192:193], v3 offset:49664
    ds_read_b64_tr_b16 a[194:195], v3 offset:53760
    v_mfma_f32_16x16x32_bf16 v[72:75], a[136:139], a[72:75], v[72:75]
    buffer_load_dwordx4 v1, s[8:11], s53 offen offset:0 nt lds
    v_mfma_f32_16x16x32_bf16 v[72:75], a[140:143], a[76:79], v[72:75]
    ds_read_b64_tr_b16 a[196:197], v3 offset:57856
    ds_read_b64_tr_b16 a[198:199], v3 offset:61952
    v_mfma_f32_16x16x32_bf16 v[76:79], a[156:159], a[76:79], 0
    v_mfma_f32_16x16x32_bf16 v[76:79], a[152:155], a[72:75], v[76:79]
    v_exp_f32 v98, v98
    v_mfma_f32_16x16x32_bf16 v[76:79], a[148:151], a[68:71], v[76:79]
    ds_read_b64_tr_b16 a[200:201], v4 offset:49664
    ds_read_b64_tr_b16 a[202:203], v4 offset:53760
    v_mfma_f32_16x16x32_bf16 v[76:79], a[144:147], a[64:67], v[76:79]
    v_exp_f32 v99, v99
    v_mfma_f32_16x16x32_bf16 v[80:83], a[96:99], a[80:83], 0
    ds_read_b64_tr_b16 a[204:205], v4 offset:57856
    ds_read_b64_tr_b16 a[206:207], v4 offset:61952
    v_mfma_f32_16x16x32_bf16 v[80:83], a[100:103], a[84:87], v[80:83]
    ds_read_b64_tr_b16 a[208:209], v3 offset:49920
    v_cvt_pk_bf16_f32 v48, v96, v97
    v_mfma_f32_16x16x32_bf16 v[80:83], a[104:107], a[88:91], v[80:83]
    ds_read_b64_tr_b16 a[210:211], v3 offset:54016
    v_mfma_f32_16x16x32_bf16 v[80:83], a[108:111], a[92:95], v[80:83]
    v_exp_f32 v100, v100
    v_mfma_f32_16x16x32_bf16 v[84:87], a[124:127], a[92:95], 0
    ds_read_b64_tr_b16 a[212:213], v3 offset:58112
    ds_read_b64_tr_b16 a[214:215], v3 offset:62208
    v_mfma_f32_16x16x32_bf16 v[84:87], a[120:123], a[88:91], v[84:87]
    ds_read_b64_tr_b16 a[216:217], v4 offset:49920
    v_mfma_f32_16x16x32_bf16 v[84:87], a[116:119], a[84:87], v[84:87]
    buffer_load_dwordx4 v1, s[8:11], s53 offen offset:1024 nt lds
    v_mfma_f32_16x16x32_bf16 v[84:87], a[112:115], a[80:83], v[84:87]
    ds_read_b64_tr_b16 a[218:219], v4 offset:54016
    ds_read_b64_tr_b16 a[220:221], v4 offset:58112
    v_mfma_f32_16x16x32_bf16 v[88:91], a[128:131], a[80:83], 0
    ds_read_b64_tr_b16 a[222:223], v4 offset:62208
    v_mfma_f32_16x16x32_bf16 v[88:91], a[132:135], a[84:87], v[88:91]
    v_exp_f32 v101, v101
    v_mfma_f32_16x16x32_bf16 v[88:91], a[136:139], a[88:91], v[88:91]
    v_cvt_pk_bf16_f32 v49, v98, v99
    v_mfma_f32_16x16x32_bf16 v[88:91], a[140:143], a[92:95], v[88:91]
    v_exp_f32 v102, v102
    v_mfma_f32_16x16x32_bf16 v[92:95], a[156:159], a[92:95], 0
    v_exp_f32 v103, v103
    v_mfma_f32_16x16x32_bf16 v[92:95], a[152:155], a[88:91], v[92:95]
    v_cvt_pk_bf16_f32 v50, v100, v101
    v_mfma_f32_16x16x32_bf16 v[92:95], a[148:151], a[84:87], v[92:95]
    v_exp_f32 v104, v104
    v_mfma_f32_16x16x32_bf16 v[92:95], a[144:147], a[80:83], v[92:95]
    s_waitcnt lgkmcnt(0)
    v_exp_f32 v105, v105
    v_mfma_f32_16x16x32_bf16 a[224:227], a[240:243], v[32:35], a[224:227]
    s_add_u32 m0, s22, 90112
    v_cvt_pk_bf16_f32 v51, v102, v103
    v_mfma_f32_16x16x32_bf16 a[224:227], a[240:243], v[36:39], a[224:227]
    v_exp_f32 v106, v106
    v_mfma_f32_16x16x32_bf16 v[128:131], a[164:167], v[36:39], v[128:131]
    v_exp_f32 v107, v107
    v_mfma_f32_16x16x32_bf16 v[128:131], a[160:163], v[32:35], v[128:131]
    buffer_load_dwordx4 v1, s[12:15], s51 offen offset:0 nt lds
    v_mfma_f32_16x16x32_bf16 v[132:135], a[168:171], v[32:35], v[132:135]
    v_cvt_pk_bf16_f32 v52, v104, v105
    v_mfma_f32_16x16x32_bf16 v[132:135], a[172:175], v[36:39], v[132:135]
    v_exp_f32 v108, v108
    v_mfma_f32_16x16x32_bf16 v[136:139], a[180:183], v[36:39], v[136:139]
    v_exp_f32 v109, v109
    v_mfma_f32_16x16x32_bf16 v[136:139], a[176:179], v[32:35], v[136:139]
    v_cvt_pk_bf16_f32 v53, v106, v107
    v_mfma_f32_16x16x32_bf16 v[140:143], a[184:187], v[32:35], v[140:143]
    v_exp_f32 v110, v110
    v_mfma_f32_16x16x32_bf16 v[140:143], a[188:191], v[36:39], v[140:143]
    v_exp_f32 v111, v111
    v_mfma_f32_16x16x32_bf16 v[144:147], a[196:199], v[36:39], v[144:147]
    v_cvt_pk_bf16_f32 v54, v108, v109
    v_mfma_f32_16x16x32_bf16 v[144:147], a[192:195], v[32:35], v[144:147]
    v_exp_f32 v112, v112
    v_mfma_f32_16x16x32_bf16 v[148:151], a[200:203], v[32:35], v[148:151]
    v_exp_f32 v113, v113
    v_mfma_f32_16x16x32_bf16 v[148:151], a[204:207], v[36:39], v[148:151]
    v_cvt_pk_bf16_f32 v55, v110, v111
    v_mfma_f32_16x16x32_bf16 v[152:155], a[212:215], v[36:39], v[152:155]
    v_exp_f32 v114, v114
    v_mfma_f32_16x16x32_bf16 v[152:155], a[208:211], v[32:35], v[152:155]
    v_exp_f32 v115, v115
    v_mfma_f32_16x16x32_bf16 v[156:159], a[216:219], v[32:35], v[156:159]
    buffer_load_dwordx4 v1, s[12:15], s51 offen offset:1024 nt lds
    v_mfma_f32_16x16x32_bf16 v[156:159], a[220:223], v[36:39], v[156:159]
    v_cvt_pk_bf16_f32 v56, v112, v113
    v_mfma_f32_16x16x32_bf16 a[228:231], a[240:243], v[40:43], a[228:231]
    v_exp_f32 v116, v116
    v_mfma_f32_16x16x32_bf16 a[228:231], a[240:243], v[44:47], a[228:231]
    v_exp_f32 v117, v117
    v_mfma_f32_16x16x32_bf16 v[160:163], a[164:167], v[44:47], v[160:163]
    v_cvt_pk_bf16_f32 v57, v114, v115
    v_mfma_f32_16x16x32_bf16 v[160:163], a[160:163], v[40:43], v[160:163]
    v_exp_f32 v118, v118
    v_mfma_f32_16x16x32_bf16 v[164:167], a[168:171], v[40:43], v[164:167]
    v_exp_f32 v119, v119
    v_mfma_f32_16x16x32_bf16 v[164:167], a[172:175], v[44:47], v[164:167]
L_pad4:
    s_cbranch_execz L_back1
    v_cvt_pk_bf16_f32 v58, v116, v117
    v_mfma_f32_16x16x32_bf16 v[168:171], a[180:183], v[44:47], v[168:171]
    v_exp_f32 v120, v120
    v_mfma_f32_16x16x32_bf16 v[168:171], a[176:179], v[40:43], v[168:171]
    s_add_u32 s23, s0, L_n18-L_pc
    v_exp_f32 v121, v121
    v_mfma_f32_16x16x32_bf16 v[172:175], a[184:187], v[40:43], v[172:175]
    v_cvt_pk_bf16_f32 v59, v118, v119
    v_mfma_f32_16x16x32_bf16 v[172:175], a[188:191], v[44:47], v[172:175]
    v_exp_f32 v122, v122
    v_mfma_f32_16x16x32_bf16 v[176:179], a[196:199], v[44:47], v[176:179]
    buffer_load_dword a247, off, s[96:99], s23
    v_mfma_f32_16x16x32_bf16 v[176:179], a[192:195], v[40:43], v[176:179]
    v_cvt_pk_bf16_f32 v60, v120, v121
    v_mfma_f32_16x16x32_bf16 v[180:183], a[200:203], v[40:43], v[180:183]
    v_exp_f32 v123, v123
    v_mfma_f32_16x16x32_bf16 v[180:183], a[204:207], v[44:47], v[180:183]
    v_exp_f32 v124, v124
    v_mfma_f32_16x16x32_bf16 v[184:187], a[212:215], v[44:47], v[184:187]
    v_cvt_pk_bf16_f32 v61, v122, v123
    v_mfma_f32_16x16x32_bf16 v[184:187], a[208:211], v[40:43], v[184:187]
    v_exp_f32 v125, v125
    v_mfma_f32_16x16x32_bf16 v[188:191], a[216:219], v[40:43], v[188:191]
    v_exp_f32 v126, v126
    v_mfma_f32_16x16x32_bf16 v[188:191], a[220:223], v[44:47], v[188:191]
    v_accvgpr_read_b32 v5, a244
    v_accvgpr_read_b32 v6, a245
    v_accvgpr_read_b32 v7, a246
    v_accvgpr_read_b32 v30, a224
    v_accvgpr_read_b32 v31, a228
    v_xor_b32 v9, 64, v6
    v_xor_b32 v11, 64, v7
    v_cmp_ngt_f32 vcc, 0x53800000, v30
    v_rcp_f32 v30, v30
    s_mov_b64 s[28:29], vcc
    v_cmp_ngt_f32 vcc, 0x53800000, v31
    v_rcp_f32 v31, v31
    s_or_b64 s[28:29], s[28:29], vcc
    v_pk_mul_f32 v[128:129], v[128:129], v[30:31] op_sel_hi:[1,0]
    v_pk_mul_f32 v[130:131], v[130:131], v[30:31] op_sel_hi:[1,0]
    v_cvt_pk_bf16_f32 v128, v128, v129
    v_cvt_pk_bf16_f32 v129, v130, v131
    v_pk_mul_f32 v[132:133], v[132:133], v[30:31] op_sel_hi:[1,0]
    v_pk_mul_f32 v[134:135], v[134:135], v[30:31] op_sel_hi:[1,0]
    v_cvt_pk_bf16_f32 v130, v132, v133
    v_cvt_pk_bf16_f32 v131, v134, v135
    ds_write_b128 v6, v[128:131] offset:0
    v_pk_mul_f32 v[136:137], v[136:137], v[30:31] op_sel_hi:[1,0]
    v_pk_mul_f32 v[138:139], v[138:139], v[30:31] op_sel_hi:[1,0]
    v_cvt_pk_bf16_f32 v132, v136, v137
    v_cvt_pk_bf16_f32 v133, v138, v139
    v_pk_mul_f32 v[140:141], v[140:141], v[30:31] op_sel_hi:[1,0]
    v_pk_mul_f32 v[142:143], v[142:143], v[30:31] op_sel_hi:[1,0]
    v_cvt_pk_bf16_f32 v134, v140, v141
    v_cvt_pk_bf16_f32 v135, v142, v143
    ds_write_b128 v9, v[132:135] offset:0
    v_pk_mul_f32 v[144:145], v[144:145], v[30:31] op_sel_hi:[1,0]
    v_pk_mul_f32 v[146:147], v[146:147], v[30:31] op_sel_hi:[1,0]
    v_cvt_pk_bf16_f32 v136, v144, v145
    v_cvt_pk_bf16_f32 v137, v146, v147
    v_pk_mul_f32 v[148:149], v[148:149], v[30:31] op_sel_hi:[1,0]
    v_pk_mul_f32 v[150:151], v[150:151], v[30:31] op_sel_hi:[1,0]
    v_cvt_pk_bf16_f32 v138, v148, v149
    v_cvt_pk_bf16_f32 v139, v150, v151
    ds_write_b128 v6, v[136:139] offset:128
    v_pk_mul_f32 v[152:153], v[152:153], v[30:31] op_sel_hi:[1,0]
    v_pk_mul_f32 v[154:155], v[154:155], v[30:31] op_sel_hi:[1,0]
    v_cvt_pk_bf16_f32 v140, v152, v153
    v_cvt_pk_bf16_f32 v141, v154, v155
    v_pk_mul_f32 v[156:157], v[156:157], v[30:31] op_sel_hi:[1,0]
    v_pk_mul_f32 v[158:159], v[158:159], v[30:31] op_sel_hi:[1,0]
    v_cvt_pk_bf16_f32 v142, v156, v157
    v_cvt_pk_bf16_f32 v143, v158, v159
    ds_write_b128 v9, v[140:143] offset:128
    ds_read_b128 a[32:35], v7 offset:0
    ds_read_b128 a[36:39], v7 offset:1024
    ds_read_b128 a[40:43], v11 offset:2048
    ds_read_b128 a[44:47], v11 offset:3072
    v_pk_mul_f32 v[160:161], v[160:161], v[30:31] op_sel:[0,1] op_sel_hi:[1,1]
    v_pk_mul_f32 v[162:163], v[162:163], v[30:31] op_sel:[0,1] op_sel_hi:[1,1]
    v_cvt_pk_bf16_f32 v160, v160, v161
    v_cvt_pk_bf16_f32 v161, v162, v163
    v_pk_mul_f32 v[164:165], v[164:165], v[30:31] op_sel:[0,1] op_sel_hi:[1,1]
    v_pk_mul_f32 v[166:167], v[166:167], v[30:31] op_sel:[0,1] op_sel_hi:[1,1]
    v_cvt_pk_bf16_f32 v162, v164, v165
    v_cvt_pk_bf16_f32 v163, v166, v167
    ds_write_b128 v6, v[160:163] offset:4096
    v_pk_mul_f32 v[168:169], v[168:169], v[30:31] op_sel:[0,1] op_sel_hi:[1,1]
    v_pk_mul_f32 v[170:171], v[170:171], v[30:31] op_sel:[0,1] op_sel_hi:[1,1]
    v_cvt_pk_bf16_f32 v164, v168, v169
    v_cvt_pk_bf16_f32 v165, v170, v171
    v_pk_mul_f32 v[172:173], v[172:173], v[30:31] op_sel:[0,1] op_sel_hi:[1,1]
    v_pk_mul_f32 v[174:175], v[174:175], v[30:31] op_sel:[0,1] op_sel_hi:[1,1]
    v_cvt_pk_bf16_f32 v166, v172, v173
    v_cvt_pk_bf16_f32 v167, v174, v175
    ds_write_b128 v9, v[164:167] offset:4096
    v_pk_mul_f32 v[176:177], v[176:177], v[30:31] op_sel:[0,1] op_sel_hi:[1,1]
    v_pk_mul_f32 v[178:179], v[178:179], v[30:31] op_sel:[0,1] op_sel_hi:[1,1]
    v_cvt_pk_bf16_f32 v168, v176, v177
    v_cvt_pk_bf16_f32 v169, v178, v179
    v_pk_mul_f32 v[180:181], v[180:181], v[30:31] op_sel:[0,1] op_sel_hi:[1,1]
    v_pk_mul_f32 v[182:183], v[182:183], v[30:31] op_sel:[0,1] op_sel_hi:[1,1]
    v_cvt_pk_bf16_f32 v170, v180, v181
    v_cvt_pk_bf16_f32 v171, v182, v183
    ds_write_b128 v6, v[168:171] offset:4224
    v_pk_mul_f32 v[184:185], v[184:185], v[30:31] op_sel:[0,1] op_sel_hi:[1,1]
    v_pk_mul_f32 v[186:187], v[186:187], v[30:31] op_sel:[0,1] op_sel_hi:[1,1]
    v_cvt_pk_bf16_f32 v172, v184, v185
    v_cvt_pk_bf16_f32 v173, v186, v187
    v_pk_mul_f32 v[188:189], v[188:189], v[30:31] op_sel:[0,1] op_sel_hi:[1,1]
    v_pk_mul_f32 v[190:191], v[190:191], v[30:31] op_sel:[0,1] op_sel_hi:[1,1]
    v_cvt_pk_bf16_f32 v174, v188, v189
    v_cvt_pk_bf16_f32 v175, v190, v191
    ds_write_b128 v9, v[172:175] offset:4224
    ds_read_b128 a[48:51], v7 offset:4096
    ds_read_b128 a[52:55], v7 offset:5120
    ds_read_b128 a[56:59], v11 offset:6144
    ds_read_b128 a[60:63], v11 offset:7168
L_n16:
    v_mfma_f32_16x16x32_bf16 v[96:99], a[96:99], a[0:3], 0
    v_exp_f32 v127, v127
    v_mfma_f32_16x16x32_bf16 v[96:99], a[100:103], a[4:7], v[96:99]
    v_cvt_pk_bf16_f32 v62, v124, v125
    v_cvt_pk_bf16_f32 v63, v126, v127
    v_max3_f32 v15, v64, v65, v66
    v_mfma_f32_16x16x32_bf16 v[96:99], a[104:107], a[8:11], v[96:99]
    v_max3_f32 v19, v80, v81, v82
    v_max3_f32 v15, v15, v67, v68
    v_mfma_f32_16x16x32_bf16 v[96:99], a[108:111], a[12:15], v[96:99]
    v_max3_f32 v19, v19, v83, v84
    v_max3_f32 v15, v15, v69, v70
    v_max3_f32 v19, v19, v85, v86
    v_mfma_f32_16x16x32_bf16 v[100:103], a[124:127], a[12:15], 0
    v_max_f32 v15, v15, v71
    v_max_f32 v19, v19, v87
    v_mov_b32 v28, v15
    v_mfma_f32_16x16x32_bf16 v[100:103], a[120:123], a[8:11], v[100:103]
    v_mov_b32 v29, v19
    v_permlane32_swap_b32 v28, v15
    v_mfma_f32_16x16x32_bf16 v[100:103], a[116:119], a[4:7], v[100:103]
    s_add_u32 m0, s22, 49152
    v_permlane32_swap_b32 v29, v19
    v_max_f32 v15, v15, v28
    v_max_f32 v19, v19, v29
    v_mfma_f32_16x16x32_bf16 v[100:103], a[112:115], a[0:3], v[100:103]
    v_mov_b32 v28, v15
    v_mov_b32 v29, v19
    v_mfma_f32_16x16x32_bf16 v[104:107], a[128:131], a[0:3], 0
    buffer_load_dwordx4 v1, s[8:11], s54 offen offset:0 nt lds
    v_permlane16_swap_b32 v28, v15
    v_mfma_f32_16x16x32_bf16 v[104:107], a[132:135], a[4:7], v[104:107]
    v_permlane16_swap_b32 v29, v19
    v_max_f32 v15, v15, v28
    v_max_f32 v19, v19, v29
    v_mfma_f32_16x16x32_bf16 v[104:107], a[136:139], a[8:11], v[104:107]
    v_mul_f32 v30, 0xbe0293ee, v15
    v_sub_f32 v12, 0, v15
    v_mfma_f32_16x16x32_bf16 v[104:107], a[140:143], a[12:15], v[104:107]
    v_sub_f32 v13, 0, v15
    v_sub_f32 v14, 0, v15
    v_sub_f32 v15, 0, v15
    v_mfma_f32_16x16x32_bf16 v[108:111], a[156:159], a[12:15], 0
    v_mul_f32 v31, 0xbe0293ee, v19
    v_sub_f32 v16, 0, v19
    v_sub_f32 v17, 0, v19
    v_mfma_f32_16x16x32_bf16 v[108:111], a[152:155], a[8:11], v[108:111]
    v_sub_f32 v18, 0, v19
    v_sub_f32 v19, 0, v19
    v_mfma_f32_16x16x32_bf16 v[108:111], a[148:151], a[4:7], v[108:111]
    v_fma_f32 v64, v64, s20, v30
    v_fma_f32 v65, v65, s20, v30
    v_fma_f32 v66, v66, s20, v30
    v_mfma_f32_16x16x32_bf16 v[108:111], a[144:147], a[0:3], v[108:111]
    v_exp_f32 v64, v64
    v_mfma_f32_16x16x32_bf16 v[112:115], a[96:99], a[16:19], 0
    v_exp_f32 v65, v65
    v_fma_f32 v67, v67, s20, v30
    v_mfma_f32_16x16x32_bf16 v[112:115], a[100:103], a[20:23], v[112:115]
    v_exp_f32 v66, v66
    v_fma_f32 v68, v68, s20, v30
    v_mfma_f32_16x16x32_bf16 v[112:115], a[104:107], a[24:27], v[112:115]
    v_exp_f32 v67, v67
    v_mfma_f32_16x16x32_bf16 v[112:115], a[108:111], a[28:31], v[112:115]
    buffer_load_dwordx4 v1, s[8:11], s54 offen offset:1024 nt lds
    v_cvt_pk_bf16_f32 v32, v64, v65
    v_mfma_f32_16x16x32_bf16 v[116:119], a[124:127], a[28:31], 0
    v_fma_f32 v69, v69, s20, v30
    v_fma_f32 v70, v70, s20, v30
    v_mfma_f32_16x16x32_bf16 v[116:119], a[120:123], a[24:27], v[116:119]
    v_exp_f32 v68, v68
    v_cvt_pk_bf16_f32 v33, v66, v67
    v_mfma_f32_16x16x32_bf16 v[116:119], a[116:119], a[20:23], v[116:119]
    v_exp_f32 v69, v69
    v_fma_f32 v71, v71, s20, v30
    v_mfma_f32_16x16x32_bf16 v[116:119], a[112:115], a[16:19], v[116:119]
    s_waitcnt vmcnt(11)
    v_exp_f32 v70, v70
    v_mfma_f32_16x16x32_bf16 v[120:123], a[128:131], a[16:19], 0
    s_barrier
    v_fma_f32 v72, v72, s20, v30
    v_exp_f32 v71, v71
    v_mfma_f32_16x16x32_bf16 v[120:123], a[132:135], a[20:23], v[120:123]
    v_cvt_pk_bf16_f32 v34, v68, v69
    v_fma_f32 v73, v73, s20, v30
    v_fma_f32 v74, v74, s20, v30
    v_mfma_f32_16x16x32_bf16 v[120:123], a[136:139], a[24:27], v[120:123]
    v_exp_f32 v72, v72
    v_mfma_f32_16x16x32_bf16 v[120:123], a[140:143], a[28:31], v[120:123]
    s_add_u32 m0, s22, 98304
    v_exp_f32 v73, v73
    v_cvt_pk_bf16_f32 v35, v70, v71
    v_mfma_f32_16x16x32_bf16 v[124:127], a[156:159], a[28:31], 0
    v_fma_f32 v75, v75, s20, v30
    v_fma_f32 v76, v76, s20, v30
    v_mfma_f32_16x16x32_bf16 v[124:127], a[152:155], a[24:27], v[124:127]
    v_exp_f32 v74, v74
    v_cvt_pk_bf16_f32 v36, v72, v73
    v_mfma_f32_16x16x32_bf16 v[124:127], a[148:151], a[20:23], v[124:127]
    v_exp_f32 v75, v75
    v_fma_f32 v77, v77, s20, v30
    v_mfma_f32_16x16x32_bf16 v[124:127], a[144:147], a[16:19], v[124:127]
    buffer_load_dwordx4 v1, s[12:15], s52 offen offset:0 nt lds
    v_mfma_f32_16x16x32_bf16 a[232:235], a[240:243], v[48:51], a[232:235]
    ds_read_b128 a[96:99], v2 offset:16384
    v_exp_f32 v76, v76
    v_mfma_f32_16x16x32_bf16 a[232:235], a[240:243], v[52:55], a[232:235]
    ds_read_b128 a[100:103], v2 offset:16640
    v_fma_f32 v78, v78, s20, v30
    v_cvt_pk_bf16_f32 v37, v74, v75
    v_mfma_f32_16x16x32_bf16 v[192:195], a[164:167], v[52:55], v[192:195]
    v_exp_f32 v77, v77
    v_mfma_f32_16x16x32_bf16 v[192:195], a[160:163], v[48:51], v[192:195]
    ds_read_b128 a[104:107], v2 offset:16896
    v_fma_f32 v79, v79, s20, v30
    v_fma_f32 v80, v80, s20, v31
    v_mfma_f32_16x16x32_bf16 v[196:199], a[168:171], v[48:51], v[196:199]
    v_exp_f32 v78, v78
    v_mfma_f32_16x16x32_bf16 v[196:199], a[172:175], v[52:55], v[196:199]
    ds_read_b128 a[108:111], v2 offset:17152
    v_exp_f32 v79, v79
    v_mfma_f32_16x16x32_bf16 v[200:203], a[180:183], v[52:55], v[200:203]
    ds_read_b128 a[112:115], v2 offset:20480
    v_cvt_pk_bf16_f32 v38, v76, v77
    v_fma_f32 v81, v81, s20, v31
    v_mfma_f32_16x16x32_bf16 v[200:203], a[176:179], v[48:51], v[200:203]
    v_exp_f32 v80, v80
    v_mfma_f32_16x16x32_bf16 v[204:207], a[184:187], v[48:51], v[204:207]
    ds_read_b128 a[116:119], v2 offset:20736
    buffer_load_dwordx4 v1, s[12:15], s52 offen offset:1024 nt lds
    v_mfma_f32_16x16x32_bf16 v[204:207], a[188:191], v[52:55], v[204:207]
    ds_read_b128 a[120:123], v2 offset:20992
    v_fma_f32 v82, v82, s20, v31
    v_mfma_f32_16x16x32_bf16 v[208:211], a[196:199], v[52:55], v[208:211]
    ds_read_b128 a[124:127], v2 offset:21248
    v_exp_f32 v81, v81
    v_mfma_f32_16x16x32_bf16 v[208:211], a[192:195], v[48:51], v[208:211]
    v_cvt_pk_bf16_f32 v39, v78, v79
    v_fma_f32 v83, v83, s20, v31
    v_fma_f32 v84, v84, s20, v31
    v_mfma_f32_16x16x32_bf16 v[212:215], a[200:203], v[48:51], v[212:215]
    v_exp_f32 v82, v82
    v_mfma_f32_16x16x32_bf16 v[212:215], a[204:207], v[52:55], v[212:215]
    ds_read_b128 a[128:131], v2 offset:24576
    v_exp_f32 v83, v83
    v_mfma_f32_16x16x32_bf16 v[216:219], a[212:215], v[52:55], v[216:219]
    ds_read_b128 a[132:135], v2 offset:24832
    v_cvt_pk_bf16_f32 v40, v80, v81
    v_fma_f32 v85, v85, s20, v31
    v_mfma_f32_16x16x32_bf16 v[216:219], a[208:211], v[48:51], v[216:219]
    v_exp_f32 v84, v84
    v_mfma_f32_16x16x32_bf16 v[220:223], a[216:219], v[48:51], v[220:223]
    ds_read_b128 a[136:139], v2 offset:25088
    ds_read_b128 a[140:143], v2 offset:25344
    v_fma_f32 v86, v86, s20, v31
    v_mfma_f32_16x16x32_bf16 v[220:223], a[220:223], v[52:55], v[220:223]
    s_xor_b32 s27, s24, 0
    v_exp_f32 v85, v85
    v_mfma_f32_16x16x32_bf16 a[236:239], a[240:243], v[56:59], a[236:239]
    s_waitcnt lgkmcnt(15)
    ds_read_b128 a[144:147], v2 offset:28672
    buffer_store_dwordx4 a[32:35], v5, s[16:19], s27 offen offset:0 sc1 nt
    v_mfma_f32_16x16x32_bf16 a[236:239], a[240:243], v[60:63], a[236:239]
    ds_read_b128 a[148:151], v2 offset:28928
    v_cvt_pk_bf16_f32 v41, v82, v83
    v_fma_f32 v87, v87, s20, v31
    v_mfma_f32_16x16x32_bf16 v[224:227], a[164:167], v[60:63], v[224:227]
    v_exp_f32 v86, v86
    v_mfma_f32_16x16x32_bf16 v[224:227], a[160:163], v[56:59], v[224:227]
    ds_read_b128 a[152:155], v2 offset:29184
    v_fma_f32 v88, v88, s20, v31
    v_cvt_pk_bf16_f32 v42, v84, v85
    v_mfma_f32_16x16x32_bf16 v[228:231], a[168:171], v[56:59], v[228:231]
    v_exp_f32 v87, v87
    v_mfma_f32_16x16x32_bf16 v[228:231], a[172:175], v[60:63], v[228:231]
    ds_read_b128 a[156:159], v2 offset:29440
    ds_read_b64_tr_b16 a[160:161], v3 offset:0
    v_fma_f32 v89, v89, s20, v31
    v_mfma_f32_16x16x32_bf16 v[232:235], a[180:183], v[60:63], v[232:235]
    ds_read_b64_tr_b16 a[162:163], v3 offset:4096
    v_exp_f32 v88, v88
    v_mfma_f32_16x16x32_bf16 v[232:235], a[176:179], v[56:59], v[232:235]
    v_fma_f32 v90, v90, s20, v31
    v_cvt_pk_bf16_f32 v43, v86, v87
    v_mfma_f32_16x16x32_bf16 v[236:239], a[184:187], v[56:59], v[236:239]
    ds_read_b64_tr_b16 a[164:165], v3 offset:8192
    v_exp_f32 v89, v89
    v_mfma_f32_16x16x32_bf16 v[236:239], a[188:191], v[60:63], v[236:239]
    ds_read_b64_tr_b16 a[166:167], v3 offset:12288
    v_fma_f32 v91, v91, s20, v31
    v_fma_f32 v92, v92, s20, v31
    v_mfma_f32_16x16x32_bf16 v[240:243], a[196:199], v[60:63], v[240:243]
    v_exp_f32 v90, v90
    v_mfma_f32_16x16x32_bf16 v[240:243], a[192:195], v[56:59], v[240:243]
    v_exp_f32 v91, v91
    v_cvt_pk_bf16_f32 v44, v88, v89
    v_mfma_f32_16x16x32_bf16 v[244:247], a[200:203], v[56:59], v[244:247]
    buffer_store_dwordx4 a[36:39], v5, s[16:19], s27 offen offset:1024 sc1 nt
    v_mfma_f32_16x16x32_bf16 v[244:247], a[204:207], v[60:63], v[244:247]
    ds_read_b64_tr_b16 a[168:169], v4 offset:0
    ds_read_b64_tr_b16 a[170:171], v4 offset:4096
    v_fma_f32 v93, v93, s20, v31
    v_mfma_f32_16x16x32_bf16 v[248:251], a[212:215], v[60:63], v[248:251]
    ds_read_b64_tr_b16 a[172:173], v4 offset:8192
    v_exp_f32 v92, v92
    v_mfma_f32_16x16x32_bf16 v[248:251], a[208:211], v[56:59], v[248:251]
    ds_read_b64_tr_b16 a[174:175], v4 offset:12288
    v_fma_f32 v94, v94, s20, v31
    v_mfma_f32_16x16x32_bf16 v[252:255], a[216:219], v[56:59], v[252:255]
    v_exp_f32 v93, v93
    v_cvt_pk_bf16_f32 v45, v90, v91
    v_mfma_f32_16x16x32_bf16 v[252:255], a[220:223], v[60:63], v[252:255]
    v_fma_f32 v95, v95, s20, v31
    v_exp_f32 v94, v94
    v_accvgpr_read_b32 v30, a232
    v_accvgpr_read_b32 v31, a236
    v_cmp_ngt_f32 vcc, 0x53800000, v30
    v_rcp_f32 v30, v30
    s_or_b64 s[28:29], s[28:29], vcc
    v_cmp_ngt_f32 vcc, 0x53800000, v31
    v_rcp_f32 v31, v31
    s_or_b64 s[28:29], s[28:29], vcc
    v_pk_mul_f32 v[192:193], v[192:193], v[30:31] op_sel_hi:[1,0]
    v_pk_mul_f32 v[194:195], v[194:195], v[30:31] op_sel_hi:[1,0]
    v_cvt_pk_bf16_f32 v192, v192, v193
    v_cvt_pk_bf16_f32 v193, v194, v195
    v_pk_mul_f32 v[196:197], v[196:197], v[30:31] op_sel_hi:[1,0]
    v_pk_mul_f32 v[198:199], v[198:199], v[30:31] op_sel_hi:[1,0]
    v_cvt_pk_bf16_f32 v194, v196, v197
    v_cvt_pk_bf16_f32 v195, v198, v199
    ds_write_b128 v6, v[192:195] offset:0
    v_pk_mul_f32 v[200:201], v[200:201], v[30:31] op_sel_hi:[1,0]
    v_pk_mul_f32 v[202:203], v[202:203], v[30:31] op_sel_hi:[1,0]
    v_cvt_pk_bf16_f32 v196, v200, v201
    v_cvt_pk_bf16_f32 v197, v202, v203
    v_pk_mul_f32 v[204:205], v[204:205], v[30:31] op_sel_hi:[1,0]
    v_pk_mul_f32 v[206:207], v[206:207], v[30:31] op_sel_hi:[1,0]
    v_cvt_pk_bf16_f32 v198, v204, v205
    v_cvt_pk_bf16_f32 v199, v206, v207
    ds_write_b128 v9, v[196:199] offset:0
    v_pk_mul_f32 v[208:209], v[208:209], v[30:31] op_sel_hi:[1,0]
    v_pk_mul_f32 v[210:211], v[210:211], v[30:31] op_sel_hi:[1,0]
    v_cvt_pk_bf16_f32 v200, v208, v209
    v_cvt_pk_bf16_f32 v201, v210, v211
    v_pk_mul_f32 v[212:213], v[212:213], v[30:31] op_sel_hi:[1,0]
    v_pk_mul_f32 v[214:215], v[214:215], v[30:31] op_sel_hi:[1,0]
    v_cvt_pk_bf16_f32 v202, v212, v213
    v_cvt_pk_bf16_f32 v203, v214, v215
    ds_write_b128 v6, v[200:203] offset:128
    v_pk_mul_f32 v[216:217], v[216:217], v[30:31] op_sel_hi:[1,0]
    v_pk_mul_f32 v[218:219], v[218:219], v[30:31] op_sel_hi:[1,0]
    v_cvt_pk_bf16_f32 v204, v216, v217
    v_cvt_pk_bf16_f32 v205, v218, v219
    v_pk_mul_f32 v[220:221], v[220:221], v[30:31] op_sel_hi:[1,0]
    v_pk_mul_f32 v[222:223], v[222:223], v[30:31] op_sel_hi:[1,0]
    v_cvt_pk_bf16_f32 v206, v220, v221
    v_cvt_pk_bf16_f32 v207, v222, v223
    ds_write_b128 v9, v[204:207] offset:128
    v_pk_mul_f32 v[224:225], v[224:225], v[30:31] op_sel:[0,1] op_sel_hi:[1,1]
    v_pk_mul_f32 v[226:227], v[226:227], v[30:31] op_sel:[0,1] op_sel_hi:[1,1]
    v_cvt_pk_bf16_f32 v224, v224, v225
    v_cvt_pk_bf16_f32 v225, v226, v227
    v_pk_mul_f32 v[228:229], v[228:229], v[30:31] op_sel:[0,1] op_sel_hi:[1,1]
    v_pk_mul_f32 v[230:231], v[230:231], v[30:31] op_sel:[0,1] op_sel_hi:[1,1]
    v_cvt_pk_bf16_f32 v226, v228, v229
    v_cvt_pk_bf16_f32 v227, v230, v231
    ds_write_b128 v6, v[224:227] offset:4096
    v_pk_mul_f32 v[232:233], v[232:233], v[30:31] op_sel:[0,1] op_sel_hi:[1,1]
    v_pk_mul_f32 v[234:235], v[234:235], v[30:31] op_sel:[0,1] op_sel_hi:[1,1]
    v_cvt_pk_bf16_f32 v228, v232, v233
    v_cvt_pk_bf16_f32 v229, v234, v235
    v_pk_mul_f32 v[236:237], v[236:237], v[30:31] op_sel:[0,1] op_sel_hi:[1,1]
    v_pk_mul_f32 v[238:239], v[238:239], v[30:31] op_sel:[0,1] op_sel_hi:[1,1]
    v_cvt_pk_bf16_f32 v230, v236, v237
    v_cvt_pk_bf16_f32 v231, v238, v239
    ds_write_b128 v9, v[228:231] offset:4096
    v_pk_mul_f32 v[240:241], v[240:241], v[30:31] op_sel:[0,1] op_sel_hi:[1,1]
    v_pk_mul_f32 v[242:243], v[242:243], v[30:31] op_sel:[0,1] op_sel_hi:[1,1]
    v_cvt_pk_bf16_f32 v232, v240, v241
    v_cvt_pk_bf16_f32 v233, v242, v243
    v_pk_mul_f32 v[244:245], v[244:245], v[30:31] op_sel:[0,1] op_sel_hi:[1,1]
    v_pk_mul_f32 v[246:247], v[246:247], v[30:31] op_sel:[0,1] op_sel_hi:[1,1]
    v_cvt_pk_bf16_f32 v234, v244, v245
    v_cvt_pk_bf16_f32 v235, v246, v247
    ds_write_b128 v6, v[232:235] offset:4224
    v_pk_mul_f32 v[248:249], v[248:249], v[30:31] op_sel:[0,1] op_sel_hi:[1,1]
    v_pk_mul_f32 v[250:251], v[250:251], v[30:31] op_sel:[0,1] op_sel_hi:[1,1]
    v_cvt_pk_bf16_f32 v236, v248, v249
    v_cvt_pk_bf16_f32 v237, v250, v251
    v_pk_mul_f32 v[252:253], v[252:253], v[30:31] op_sel:[0,1] op_sel_hi:[1,1]
    v_pk_mul_f32 v[254:255], v[254:255], v[30:31] op_sel:[0,1] op_sel_hi:[1,1]
    v_cvt_pk_bf16_f32 v238, v252, v253
    v_cvt_pk_bf16_f32 v239, v254, v255
    ds_write_b128 v9, v[236:239] offset:4224
    s_waitcnt lgkmcnt(15)
L_n17:
    v_mfma_f32_16x16x32_bf16 v[64:67], a[96:99], a[64:67], v[12:15]
    v_exp_f32 v95, v95
    v_mfma_f32_16x16x32_bf16 v[64:67], a[100:103], a[68:71], v[64:67]
    ds_read_b64_tr_b16 a[176:177], v3 offset:256
    ds_read_b64_tr_b16 a[178:179], v3 offset:4352
    v_cvt_pk_bf16_f32 v46, v92, v93
    v_mfma_f32_16x16x32_bf16 v[64:67], a[104:107], a[72:75], v[64:67]
    ds_read_b64_tr_b16 a[180:181], v3 offset:8448
    v_cvt_pk_bf16_f32 v47, v94, v95
    v_mfma_f32_16x16x32_bf16 v[64:67], a[108:111], a[76:79], v[64:67]
    ds_read_b64_tr_b16 a[182:183], v3 offset:12544
    v_max3_f32 v23, v96, v97, v98
    v_max3_f32 v27, v112, v113, v114
    v_mfma_f32_16x16x32_bf16 v[68:71], a[124:127], a[76:79], v[12:15]
    ds_read_b64_tr_b16 a[184:185], v4 offset:256
    v_max3_f32 v23, v23, v99, v100
    v_mfma_f32_16x16x32_bf16 v[68:71], a[120:123], a[72:75], v[68:71]
    ds_read_b64_tr_b16 a[186:187], v4 offset:4352
    v_max3_f32 v27, v27, v115, v116
    v_max3_f32 v23, v23, v101, v102
    v_mfma_f32_16x16x32_bf16 v[68:71], a[116:119], a[68:71], v[68:71]
    ds_read_b64_tr_b16 a[188:189], v4 offset:8448
    v_max3_f32 v27, v27, v117, v118
    v_max_f32 v23, v23, v103
    v_mfma_f32_16x16x32_bf16 v[68:71], a[112:115], a[64:67], v[68:71]
    ds_read_b64_tr_b16 a[190:191], v4 offset:12544
    v_max_f32 v27, v27, v119
    v_mfma_f32_16x16x32_bf16 v[72:75], a[128:131], a[64:67], v[12:15]
    s_add_u32 m0, s22, 57344
    ds_read_b64_tr_b16 a[192:193], v3 offset:512
    v_mov_b32 v28, v23
    v_mov_b32 v29, v27
    v_mfma_f32_16x16x32_bf16 v[72:75], a[132:135], a[68:71], v[72:75]
    ds_read_b64_tr_b16 a[194:195], v3 offset:4608
    v_permlane32_swap_b32 v28, v23
    v_mfma_f32_16x16x32_bf16 v[72:75], a[136:139], a[72:75], v[72:75]
    buffer_load_dwordx4 v1, s[8:11], s55 offen offset:0 nt lds
    ds_read_b64_tr_b16 a[196:197], v3 offset:8704
    v_mfma_f32_16x16x32_bf16 v[72:75], a[140:143], a[76:79], v[72:75]
    ds_read_b64_tr_b16 a[198:199], v3 offset:12800
    v_permlane32_swap_b32 v29, v27
    v_max_f32 v23, v23, v28
    v_mfma_f32_16x16x32_bf16 v[76:79], a[156:159], a[76:79], v[12:15]
    v_max_f32 v27, v27, v29
    v_mov_b32 v28, v23
    v_mfma_f32_16x16x32_bf16 v[76:79], a[152:155], a[72:75], v[76:79]
    ds_read_b64_tr_b16 a[200:201], v4 offset:512
    v_mov_b32 v29, v27
    v_permlane16_swap_b32 v28, v23
    v_mfma_f32_16x16x32_bf16 v[76:79], a[148:151], a[68:71], v[76:79]
    ds_read_b64_tr_b16 a[202:203], v4 offset:4608
    v_permlane16_swap_b32 v29, v27
    v_mfma_f32_16x16x32_bf16 v[76:79], a[144:147], a[64:67], v[76:79]
    ds_read_b64_tr_b16 a[204:205], v4 offset:8704
    v_max_f32 v23, v23, v28
    v_max_f32 v27, v27, v29
    v_mfma_f32_16x16x32_bf16 v[80:83], a[96:99], a[80:83], v[16:19]
    ds_read_b64_tr_b16 a[206:207], v4 offset:12800
    v_mul_f32 v30, 0xbe0293ee, v23
    v_sub_f32 v20, 0, v23
    v_mfma_f32_16x16x32_bf16 v[80:83], a[100:103], a[84:87], v[80:83]
    ds_read_b64_tr_b16 a[208:209], v3 offset:768
    v_sub_f32 v21, 0, v23
    v_mfma_f32_16x16x32_bf16 v[80:83], a[104:107], a[88:91], v[80:83]
    ds_read_b64_tr_b16 a[210:211], v3 offset:4864
    v_sub_f32 v22, 0, v23
    v_sub_f32 v23, 0, v23
    v_mfma_f32_16x16x32_bf16 v[80:83], a[108:111], a[92:95], v[80:83]
    ds_read_b64_tr_b16 a[212:213], v3 offset:8960
    v_mul_f32 v31, 0xbe0293ee, v27
    v_mfma_f32_16x16x32_bf16 v[84:87], a[124:127], a[92:95], v[16:19]
    ds_read_b64_tr_b16 a[214:215], v3 offset:13056
    v_sub_f32 v24, 0, v27
    v_sub_f32 v25, 0, v27
    v_mfma_f32_16x16x32_bf16 v[84:87], a[120:123], a[88:91], v[84:87]
    ds_read_b64_tr_b16 a[216:217], v4 offset:768
    v_sub_f32 v26, 0, v27
    v_mfma_f32_16x16x32_bf16 v[84:87], a[116:119], a[84:87], v[84:87]
    buffer_load_dwordx4 v1, s[8:11], s55 offen offset:1024 nt lds
    ds_read_b64_tr_b16 a[218:219], v4 offset:4864
    v_mfma_f32_16x16x32_bf16 v[84:87], a[112:115], a[80:83], v[84:87]
    ds_read_b64_tr_b16 a[220:221], v4 offset:8960
    v_sub_f32 v27, 0, v27
    v_fma_f32 v96, v96, s20, v30
    v_mfma_f32_16x16x32_bf16 v[88:91], a[128:131], a[80:83], v[16:19]
    ds_read_b64_tr_b16 a[222:223], v4 offset:13056
    v_fma_f32 v97, v97, s20, v30
    v_mfma_f32_16x16x32_bf16 v[88:91], a[132:135], a[84:87], v[88:91]
    v_exp_f32 v96, v96
    v_fma_f32 v98, v98, s20, v30
    v_mfma_f32_16x16x32_bf16 v[88:91], a[136:139], a[88:91], v[88:91]
    v_exp_f32 v97, v97
    v_mfma_f32_16x16x32_bf16 v[88:91], a[140:143], a[92:95], v[88:91]
    v_fma_f32 v99, v99, s20, v30
    v_exp_f32 v98, v98
    v_mfma_f32_16x16x32_bf16 v[92:95], a[156:159], a[92:95], v[16:19]
    v_fma_f32 v100, v100, s20, v30
    v_exp_f32 v99, v99
    v_mfma_f32_16x16x32_bf16 v[92:95], a[152:155], a[88:91], v[92:95]
    v_cvt_pk_bf16_f32 v48, v96, v97
    v_fma_f32 v101, v101, s20, v30
    v_mfma_f32_16x16x32_bf16 v[92:95], a[148:151], a[84:87], v[92:95]
    v_exp_f32 v100, v100
    v_fma_f32 v102, v102, s20, v30
    v_mfma_f32_16x16x32_bf16 v[92:95], a[144:147], a[80:83], v[92:95]
    s_waitcnt lgkmcnt(0)
    v_exp_f32 v101, v101
    v_mfma_f32_16x16x32_bf16 a[224:227], a[240:243], v[32:35], 0
    s_add_u32 m0, s22, 106496
    v_cvt_pk_bf16_f32 v49, v98, v99
    v_fma_f32 v103, v103, s20, v30
    v_fma_f32 v104, v104, s20, v30
    v_mfma_f32_16x16x32_bf16 a[224:227], a[240:243], v[36:39], a[224:227]
    v_exp_f32 v102, v102
    v_cvt_pk_bf16_f32 v50, v100, v101
    v_mfma_f32_16x16x32_bf16 v[128:131], a[164:167], v[36:39], 0
    v_exp_f32 v103, v103
    v_mfma_f32_16x16x32_bf16 v[128:131], a[160:163], v[32:35], v[128:131]
    buffer_load_dwordx4 v1, s[12:15], s53 offen offset:0 nt lds
    v_fma_f32 v105, v105, s20, v30
    v_mfma_f32_16x16x32_bf16 v[132:135], a[168:171], v[32:35], 0
    v_exp_f32 v104, v104
    v_mfma_f32_16x16x32_bf16 v[132:135], a[172:175], v[36:39], v[132:135]
    v_fma_f32 v106, v106, s20, v30
    v_exp_f32 v105, v105
    v_mfma_f32_16x16x32_bf16 v[136:139], a[180:183], v[36:39], 0
    v_cvt_pk_bf16_f32 v51, v102, v103
    v_fma_f32 v107, v107, s20, v30
    v_mfma_f32_16x16x32_bf16 v[136:139], a[176:179], v[32:35], v[136:139]
    v_exp_f32 v106, v106
    v_fma_f32 v108, v108, s20, v30
    v_mfma_f32_16x16x32_bf16 v[140:143], a[184:187], v[32:35], 0
    v_exp_f32 v107, v107
    v_cvt_pk_bf16_f32 v52, v104, v105
    v_mfma_f32_16x16x32_bf16 v[140:143], a[188:191], v[36:39], v[140:143]
    v_fma_f32 v109, v109, s20, v30
    v_fma_f32 v110, v110, s20, v30
    v_mfma_f32_16x16x32_bf16 v[144:147], a[196:199], v[36:39], 0
    v_exp_f32 v108, v108
    v_cvt_pk_bf16_f32 v53, v106, v107
    v_mfma_f32_16x16x32_bf16 v[144:147], a[192:195], v[32:35], v[144:147]
    v_exp_f32 v109, v109
    v_mfma_f32_16x16x32_bf16 v[148:151], a[200:203], v[32:35], 0
    v_fma_f32 v111, v111, s20, v30
    v_exp_f32 v110, v110
    v_mfma_f32_16x16x32_bf16 v[148:151], a[204:207], v[36:39], v[148:151]
    v_fma_f32 v112, v112, s20, v31
    v_exp_f32 v111, v111
    v_mfma_f32_16x16x32_bf16 v[152:155], a[212:215], v[36:39], 0
    v_cvt_pk_bf16_f32 v54, v108, v109
    v_fma_f32 v113, v113, s20, v31
    v_mfma_f32_16x16x32_bf16 v[152:155], a[208:211], v[32:35], v[152:155]
    v_exp_f32 v112, v112
    v_fma_f32 v114, v114, s20, v31
    v_mfma_f32_16x16x32_bf16 v[156:159], a[216:219], v[32:35], 0
    buffer_load_dwordx4 v1, s[12:15], s53 offen offset:1024 nt lds
    v_mfma_f32_16x16x32_bf16 v[156:159], a[220:223], v[36:39], v[156:159]
L_pad5:
    s_cbranch_execz L_back1
    v_exp_f32 v113, v113
    v_cvt_pk_bf16_f32 v55, v110, v111
    v_mfma_f32_16x16x32_bf16 a[228:231], a[240:243], v[40:43], 0
    v_fma_f32 v115, v115, s20, v31
    v_exp_f32 v114, v114
    v_mfma_f32_16x16x32_bf16 a[228:231], a[240:243], v[44:47], a[228:231]
    v_fma_f32 v116, v116, s20, v31
    v_cvt_pk_bf16_f32 v56, v112, v113
    v_mfma_f32_16x16x32_bf16 v[160:163], a[164:167], v[44:47], 0
    v_exp_f32 v115, v115
    v_fma_f32 v117, v117, s20, v31
    v_mfma_f32_16x16x32_bf16 v[160:163], a[160:163], v[40:43], v[160:163]
    v_exp_f32 v116, v116
    v_mfma_f32_16x16x32_bf16 v[164:167], a[168:171], v[40:43], 0
    v_fma_f32 v118, v118, s20, v31
    v_exp_f32 v117, v117
    v_mfma_f32_16x16x32_bf16 v[164:167], a[172:175], v[44:47], v[164:167]
    v_cvt_pk_bf16_f32 v57, v114, v115
    v_fma_f32 v119, v119, s20, v31
    v_mfma_f32_16x16x32_bf16 v[168:171], a[180:183], v[44:47], 0
    v_exp_f32 v118, v118
    v_fma_f32 v120, v120, s20, v31
    v_mfma_f32_16x16x32_bf16 v[168:171], a[176:179], v[40:43], v[168:171]
    v_exp_f32 v119, v119
    v_cvt_pk_bf16_f32 v58, v116, v117
    v_mfma_f32_16x16x32_bf16 v[172:175], a[184:187], v[40:43], 0
    v_fma_f32 v121, v121, s20, v31
    v_fma_f32 v122, v122, s20, v31
    v_mfma_f32_16x16x32_bf16 v[172:175], a[188:191], v[44:47], v[172:175]
    v_exp_f32 v120, v120
    v_cvt_pk_bf16_f32 v59, v118, v119
    v_mfma_f32_16x16x32_bf16 v[176:179], a[196:199], v[44:47], 0
    buffer_store_dwordx4 a[40:43], v5, s[16:19], s27 offen offset:2048 sc1 nt
    v_mfma_f32_16x16x32_bf16 v[176:179], a[192:195], v[40:43], v[176:179]
    v_exp_f32 v121, v121
    v_fma_f32 v123, v123, s20, v31
    v_mfma_f32_16x16x32_bf16 v[180:183], a[200:203], v[40:43], 0
    v_exp_f32 v122, v122
    v_fma_f32 v124, v124, s20, v31
    v_mfma_f32_16x16x32_bf16 v[180:183], a[204:207], v[44:47], v[180:183]
    v_exp_f32 v123, v123
    v_mfma_f32_16x16x32_bf16 v[184:187], a[212:215], v[44:47], 0
    v_cvt_pk_bf16_f32 v60, v120, v121
    v_fma_f32 v125, v125, s20, v31
    v_fma_f32 v126, v126, s20, v31
    v_mfma_f32_16x16x32_bf16 v[184:187], a[208:211], v[40:43], v[184:187]
    v_exp_f32 v124, v124
    v_mfma_f32_16x16x32_bf16 v[188:191], a[216:219], v[40:43], 0
    v_exp_f32 v125, v125
    v_cvt_pk_bf16_f32 v61, v122, v123
    v_mfma_f32_16x16x32_bf16 v[188:191], a[220:223], v[44:47], v[188:191]
    v_fma_f32 v127, v127, s20, v31
    v_exp_f32 v126, v126
L_n18:
    v_mfma_f32_16x16x32_bf16 v[96:99], a[96:99], a[0:3], v[20:23]
    v_exp_f32 v127, v127
    v_mfma_f32_16x16x32_bf16 v[96:99], a[100:103], a[4:7], v[96:99]
    v_cvt_pk_bf16_f32 v62, v124, v125
    v_cvt_pk_bf16_f32 v63, v126, v127
    v_mfma_f32_16x16x32_bf16 v[96:99], a[104:107], a[8:11], v[96:99]
    v_mul_f32 v64, s20, v64
    v_mul_f32 v65, s20, v65
    v_mfma_f32_16x16x32_bf16 v[96:99], a[108:111], a[12:15], v[96:99]
    v_exp_f32 v64, v64
    v_mfma_f32_16x16x32_bf16 v[100:103], a[124:127], a[12:15], v[20:23]
    v_mul_f32 v66, s20, v66
    v_mul_f32 v67, s20, v67
    v_mfma_f32_16x16x32_bf16 v[100:103], a[120:123], a[8:11], v[100:103]
    v_exp_f32 v65, v65
    v_mfma_f32_16x16x32_bf16 v[100:103], a[116:119], a[4:7], v[100:103]
    v_exp_f32 v66, v66
    v_mul_f32 v68, s20, v68
    v_mfma_f32_16x16x32_bf16 v[100:103], a[112:115], a[0:3], v[100:103]
    s_add_u32 m0, s22, 0
    v_exp_f32 v67, v67
    v_mfma_f32_16x16x32_bf16 v[104:107], a[128:131], a[0:3], v[20:23]
    v_cvt_pk_bf16_f32 v32, v64, v65
    v_mul_f32 v69, s20, v69
    v_mfma_f32_16x16x32_bf16 v[104:107], a[132:135], a[4:7], v[104:107]
    v_exp_f32 v68, v68
    v_mfma_f32_16x16x32_bf16 v[104:107], a[136:139], a[8:11], v[104:107]
    buffer_load_dwordx4 v1, s[8:11], s56 offen offset:0 nt lds
    v_mfma_f32_16x16x32_bf16 v[104:107], a[140:143], a[12:15], v[104:107]
    v_mul_f32 v70, s20, v70
    v_cvt_pk_bf16_f32 v33, v66, v67
    v_mfma_f32_16x16x32_bf16 v[108:111], a[156:159], a[12:15], v[20:23]
    v_exp_f32 v69, v69
    v_mfma_f32_16x16x32_bf16 v[108:111], a[152:155], a[8:11], v[108:111]
    v_mul_f32 v71, s20, v71
    v_exp_f32 v70, v70
    v_mfma_f32_16x16x32_bf16 v[108:111], a[148:151], a[4:7], v[108:111]
    v_mul_f32 v72, s20, v72
    v_cvt_pk_bf16_f32 v34, v68, v69
    v_mfma_f32_16x16x32_bf16 v[108:111], a[144:147], a[0:3], v[108:111]
    v_exp_f32 v71, v71
    v_mfma_f32_16x16x32_bf16 v[112:115], a[96:99], a[16:19], v[24:27]
    v_mul_f32 v73, s20, v73
    v_mul_f32 v74, s20, v74
    v_mfma_f32_16x16x32_bf16 v[112:115], a[100:103], a[20:23], v[112:115]
    v_exp_f32 v72, v72
    v_mfma_f32_16x16x32_bf16 v[112:115], a[104:107], a[24:27], v[112:115]
    v_exp_f32 v73, v73
    v_mfma_f32_16x16x32_bf16 v[112:115], a[108:111], a[28:31], v[112:115]
    v_cvt_pk_bf16_f32 v35, v70, v71
    v_mul_f32 v75, s20, v75
    v_mfma_f32_16x16x32_bf16 v[116:119], a[124:127], a[28:31], v[24:27]
    v_exp_f32 v74, v74
    v_mul_f32 v76, s20, v76
    v_mfma_f32_16x16x32_bf16 v[116:119], a[120:123], a[24:27], v[116:119]
    v_exp_f32 v75, v75
    v_mfma_f32_16x16x32_bf16 v[116:119], a[116:119], a[20:23], v[116:119]
    buffer_load_dwordx4 v1, s[8:11], s56 offen offset:1024 nt lds
    v_mfma_f32_16x16x32_bf16 v[116:119], a[112:115], a[16:19], v[116:119]
    s_waitcnt vmcnt(14)
    v_cvt_pk_bf16_f32 v36, v72, v73
    v_mul_f32 v77, s20, v77
    v_mfma_f32_16x16x32_bf16 v[120:123], a[128:131], a[16:19], v[24:27]
    s_barrier
    v_exp_f32 v76, v76
    v_mfma_f32_16x16x32_bf16 v[120:123], a[132:135], a[20:23], v[120:123]
    v_mul_f32 v78, s20, v78
    v_cvt_pk_bf16_f32 v37, v74, v75
    v_mfma_f32_16x16x32_bf16 v[120:123], a[136:139], a[24:27], v[120:123]
    v_exp_f32 v77, v77
    v_mfma_f32_16x16x32_bf16 v[120:123], a[140:143], a[28:31], v[120:123]
    v_mul_f32 v79, s20, v79
    v_exp_f32 v78, v78
    v_mfma_f32_16x16x32_bf16 v[124:127], a[156:159], a[28:31], v[24:27]
    v_mul_f32 v80, s20, v80
    v_cvt_pk_bf16_f32 v38, v76, v77
    v_mfma_f32_16x16x32_bf16 v[124:127], a[152:155], a[24:27], v[124:127]
    v_exp_f32 v79, v79
    v_mfma_f32_16x16x32_bf16 v[124:127], a[148:151], a[20:23], v[124:127]
    v_mul_f32 v81, s20, v81
    v_mul_f32 v82, s20, v82
    v_mfma_f32_16x16x32_bf16 v[124:127], a[144:147], a[16:19], v[124:127]
    v_exp_f32 v80, v80
    v_mfma_f32_16x16x32_bf16 a[232:235], a[240:243], v[48:51], 0
    v_exp_f32 v81, v81
    v_mfma_f32_16x16x32_bf16 a[232:235], a[240:243], v[52:55], a[232:235]
    ds_read_b128 a[96:99], v2 offset:32768
    v_cvt_pk_bf16_f32 v39, v78, v79
    v_mul_f32 v83, s20, v83
    v_mfma_f32_16x16x32_bf16 v[192:195], a[164:167], v[52:55], 0
    s_add_u32 m0, s22, 114688
    ds_read_b128 a[100:103], v2 offset:33024
    v_mul_f32 v84, s20, v84
    v_mfma_f32_16x16x32_bf16 v[192:195], a[160:163], v[48:51], v[192:195]
    buffer_load_dwordx4 v1, s[12:15], s54 offen offset:0 nt lds
    v_mfma_f32_16x16x32_bf16 v[196:199], a[168:171], v[48:51], 0
    ds_read_b128 a[104:107], v2 offset:33280
    ds_read_b128 a[108:111], v2 offset:33536
    v_mfma_f32_16x16x32_bf16 v[196:199], a[172:175], v[52:55], v[196:199]
    v_exp_f32 v82, v82
    v_mfma_f32_16x16x32_bf16 v[200:203], a[180:183], v[52:55], 0
    v_exp_f32 v83, v83
    v_mfma_f32_16x16x32_bf16 v[200:203], a[176:179], v[48:51], v[200:203]
    ds_read_b128 a[112:115], v2 offset:36864
    ds_read_b128 a[116:119], v2 offset:37120
    v_mfma_f32_16x16x32_bf16 v[204:207], a[184:187], v[48:51], 0
    v_cvt_pk_bf16_f32 v40, v80, v81
    v_mul_f32 v85, s20, v85
    v_mul_f32 v86, s20, v86
    v_mfma_f32_16x16x32_bf16 v[204:207], a[188:191], v[52:55], v[204:207]
    v_exp_f32 v84, v84
    v_mfma_f32_16x16x32_bf16 v[208:211], a[196:199], v[52:55], 0
    ds_read_b128 a[120:123], v2 offset:37376
    ds_read_b128 a[124:127], v2 offset:37632
    v_mfma_f32_16x16x32_bf16 v[208:211], a[192:195], v[48:51], v[208:211]
    v_exp_f32 v85, v85
    v_mfma_f32_16x16x32_bf16 v[212:215], a[200:203], v[48:51], 0
    ds_read_b128 a[128:131], v2 offset:40960
    v_cvt_pk_bf16_f32 v41, v82, v83
    v_mfma_f32_16x16x32_bf16 v[212:215], a[204:207], v[52:55], v[212:215]
    ds_read_b128 a[132:135], v2 offset:41216
    v_mul_f32 v87, s20, v87
    v_mfma_f32_16x16x32_bf16 v[216:219], a[212:215], v[52:55], 0
    v_exp_f32 v86, v86
    v_mfma_f32_16x16x32_bf16 v[216:219], a[208:211], v[48:51], v[216:219]
    ds_read_b128 a[136:139], v2 offset:41472
    buffer_load_dwordx4 v1, s[12:15], s54 offen offset:1024 nt lds
    v_mfma_f32_16x16x32_bf16 v[220:223], a[216:219], v[48:51], 0
    ds_read_b128 a[140:143], v2 offset:41728
    v_mul_f32 v88, s20, v88
    v_mfma_f32_16x16x32_bf16 v[220:223], a[220:223], v[52:55], v[220:223]
    v_exp_f32 v87, v87
    v_mfma_f32_16x16x32_bf16 a[236:239], a[240:243], v[56:59], 0
    ds_read_b128 a[144:147], v2 offset:45056
    v_cvt_pk_bf16_f32 v42, v84, v85
    v_mfma_f32_16x16x32_bf16 a[236:239], a[240:243], v[60:63], a[236:239]
    ds_read_b128 a[148:151], v2 offset:45312
    v_mul_f32 v89, s20, v89
    v_mfma_f32_16x16x32_bf16 v[224:227], a[164:167], v[60:63], 0
    v_exp_f32 v88, v88
    v_mfma_f32_16x16x32_bf16 v[224:227], a[160:163], v[56:59], v[224:227]
    ds_read_b128 a[152:155], v2 offset:45568
    v_mul_f32 v90, s20, v90
    v_mfma_f32_16x16x32_bf16 v[228:231], a[168:171], v[56:59], 0
    ds_read_b128 a[156:159], v2 offset:45824
    v_exp_f32 v89, v89
    v_mfma_f32_16x16x32_bf16 v[228:231], a[172:175], v[60:63], v[228:231]
    ds_read_b64_tr_b16 a[160:161], v3 offset:16384
    v_cvt_pk_bf16_f32 v43, v86, v87
    v_mfma_f32_16x16x32_bf16 v[232:235], a[180:183], v[60:63], 0
    ds_read_b64_tr_b16 a[162:163], v3 offset:20480
    v_mul_f32 v91, s20, v91
    v_mfma_f32_16x16x32_bf16 v[232:235], a[176:179], v[56:59], v[232:235]
    v_exp_f32 v90, v90
    v_mfma_f32_16x16x32_bf16 v[236:239], a[184:187], v[56:59], 0
    ds_read_b64_tr_b16 a[164:165], v3 offset:24576
    v_mul_f32 v92, s20, v92
    v_mfma_f32_16x16x32_bf16 v[236:239], a[188:191], v[60:63], v[236:239]
    v_exp_f32 v91, v91
    v_mfma_f32_16x16x32_bf16 v[240:243], a[196:199], v[60:63], 0
    ds_read_b64_tr_b16 a[166:167], v3 offset:28672
    v_cvt_pk_bf16_f32 v44, v88, v89
    v_mfma_f32_16x16x32_bf16 v[240:243], a[192:195], v[56:59], v[240:243]
    buffer_store_dwordx4 a[44:47], v5, s[16:19], s27 offen offset:3072 sc1 nt
    ds_read_b64_tr_b16 a[168:169], v4 offset:16384
    v_mfma_f32_16x16x32_bf16 v[244:247], a[200:203], v[56:59], 0
    ds_read_b64_tr_b16 a[170:171], v4 offset:20480
    v_mul_f32 v93, s20, v93
    v_mfma_f32_16x16x32_bf16 v[244:247], a[204:207], v[60:63], v[244:247]
    v_exp_f32 v92, v92
    v_mfma_f32_16x16x32_bf16 v[248:251], a[212:215], v[60:63], 0
    ds_read_b64_tr_b16 a[172:173], v4 offset:24576
    v_mul_f32 v94, s20, v94
    v_mfma_f32_16x16x32_bf16 v[248:251], a[208:211], v[56:59], v[248:251]
    v_exp_f32 v93, v93
    v_mfma_f32_16x16x32_bf16 v[252:255], a[216:219], v[56:59], 0
    ds_read_b64_tr_b16 a[174:175], v4 offset:28672
    v_cvt_pk_bf16_f32 v45, v90, v91
    v_mfma_f32_16x16x32_bf16 v[252:255], a[220:223], v[60:63], v[252:255]
    s_waitcnt lgkmcnt(8)
    v_mul_f32 v95, s20, v95
    v_exp_f32 v94, v94
L_n19:
    v_mfma_f32_16x16x32_bf16 v[64:67], a[96:99], a[64:67], v[12:15]
    v_exp_f32 v95, v95
    v_mfma_f32_16x16x32_bf16 v[64:67], a[100:103], a[68:71], v[64:67]
    ds_read_b64_tr_b16 a[176:177], v3 offset:16640
    ds_read_b64_tr_b16 a[178:179], v3 offset:20736
    v_mfma_f32_16x16x32_bf16 v[64:67], a[104:107], a[72:75], v[64:67]
    ds_read_b64_tr_b16 a[180:181], v3 offset:24832
    v_cvt_pk_bf16_f32 v46, v92, v93
    v_mfma_f32_16x16x32_bf16 v[64:67], a[108:111], a[76:79], v[64:67]
    ds_read_b64_tr_b16 a[182:183], v3 offset:28928
    v_cvt_pk_bf16_f32 v47, v94, v95
    v_mfma_f32_16x16x32_bf16 v[68:71], a[124:127], a[76:79], v[12:15]
    ds_read_b64_tr_b16 a[184:185], v4 offset:16640
    v_mul_f32 v96, s20, v96
    v_mul_f32 v97, s20, v97
    v_mfma_f32_16x16x32_bf16 v[68:71], a[120:123], a[72:75], v[68:71]
    v_exp_f32 v96, v96
    v_mfma_f32_16x16x32_bf16 v[68:71], a[116:119], a[68:71], v[68:71]
    ds_read_b64_tr_b16 a[186:187], v4 offset:20736
    ds_read_b64_tr_b16 a[188:189], v4 offset:24832
    v_mfma_f32_16x16x32_bf16 v[68:71], a[112:115], a[64:67], v[68:71]
    s_add_u32 m0, s22, 8192
    ds_read_b64_tr_b16 a[190:191], v4 offset:28928
    v_mul_f32 v98, s20, v98
    v_mfma_f32_16x16x32_bf16 v[72:75], a[128:131], a[64:67], v[12:15]
    ds_read_b64_tr_b16 a[192:193], v3 offset:16896
    v_exp_f32 v97, v97
    v_mfma_f32_16x16x32_bf16 v[72:75], a[132:135], a[68:71], v[72:75]
    buffer_load_dwordx4 v1, s[8:11], s57 offen offset:0 nt lds
    v_mfma_f32_16x16x32_bf16 v[72:75], a[136:139], a[72:75], v[72:75]
    ds_read_b64_tr_b16 a[194:195], v3 offset:20992
    ds_read_b64_tr_b16 a[196:197], v3 offset:25088
    v_mfma_f32_16x16x32_bf16 v[72:75], a[140:143], a[76:79], v[72:75]
    ds_read_b64_tr_b16 a[198:199], v3 offset:29184
    v_mul_f32 v99, s20, v99
    v_mfma_f32_16x16x32_bf16 v[76:79], a[156:159], a[76:79], v[12:15]
    v_exp_f32 v98, v98
    v_mul_f32 v100, s20, v100
    v_mfma_f32_16x16x32_bf16 v[76:79], a[152:155], a[72:75], v[76:79]
    v_exp_f32 v99, v99
    v_mfma_f32_16x16x32_bf16 v[76:79], a[148:151], a[68:71], v[76:79]
    ds_read_b64_tr_b16 a[200:201], v4 offset:16896
    ds_read_b64_tr_b16 a[202:203], v4 offset:20992
    v_mfma_f32_16x16x32_bf16 v[76:79], a[144:147], a[64:67], v[76:79]
    ds_read_b64_tr_b16 a[204:205], v4 offset:25088
    v_cvt_pk_bf16_f32 v48, v96, v97
    v_mfma_f32_16x16x32_bf16 v[80:83], a[96:99], a[80:83], v[16:19]
    ds_read_b64_tr_b16 a[206:207], v4 offset:29184
    v_mul_f32 v101, s20, v101
    v_mul_f32 v102, s20, v102
    v_mfma_f32_16x16x32_bf16 v[80:83], a[100:103], a[84:87], v[80:83]
    v_exp_f32 v100, v100
    v_mfma_f32_16x16x32_bf16 v[80:83], a[104:107], a[88:91], v[80:83]
    ds_read_b64_tr_b16 a[208:209], v3 offset:17152
    ds_read_b64_tr_b16 a[210:211], v3 offset:21248
    v_mfma_f32_16x16x32_bf16 v[80:83], a[108:111], a[92:95], v[80:83]
    buffer_load_dwordx4 v1, s[8:11], s57 offen offset:1024 nt lds
    v_mfma_f32_16x16x32_bf16 v[84:87], a[124:127], a[92:95], v[16:19]
    ds_read_b64_tr_b16 a[212:213], v3 offset:25344
    ds_read_b64_tr_b16 a[214:215], v3 offset:29440
    v_mfma_f32_16x16x32_bf16 v[84:87], a[120:123], a[88:91], v[84:87]
    ds_read_b64_tr_b16 a[216:217], v4 offset:17152
    v_exp_f32 v101, v101
    v_mfma_f32_16x16x32_bf16 v[84:87], a[116:119], a[84:87], v[84:87]
    ds_read_b64_tr_b16 a[218:219], v4 offset:21248
    v_cvt_pk_bf16_f32 v49, v98, v99
    v_mfma_f32_16x16x32_bf16 v[84:87], a[112:115], a[80:83], v[84:87]
    ds_read_b64_tr_b16 a[220:221], v4 offset:25344
    v_mul_f32 v103, s20, v103
    v_mfma_f32_16x16x32_bf16 v[88:91], a[128:131], a[80:83], v[16:19]
    v_exp_f32 v102, v102
    v_mfma_f32_16x16x32_bf16 v[88:91], a[132:135], a[84:87], v[88:91]
    ds_read_b64_tr_b16 a[222:223], v4 offset:29440
    v_mul_f32 v104, s20, v104
    v_cvt_pk_bf16_f32 v50, v100, v101
    v_mfma_f32_16x16x32_bf16 v[88:91], a[136:139], a[88:91], v[88:91]
    v_exp_f32 v103, v103
    v_mfma_f32_16x16x32_bf16 v[88:91], a[140:143], a[92:95], v[88:91]
    s_add_u32 m0, s22, 122880
    v_mul_f32 v105, s20, v105
    v_mul_f32 v106, s20, v106
    v_mfma_f32_16x16x32_bf16 v[92:95], a[156:159], a[92:95], v[16:19]
    v_exp_f32 v104, v104
    v_mfma_f32_16x16x32_bf16 v[92:95], a[152:155], a[88:91], v[92:95]
    v_exp_f32 v105, v105
    v_cvt_pk_bf16_f32 v51, v102, v103
    v_mfma_f32_16x16x32_bf16 v[92:95], a[148:151], a[84:87], v[92:95]
    buffer_load_dwordx4 v1, s[12:15], s55 offen offset:0 nt lds
    v_mfma_f32_16x16x32_bf16 v[92:95], a[144:147], a[80:83], v[92:95]
    s_waitcnt lgkmcnt(0)
    v_mul_f32 v107, s20, v107
    v_mul_f32 v108, s20, v108
    v_mfma_f32_16x16x32_bf16 a[224:227], a[240:243], v[32:35], a[224:227]
    v_exp_f32 v106, v106
    v_mfma_f32_16x16x32_bf16 a[224:227], a[240:243], v[36:39], a[224:227]
    ds_read_b128 a[32:35], v7 offset:0
    v_exp_f32 v107, v107
    v_mfma_f32_16x16x32_bf16 v[128:131], a[164:167], v[36:39], v[128:131]
    v_cvt_pk_bf16_f32 v52, v104, v105
    v_mul_f32 v109, s20, v109
    v_mfma_f32_16x16x32_bf16 v[128:131], a[160:163], v[32:35], v[128:131]
    v_exp_f32 v108, v108
    v_mfma_f32_16x16x32_bf16 v[132:135], a[168:171], v[32:35], v[132:135]
    v_mul_f32 v110, s20, v110
    v_cvt_pk_bf16_f32 v53, v106, v107
    v_mfma_f32_16x16x32_bf16 v[132:135], a[172:175], v[36:39], v[132:135]
    v_exp_f32 v109, v109
    v_mfma_f32_16x16x32_bf16 v[136:139], a[180:183], v[36:39], v[136:139]
    ds_read_b128 a[36:39], v7 offset:1024
    v_mul_f32 v111, s20, v111
    v_mul_f32 v112, s20, v112
    v_mfma_f32_16x16x32_bf16 v[136:139], a[176:179], v[32:35], v[136:139]
    v_exp_f32 v110, v110
    v_mfma_f32_16x16x32_bf16 v[140:143], a[184:187], v[32:35], v[140:143]
    buffer_load_dwordx4 v1, s[12:15], s55 offen offset:1024 nt lds
    v_mfma_f32_16x16x32_bf16 v[140:143], a[188:191], v[36:39], v[140:143]
    v_exp_f32 v111, v111
    v_mfma_f32_16x16x32_bf16 v[144:147], a[196:199], v[36:39], v[144:147]
    v_cvt_pk_bf16_f32 v54, v108, v109
    v_mul_f32 v113, s20, v113
    v_mul_f32 v114, s20, v114
    v_mfma_f32_16x16x32_bf16 v[144:147], a[192:195], v[32:35], v[144:147]
    v_exp_f32 v112, v112
    v_mfma_f32_16x16x32_bf16 v[148:151], a[200:203], v[32:35], v[148:151]
    v_exp_f32 v113, v113
    v_mfma_f32_16x16x32_bf16 v[148:151], a[204:207], v[36:39], v[148:151]
    ds_read_b128 a[40:43], v11 offset:2048
    v_cvt_pk_bf16_f32 v55, v110, v111
    v_mfma_f32_16x16x32_bf16 v[152:155], a[212:215], v[36:39], v[152:155]
    v_mul_f32 v115, s20, v115
    v_exp_f32 v114, v114
    v_mfma_f32_16x16x32_bf16 v[152:155], a[208:211], v[32:35], v[152:155]
    v_mul_f32 v116, s20, v116
    v_cvt_pk_bf16_f32 v56, v112, v113
    v_mfma_f32_16x16x32_bf16 v[156:159], a[216:219], v[32:35], v[156:159]
    s_xor_b32 s27, s24, 4096
    v_exp_f32 v115, v115
    v_mfma_f32_16x16x32_bf16 v[156:159], a[220:223], v[36:39], v[156:159]
    v_mul_f32 v117, s20, v117
    v_mul_f32 v118, s20, v118
    v_mfma_f32_16x16x32_bf16 a[228:231], a[240:243], v[40:43], a[228:231]
    ds_read_b128 a[44:47], v11 offset:3072
    v_exp_f32 v116, v116
    v_mfma_f32_16x16x32_bf16 a[228:231], a[240:243], v[44:47], a[228:231]
    buffer_store_dwordx4 a[48:51], v5, s[16:19], s27 offen offset:0 sc1 nt
    v_mfma_f32_16x16x32_bf16 v[160:163], a[164:167], v[44:47], v[160:163]
    v_exp_f32 v117, v117
    v_mfma_f32_16x16x32_bf16 v[160:163], a[160:163], v[40:43], v[160:163]
    v_cvt_pk_bf16_f32 v57, v114, v115
    v_mul_f32 v119, s20, v119
    v_mfma_f32_16x16x32_bf16 v[164:167], a[168:171], v[40:43], v[164:167]
    v_exp_f32 v118, v118
    v_mfma_f32_16x16x32_bf16 v[164:167], a[172:175], v[44:47], v[164:167]
    v_mul_f32 v120, s20, v120
    v_exp_f32 v119, v119
    v_mfma_f32_16x16x32_bf16 v[168:171], a[180:183], v[44:47], v[168:171]
    v_cvt_pk_bf16_f32 v58, v116, v117
    v_mul_f32 v121, s20, v121
    v_mfma_f32_16x16x32_bf16 v[168:171], a[176:179], v[40:43], v[168:171]
    v_exp_f32 v120, v120
    v_mfma_f32_16x16x32_bf16 v[172:175], a[184:187], v[40:43], v[172:175]
    v_mul_f32 v122, s20, v122
    v_cvt_pk_bf16_f32 v59, v118, v119
    v_mfma_f32_16x16x32_bf16 v[172:175], a[188:191], v[44:47], v[172:175]
    v_exp_f32 v121, v121
    v_mul_f32 v123, s20, v123
    v_mfma_f32_16x16x32_bf16 v[176:179], a[196:199], v[44:47], v[176:179]
    v_exp_f32 v122, v122
    v_mfma_f32_16x16x32_bf16 v[176:179], a[192:195], v[40:43], v[176:179]
    buffer_store_dwordx4 a[52:55], v5, s[16:19], s27 offen offset:1024 sc1 nt
    v_mfma_f32_16x16x32_bf16 v[180:183], a[200:203], v[40:43], v[180:183]
    v_mul_f32 v124, s20, v124
    v_cvt_pk_bf16_f32 v60, v120, v121
    v_mfma_f32_16x16x32_bf16 v[180:183], a[204:207], v[44:47], v[180:183]
    v_exp_f32 v123, v123
    v_mul_f32 v125, s20, v125
    v_mfma_f32_16x16x32_bf16 v[184:187], a[212:215], v[44:47], v[184:187]
    v_exp_f32 v124, v124
    v_mfma_f32_16x16x32_bf16 v[184:187], a[208:211], v[40:43], v[184:187]
    v_mul_f32 v126, s20, v126
    v_cvt_pk_bf16_f32 v61, v122, v123
    v_mfma_f32_16x16x32_bf16 v[188:191], a[216:219], v[40:43], v[188:191]
    v_exp_f32 v125, v125
    v_mfma_f32_16x16x32_bf16 v[188:191], a[220:223], v[44:47], v[188:191]
    v_mul_f32 v127, s20, v127
    v_exp_f32 v126, v126
L_n20:
    v_mfma_f32_16x16x32_bf16 v[96:99], a[96:99], a[0:3], v[20:23]
    v_exp_f32 v127, v127
    v_mfma_f32_16x16x32_bf16 v[96:99], a[100:103], a[4:7], v[96:99]
    v_cvt_pk_bf16_f32 v62, v124, v125
    v_cvt_pk_bf16_f32 v63, v126, v127
    v_mfma_f32_16x16x32_bf16 v[96:99], a[104:107], a[8:11], v[96:99]
    v_mul_f32 v64, s20, v64
    v_mul_f32 v65, s20, v65
    v_mfma_f32_16x16x32_bf16 v[96:99], a[108:111], a[12:15], v[96:99]
    v_exp_f32 v64, v64
    v_mfma_f32_16x16x32_bf16 v[100:103], a[124:127], a[12:15], v[20:23]
    v_mul_f32 v66, s20, v66
    v_mul_f32 v67, s20, v67
    v_mfma_f32_16x16x32_bf16 v[100:103], a[120:123], a[8:11], v[100:103]
    v_exp_f32 v65, v65
    v_mfma_f32_16x16x32_bf16 v[100:103], a[116:119], a[4:7], v[100:103]
    v_exp_f32 v66, v66
    v_mul_f32 v68, s20, v68
    v_mfma_f32_16x16x32_bf16 v[100:103], a[112:115], a[0:3], v[100:103]
    s_add_u32 m0, s22, 16384
    v_exp_f32 v67, v67
    v_mfma_f32_16x16x32_bf16 v[104:107], a[128:131], a[0:3], v[20:23]
    v_cvt_pk_bf16_f32 v32, v64, v65
    v_mul_f32 v69, s20, v69
    v_mfma_f32_16x16x32_bf16 v[104:107], a[132:135], a[4:7], v[104:107]
    v_exp_f32 v68, v68
    v_mfma_f32_16x16x32_bf16 v[104:107], a[136:139], a[8:11], v[104:107]
    buffer_load_dwordx4 v1, s[8:11], s58 offen offset:0 nt lds
    v_mfma_f32_16x16x32_bf16 v[104:107], a[140:143], a[12:15], v[104:107]
    v_mul_f32 v70, s20, v70
    v_cvt_pk_bf16_f32 v33, v66, v67
    v_mfma_f32_16x16x32_bf16 v[108:111], a[156:159], a[12:15], v[20:23]
    v_exp_f32 v69, v69
    v_mfma_f32_16x16x32_bf16 v[108:111], a[152:155], a[8:11], v[108:111]
    v_mul_f32 v71, s20, v71
    v_exp_f32 v70, v70
    v_mfma_f32_16x16x32_bf16 v[108:111], a[148:151], a[4:7], v[108:111]
    v_mul_f32 v72, s20, v72
    v_cvt_pk_bf16_f32 v34, v68, v69
    v_mfma_f32_16x16x32_bf16 v[108:111], a[144:147], a[0:3], v[108:111]
    v_exp_f32 v71, v71
    v_mfma_f32_16x16x32_bf16 v[112:115], a[96:99], a[16:19], v[24:27]
    v_mul_f32 v73, s20, v73
    v_mul_f32 v74, s20, v74
    v_mfma_f32_16x16x32_bf16 v[112:115], a[100:103], a[20:23], v[112:115]
    v_exp_f32 v72, v72
    v_mfma_f32_16x16x32_bf16 v[112:115], a[104:107], a[24:27], v[112:115]
    v_exp_f32 v73, v73
    v_mfma_f32_16x16x32_bf16 v[112:115], a[108:111], a[28:31], v[112:115]
    v_cvt_pk_bf16_f32 v35, v70, v71
    v_mul_f32 v75, s20, v75
    v_mfma_f32_16x16x32_bf16 v[116:119], a[124:127], a[28:31], v[24:27]
    v_exp_f32 v74, v74
    v_mul_f32 v76, s20, v76
    v_mfma_f32_16x16x32_bf16 v[116:119], a[120:123], a[24:27], v[116:119]
    v_exp_f32 v75, v75
    v_mfma_f32_16x16x32_bf16 v[116:119], a[116:119], a[20:23], v[116:119]
    buffer_load_dwordx4 v1, s[8:11], s58 offen offset:1024 nt lds
    v_mfma_f32_16x16x32_bf16 v[116:119], a[112:115], a[16:19], v[116:119]
    s_waitcnt vmcnt(14)
    v_cvt_pk_bf16_f32 v36, v72, v73
    v_mul_f32 v77, s20, v77
    v_mfma_f32_16x16x32_bf16 v[120:123], a[128:131], a[16:19], v[24:27]
    s_barrier
    v_exp_f32 v76, v76
    v_mfma_f32_16x16x32_bf16 v[120:123], a[132:135], a[20:23], v[120:123]
    v_mul_f32 v78, s20, v78
    v_cvt_pk_bf16_f32 v37, v74, v75
    v_mfma_f32_16x16x32_bf16 v[120:123], a[136:139], a[24:27], v[120:123]
    v_exp_f32 v77, v77
    v_mfma_f32_16x16x32_bf16 v[120:123], a[140:143], a[28:31], v[120:123]
    v_mul_f32 v79, s20, v79
    v_exp_f32 v78, v78
    v_mfma_f32_16x16x32_bf16 v[124:127], a[156:159], a[28:31], v[24:27]
    v_mul_f32 v80, s20, v80
    v_cvt_pk_bf16_f32 v38, v76, v77
    v_mfma_f32_16x16x32_bf16 v[124:127], a[152:155], a[24:27], v[124:127]
    v_exp_f32 v79, v79
    v_mfma_f32_16x16x32_bf16 v[124:127], a[148:151], a[20:23], v[124:127]
    v_mul_f32 v81, s20, v81
    v_mul_f32 v82, s20, v82
    v_mfma_f32_16x16x32_bf16 v[124:127], a[144:147], a[16:19], v[124:127]
    v_exp_f32 v80, v80
    v_mfma_f32_16x16x32_bf16 a[232:235], a[240:243], v[48:51], a[232:235]
    v_exp_f32 v81, v81
    v_mfma_f32_16x16x32_bf16 a[232:235], a[240:243], v[52:55], a[232:235]
    ds_read_b128 a[96:99], v2 offset:49152
    v_cvt_pk_bf16_f32 v39, v78, v79
    v_mul_f32 v83, s20, v83
    v_mfma_f32_16x16x32_bf16 v[192:195], a[164:167], v[52:55], v[192:195]
    s_add_u32 m0, s22, 65536
    ds_read_b128 a[100:103], v2 offset:49408
    v_mul_f32 v84, s20, v84
    v_mfma_f32_16x16x32_bf16 v[192:195], a[160:163], v[48:51], v[192:195]
    buffer_load_dwordx4 v1, s[12:15], s56 offen offset:0 nt lds
    v_mfma_f32_16x16x32_bf16 v[196:199], a[168:171], v[48:51], v[196:199]
    ds_read_b128 a[104:107], v2 offset:49664
    ds_read_b128 a[108:111], v2 offset:49920
    v_mfma_f32_16x16x32_bf16 v[196:199], a[172:175], v[52:55], v[196:199]
    v_exp_f32 v82, v82
    v_mfma_f32_16x16x32_bf16 v[200:203], a[180:183], v[52:55], v[200:203]
    v_exp_f32 v83, v83
    v_mfma_f32_16x16x32_bf16 v[200:203], a[176:179], v[48:51], v[200:203]
    ds_read_b128 a[112:115], v2 offset:53248
    ds_read_b128 a[116:119], v2 offset:53504
    v_mfma_f32_16x16x32_bf16 v[204:207], a[184:187], v[48:51], v[204:207]
    v_cvt_pk_bf16_f32 v40, v80, v81
    v_mul_f32 v85, s20, v85
    v_mul_f32 v86, s20, v86
    v_mfma_f32_16x16x32_bf16 v[204:207], a[188:191], v[52:55], v[204:207]
    v_exp_f32 v84, v84
    v_mfma_f32_16x16x32_bf16 v[208:211], a[196:199], v[52:55], v[208:211]
    ds_read_b128 a[120:123], v2 offset:53760
    ds_read_b128 a[124:127], v2 offset:54016
    v_mfma_f32_16x16x32_bf16 v[208:211], a[192:195], v[48:51], v[208:211]
    v_exp_f32 v85, v85
    v_mfma_f32_16x16x32_bf16 v[212:215], a[200:203], v[48:51], v[212:215]
    ds_read_b128 a[128:131], v2 offset:57344
    v_cvt_pk_bf16_f32 v41, v82, v83
    v_mfma_f32_16x16x32_bf16 v[212:215], a[204:207], v[52:55], v[212:215]
    ds_read_b128 a[132:135], v2 offset:57600
    v_mul_f32 v87, s20, v87
    v_mfma_f32_16x16x32_bf16 v[216:219], a[212:215], v[52:55], v[216:219]
    v_exp_f32 v86, v86
    v_mfma_f32_16x16x32_bf16 v[216:219], a[208:211], v[48:51], v[216:219]
    ds_read_b128 a[136:139], v2 offset:57856
    buffer_load_dwordx4 v1, s[12:15], s56 offen offset:1024 nt lds
    v_mfma_f32_16x16x32_bf16 v[220:223], a[216:219], v[48:51], v[220:223]
    ds_read_b128 a[140:143], v2 offset:58112
    v_mul_f32 v88, s20, v88
    v_mfma_f32_16x16x32_bf16 v[220:223], a[220:223], v[52:55], v[220:223]
    v_exp_f32 v87, v87
    v_mfma_f32_16x16x32_bf16 a[236:239], a[240:243], v[56:59], a[236:239]
    ds_read_b128 a[144:147], v2 offset:61440
    v_cvt_pk_bf16_f32 v42, v84, v85
    v_mfma_f32_16x16x32_bf16 a[236:239], a[240:243], v[60:63], a[236:239]
    ds_read_b128 a[148:151], v2 offset:61696
    v_mul_f32 v89, s20, v89
    v_mfma_f32_16x16x32_bf16 v[224:227], a[164:167], v[60:63], v[224:227]
    v_exp_f32 v88, v88
    v_mfma_f32_16x16x32_bf16 v[224:227], a[160:163], v[56:59], v[224:227]
    ds_read_b128 a[152:155], v2 offset:61952
    v_mul_f32 v90, s20, v90
    v_mfma_f32_16x16x32_bf16 v[228:231], a[168:171], v[56:59], v[228:231]
    ds_read_b128 a[156:159], v2 offset:62208
    v_exp_f32 v89, v89
    v_mfma_f32_16x16x32_bf16 v[228:231], a[172:175], v[60:63], v[228:231]
    ds_read_b64_tr_b16 a[160:161], v3 offset:32768
    v_cvt_pk_bf16_f32 v43, v86, v87
    v_mfma_f32_16x16x32_bf16 v[232:235], a[180:183], v[60:63], v[232:235]
    ds_read_b64_tr_b16 a[162:163], v3 offset:36864
    v_mul_f32 v91, s20, v91
    v_mfma_f32_16x16x32_bf16 v[232:235], a[176:179], v[56:59], v[232:235]
    v_exp_f32 v90, v90
    v_mfma_f32_16x16x32_bf16 v[236:239], a[184:187], v[56:59], v[236:239]
    ds_read_b64_tr_b16 a[164:165], v3 offset:40960
    v_mul_f32 v92, s20, v92
    v_mfma_f32_16x16x32_bf16 v[236:239], a[188:191], v[60:63], v[236:239]
    v_exp_f32 v91, v91
    v_mfma_f32_16x16x32_bf16 v[240:243], a[196:199], v[60:63], v[240:243]
    ds_read_b64_tr_b16 a[166:167], v3 offset:45056
    v_cvt_pk_bf16_f32 v44, v88, v89
    v_mfma_f32_16x16x32_bf16 v[240:243], a[192:195], v[56:59], v[240:243]
    buffer_store_dwordx4 a[56:59], v5, s[16:19], s27 offen offset:2048 sc1 nt
    ds_read_b64_tr_b16 a[168:169], v4 offset:32768
    v_mfma_f32_16x16x32_bf16 v[244:247], a[200:203], v[56:59], v[244:247]
    ds_read_b64_tr_b16 a[170:171], v4 offset:36864
    v_mul_f32 v93, s20, v93
    v_mfma_f32_16x16x32_bf16 v[244:247], a[204:207], v[60:63], v[244:247]
    v_exp_f32 v92, v92
    v_mfma_f32_16x16x32_bf16 v[248:251], a[212:215], v[60:63], v[248:251]
    ds_read_b64_tr_b16 a[172:173], v4 offset:40960
    v_mul_f32 v94, s20, v94
    v_mfma_f32_16x16x32_bf16 v[248:251], a[208:211], v[56:59], v[248:251]
    v_exp_f32 v93, v93
    v_mfma_f32_16x16x32_bf16 v[252:255], a[216:219], v[56:59], v[252:255]
    ds_read_b64_tr_b16 a[174:175], v4 offset:45056
    v_cvt_pk_bf16_f32 v45, v90, v91
    v_mfma_f32_16x16x32_bf16 v[252:255], a[220:223], v[60:63], v[252:255]
    s_waitcnt lgkmcnt(8)
    v_mul_f32 v95, s20, v95
    v_exp_f32 v94, v94
L_n21:
    v_mfma_f32_16x16x32_bf16 v[64:67], a[96:99], a[64:67], v[12:15]
    v_exp_f32 v95, v95
    v_mfma_f32_16x16x32_bf16 v[64:67], a[100:103], a[68:71], v[64:67]
    ds_read_b64_tr_b16 a[176:177], v3 offset:33024
    ds_read_b64_tr_b16 a[178:179], v3 offset:37120
    v_mfma_f32_16x16x32_bf16 v[64:67], a[104:107], a[72:75], v[64:67]
    ds_read_b64_tr_b16 a[180:181], v3 offset:41216
    v_cvt_pk_bf16_f32 v46, v92, v93
    v_mfma_f32_16x16x32_bf16 v[64:67], a[108:111], a[76:79], v[64:67]
    ds_read_b64_tr_b16 a[182:183], v3 offset:45312
    v_cvt_pk_bf16_f32 v47, v94, v95
    v_mfma_f32_16x16x32_bf16 v[68:71], a[124:127], a[76:79], v[12:15]
    ds_read_b64_tr_b16 a[184:185], v4 offset:33024
    v_mul_f32 v96, s20, v96
    v_mfma_f32_16x16x32_bf16 v[68:71], a[120:123], a[72:75], v[68:71]
    ds_read_b64_tr_b16 a[186:187], v4 offset:37120
    v_mul_f32 v97, s20, v97
    v_mfma_f32_16x16x32_bf16 v[68:71], a[116:119], a[68:71], v[68:71]
L_pad6:
    s_cbranch_execz L_back1
    ds_read_b64_tr_b16 a[188:189], v4 offset:41216
    v_exp_f32 v96, v96
    v_mfma_f32_16x16x32_bf16 v[68:71], a[112:115], a[64:67], v[68:71]
    ds_read_b64_tr_b16 a[190:191], v4 offset:45312
    v_mul_f32 v98, s20, v98
    v_mfma_f32_16x16x32_bf16 v[72:75], a[128:131], a[64:67], v[12:15]
    s_add_u32 m0, s22, 24576
    v_exp_f32 v97, v97
    v_mfma_f32_16x16x32_bf16 v[72:75], a[132:135], a[68:71], v[72:75]
    ds_read_b64_tr_b16 a[192:193], v3 offset:33280
    ds_read_b64_tr_b16 a[194:195], v3 offset:37376
    v_mfma_f32_16x16x32_bf16 v[72:75], a[136:139], a[72:75], v[72:75]
    buffer_load_dwordx4 v1, s[8:11], s59 offen offset:0 nt lds
    v_mfma_f32_16x16x32_bf16 v[72:75], a[140:143], a[76:79], v[72:75]
    ds_read_b64_tr_b16 a[196:197], v3 offset:41472
    ds_read_b64_tr_b16 a[198:199], v3 offset:45568
    v_mfma_f32_16x16x32_bf16 v[76:79], a[156:159], a[76:79], v[12:15]
    v_mul_f32 v99, s20, v99
    v_mul_f32 v100, s20, v100
    v_mfma_f32_16x16x32_bf16 v[76:79], a[152:155], a[72:75], v[76:79]
    ds_read_b64_tr_b16 a[200:201], v4 offset:33280
    v_exp_f32 v98, v98
    v_mfma_f32_16x16x32_bf16 v[76:79], a[148:151], a[68:71], v[76:79]
    v_exp_f32 v99, v99
    v_mfma_f32_16x16x32_bf16 v[76:79], a[144:147], a[64:67], v[76:79]
    ds_read_b64_tr_b16 a[202:203], v4 offset:37376
    ds_read_b64_tr_b16 a[204:205], v4 offset:41472
    v_mfma_f32_16x16x32_bf16 v[80:83], a[96:99], a[80:83], v[16:19]
    ds_read_b64_tr_b16 a[206:207], v4 offset:45568
    v_cvt_pk_bf16_f32 v48, v96, v97
    v_mfma_f32_16x16x32_bf16 v[80:83], a[100:103], a[84:87], v[80:83]
    ds_read_b64_tr_b16 a[208:209], v3 offset:33536
    v_mul_f32 v101, s20, v101
    v_mfma_f32_16x16x32_bf16 v[80:83], a[104:107], a[88:91], v[80:83]
    v_exp_f32 v100, v100
    v_mfma_f32_16x16x32_bf16 v[80:83], a[108:111], a[92:95], v[80:83]
    ds_read_b64_tr_b16 a[210:211], v3 offset:37632
    ds_read_b64_tr_b16 a[212:213], v3 offset:41728
    v_mfma_f32_16x16x32_bf16 v[84:87], a[124:127], a[92:95], v[16:19]
    ds_read_b64_tr_b16 a[214:215], v3 offset:45824
    v_mul_f32 v102, s20, v102
    v_cvt_pk_bf16_f32 v49, v98, v99
    v_mfma_f32_16x16x32_bf16 v[84:87], a[120:123], a[88:91], v[84:87]
    v_exp_f32 v101, v101
    v_mfma_f32_16x16x32_bf16 v[84:87], a[116:119], a[84:87], v[84:87]
    ds_read_b64_tr_b16 a[216:217], v4 offset:33536
    v_mul_f32 v103, s20, v103
    v_mfma_f32_16x16x32_bf16 v[84:87], a[112:115], a[80:83], v[84:87]
    buffer_load_dwordx4 v1, s[8:11], s59 offen offset:1024 nt lds
    v_mfma_f32_16x16x32_bf16 v[88:91], a[128:131], a[80:83], v[16:19]
    ds_read_b64_tr_b16 a[218:219], v4 offset:37632
    ds_read_b64_tr_b16 a[220:221], v4 offset:41728
    v_mfma_f32_16x16x32_bf16 v[88:91], a[132:135], a[84:87], v[88:91]
    ds_read_b64_tr_b16 a[222:223], v4 offset:45824
    v_mul_f32 v104, s20, v104
    v_mfma_f32_16x16x32_bf16 v[88:91], a[136:139], a[88:91], v[88:91]
    v_exp_f32 v102, v102
    v_mfma_f32_16x16x32_bf16 v[88:91], a[140:143], a[92:95], v[88:91]
    v_exp_f32 v103, v103
    v_cvt_pk_bf16_f32 v50, v100, v101
    v_mfma_f32_16x16x32_bf16 v[92:95], a[156:159], a[92:95], v[16:19]
    v_mul_f32 v105, s20, v105
    v_mul_f32 v106, s20, v106
    v_mfma_f32_16x16x32_bf16 v[92:95], a[152:155], a[88:91], v[92:95]
    v_exp_f32 v104, v104
    v_mfma_f32_16x16x32_bf16 v[92:95], a[148:151], a[84:87], v[92:95]
    v_exp_f32 v105, v105
    v_mfma_f32_16x16x32_bf16 v[92:95], a[144:147], a[80:83], v[92:95]
    s_waitcnt lgkmcnt(0)
    v_cvt_pk_bf16_f32 v51, v102, v103
    v_mul_f32 v107, s20, v107
    v_mfma_f32_16x16x32_bf16 a[224:227], a[240:243], v[32:35], a[224:227]
    s_add_u32 m0, s22, 73728
    v_exp_f32 v106, v106
    v_mfma_f32_16x16x32_bf16 a[224:227], a[240:243], v[36:39], a[224:227]
    v_mul_f32 v108, s20, v108
    v_exp_f32 v107, v107
    v_mfma_f32_16x16x32_bf16 v[128:131], a[164:167], v[36:39], v[128:131]
    buffer_load_dwordx4 v1, s[12:15], s57 offen offset:0 nt lds
    v_mfma_f32_16x16x32_bf16 v[128:131], a[160:163], v[32:35], v[128:131]
    v_cvt_pk_bf16_f32 v52, v104, v105
    v_mul_f32 v109, s20, v109
    v_mfma_f32_16x16x32_bf16 v[132:135], a[168:171], v[32:35], v[132:135]
    v_exp_f32 v108, v108
    v_mfma_f32_16x16x32_bf16 v[132:135], a[172:175], v[36:39], v[132:135]
    v_mul_f32 v110, s20, v110
    v_cvt_pk_bf16_f32 v53, v106, v107
    v_mfma_f32_16x16x32_bf16 v[136:139], a[180:183], v[36:39], v[136:139]
    v_exp_f32 v109, v109
    v_mfma_f32_16x16x32_bf16 v[136:139], a[176:179], v[32:35], v[136:139]
    v_mul_f32 v111, s20, v111
    v_mul_f32 v112, s20, v112
    v_mfma_f32_16x16x32_bf16 v[140:143], a[184:187], v[32:35], v[140:143]
    v_exp_f32 v110, v110
    v_cvt_pk_bf16_f32 v54, v108, v109
    v_mfma_f32_16x16x32_bf16 v[140:143], a[188:191], v[36:39], v[140:143]
    v_exp_f32 v111, v111
    v_mfma_f32_16x16x32_bf16 v[144:147], a[196:199], v[36:39], v[144:147]
    v_mul_f32 v113, s20, v113
    v_mul_f32 v114, s20, v114
    v_mfma_f32_16x16x32_bf16 v[144:147], a[192:195], v[32:35], v[144:147]
    v_exp_f32 v112, v112
    v_mfma_f32_16x16x32_bf16 v[148:151], a[200:203], v[32:35], v[148:151]
    v_exp_f32 v113, v113
    v_mfma_f32_16x16x32_bf16 v[148:151], a[204:207], v[36:39], v[148:151]
    v_cvt_pk_bf16_f32 v55, v110, v111
    v_mul_f32 v115, s20, v115
    v_mfma_f32_16x16x32_bf16 v[152:155], a[212:215], v[36:39], v[152:155]
    v_exp_f32 v114, v114
    v_mfma_f32_16x16x32_bf16 v[152:155], a[208:211], v[32:35], v[152:155]
    buffer_load_dwordx4 v1, s[12:15], s57 offen offset:1024 nt lds
    v_mul_f32 v116, s20, v116
    v_mfma_f32_16x16x32_bf16 v[156:159], a[216:219], v[32:35], v[156:159]
    v_exp_f32 v115, v115
    v_mfma_f32_16x16x32_bf16 v[156:159], a[220:223], v[36:39], v[156:159]
    v_cvt_pk_bf16_f32 v56, v112, v113
    v_mul_f32 v117, s20, v117
    v_mfma_f32_16x16x32_bf16 a[228:231], a[240:243], v[40:43], a[228:231]
    v_exp_f32 v116, v116
    v_mfma_f32_16x16x32_bf16 a[228:231], a[240:243], v[44:47], a[228:231]
    v_mul_f32 v118, s20, v118
    v_cvt_pk_bf16_f32 v57, v114, v115
    v_mfma_f32_16x16x32_bf16 v[160:163], a[164:167], v[44:47], v[160:163]
    v_exp_f32 v117, v117
    v_mfma_f32_16x16x32_bf16 v[160:163], a[160:163], v[40:43], v[160:163]
    v_mul_f32 v119, s20, v119
    v_mul_f32 v120, s20, v120
    v_mfma_f32_16x16x32_bf16 v[164:167], a[168:171], v[40:43], v[164:167]
    v_exp_f32 v118, v118
    v_cvt_pk_bf16_f32 v58, v116, v117
    v_mfma_f32_16x16x32_bf16 v[164:167], a[172:175], v[44:47], v[164:167]
    v_exp_f32 v119, v119
    v_mfma_f32_16x16x32_bf16 v[168:171], a[180:183], v[44:47], v[168:171]
    v_mul_f32 v121, s20, v121
    v_mul_f32 v122, s20, v122
    v_mfma_f32_16x16x32_bf16 v[168:171], a[176:179], v[40:43], v[168:171]
    v_exp_f32 v120, v120
    v_mfma_f32_16x16x32_bf16 v[172:175], a[184:187], v[40:43], v[172:175]
    v_exp_f32 v121, v121
    v_mfma_f32_16x16x32_bf16 v[172:175], a[188:191], v[44:47], v[172:175]
    buffer_store_dwordx4 a[60:63], v5, s[16:19], s27 offen offset:3072 sc1 nt
    v_mfma_f32_16x16x32_bf16 v[176:179], a[196:199], v[44:47], v[176:179]
    v_cvt_pk_bf16_f32 v59, v118, v119
    v_mul_f32 v123, s20, v123
    v_mfma_f32_16x16x32_bf16 v[176:179], a[192:195], v[40:43], v[176:179]
    v_exp_f32 v122, v122
    v_mul_f32 v124, s20, v124
    v_mfma_f32_16x16x32_bf16 v[180:183], a[200:203], v[40:43], v[180:183]
    v_exp_f32 v123, v123
    v_mfma_f32_16x16x32_bf16 v[180:183], a[204:207], v[44:47], v[180:183]
    v_cvt_pk_bf16_f32 v60, v120, v121
    v_mul_f32 v125, s20, v125
    v_mfma_f32_16x16x32_bf16 v[184:187], a[212:215], v[44:47], v[184:187]
    v_exp_f32 v124, v124
    v_mfma_f32_16x16x32_bf16 v[184:187], a[208:211], v[40:43], v[184:187]
    v_mul_f32 v126, s20, v126
    v_cvt_pk_bf16_f32 v61, v122, v123
    v_mfma_f32_16x16x32_bf16 v[188:191], a[216:219], v[40:43], v[188:191]
    v_exp_f32 v125, v125
    v_mfma_f32_16x16x32_bf16 v[188:191], a[220:223], v[44:47], v[188:191]
    v_mul_f32 v127, s20, v127
    v_exp_f32 v126, v126
L_n22:
    v_mfma_f32_16x16x32_bf16 v[96:99], a[96:99], a[0:3], v[20:23]
    v_exp_f32 v127, v127
    v_mfma_f32_16x16x32_bf16 v[96:99], a[100:103], a[4:7], v[96:99]
    v_cvt_pk_bf16_f32 v62, v124, v125
    v_cvt_pk_bf16_f32 v63, v126, v127
    v_mfma_f32_16x16x32_bf16 v[96:99], a[104:107], a[8:11], v[96:99]
    v_mul_f32 v64, s20, v64
    v_mul_f32 v65, s20, v65
    v_mfma_f32_16x16x32_bf16 v[96:99], a[108:111], a[12:15], v[96:99]
    v_exp_f32 v64, v64
    v_mfma_f32_16x16x32_bf16 v[100:103], a[124:127], a[12:15], v[20:23]
    v_mul_f32 v66, s20, v66
    v_exp_f32 v65, v65
    v_mfma_f32_16x16x32_bf16 v[100:103], a[120:123], a[8:11], v[100:103]
    v_mul_f32 v67, s20, v67
    v_mul_f32 v68, s20, v68
    v_mfma_f32_16x16x32_bf16 v[100:103], a[116:119], a[4:7], v[100:103]
    s_add_u32 m0, s22, 32768
    v_exp_f32 v66, v66
    v_mfma_f32_16x16x32_bf16 v[100:103], a[112:115], a[0:3], v[100:103]
    v_exp_f32 v67, v67
    v_mfma_f32_16x16x32_bf16 v[104:107], a[128:131], a[0:3], v[20:23]
    buffer_load_dwordx4 v1, s[8:11], s60 offen offset:0 nt lds
    v_cvt_pk_bf16_f32 v32, v64, v65
    v_mfma_f32_16x16x32_bf16 v[104:107], a[132:135], a[4:7], v[104:107]
    v_mul_f32 v69, s20, v69
    v_mul_f32 v70, s20, v70
    v_mfma_f32_16x16x32_bf16 v[104:107], a[136:139], a[8:11], v[104:107]
    v_exp_f32 v68, v68
    v_mfma_f32_16x16x32_bf16 v[104:107], a[140:143], a[12:15], v[104:107]
    v_exp_f32 v69, v69
    v_mfma_f32_16x16x32_bf16 v[108:111], a[156:159], a[12:15], v[20:23]
    v_cvt_pk_bf16_f32 v33, v66, v67
    v_mul_f32 v71, s20, v71
    v_mul_f32 v72, s20, v72
    v_mfma_f32_16x16x32_bf16 v[108:111], a[152:155], a[8:11], v[108:111]
    v_exp_f32 v70, v70
    v_mfma_f32_16x16x32_bf16 v[108:111], a[148:151], a[4:7], v[108:111]
    v_exp_f32 v71, v71
    v_mfma_f32_16x16x32_bf16 v[108:111], a[144:147], a[0:3], v[108:111]
    v_cvt_pk_bf16_f32 v34, v68, v69
    v_mul_f32 v73, s20, v73
    v_mfma_f32_16x16x32_bf16 v[112:115], a[96:99], a[16:19], v[24:27]
    v_exp_f32 v72, v72
    v_mul_f32 v74, s20, v74
    v_mfma_f32_16x16x32_bf16 v[112:115], a[100:103], a[20:23], v[112:115]
    v_exp_f32 v73, v73
    v_mfma_f32_16x16x32_bf16 v[112:115], a[104:107], a[24:27], v[112:115]
    buffer_load_dwordx4 v1, s[8:11], s60 offen offset:1024 nt lds
    v_mfma_f32_16x16x32_bf16 v[112:115], a[108:111], a[28:31], v[112:115]
    v_cvt_pk_bf16_f32 v35, v70, v71
    v_mul_f32 v75, s20, v75
    v_mfma_f32_16x16x32_bf16 v[116:119], a[124:127], a[28:31], v[24:27]
    v_exp_f32 v74, v74
    v_mfma_f32_16x16x32_bf16 v[116:119], a[120:123], a[24:27], v[116:119]
    v_mul_f32 v76, s20, v76
    v_exp_f32 v75, v75
    v_mfma_f32_16x16x32_bf16 v[116:119], a[116:119], a[20:23], v[116:119]
    v_cvt_pk_bf16_f32 v36, v72, v73
    v_mul_f32 v77, s20, v77
    v_mfma_f32_16x16x32_bf16 v[116:119], a[112:115], a[16:19], v[116:119]
    s_waitcnt vmcnt(14)
    v_exp_f32 v76, v76
    v_mfma_f32_16x16x32_bf16 v[120:123], a[128:131], a[16:19], v[24:27]
    s_barrier
    v_mul_f32 v78, s20, v78
    v_cvt_pk_bf16_f32 v37, v74, v75
    v_mfma_f32_16x16x32_bf16 v[120:123], a[132:135], a[20:23], v[120:123]
    v_exp_f32 v77, v77
    v_mul_f32 v79, s20, v79
    v_mfma_f32_16x16x32_bf16 v[120:123], a[136:139], a[24:27], v[120:123]
    v_exp_f32 v78, v78
    v_mfma_f32_16x16x32_bf16 v[120:123], a[140:143], a[28:31], v[120:123]
    s_add_u32 m0, s22, 81920
    v_mul_f32 v80, s20, v80
    v_cvt_pk_bf16_f32 v38, v76, v77
    v_mfma_f32_16x16x32_bf16 v[124:127], a[156:159], a[28:31], v[24:27]
    v_exp_f32 v79, v79
    v_mfma_f32_16x16x32_bf16 v[124:127], a[152:155], a[24:27], v[124:127]
    buffer_load_dwordx4 v1, s[12:15], s58 offen offset:0 nt lds
    v_mul_f32 v81, s20, v81
    v_mfma_f32_16x16x32_bf16 v[124:127], a[148:151], a[20:23], v[124:127]
    v_exp_f32 v80, v80
    v_mfma_f32_16x16x32_bf16 v[124:127], a[144:147], a[16:19], v[124:127]
    v_mul_f32 v82, s20, v82
    v_cvt_pk_bf16_f32 v39, v78, v79
    v_mfma_f32_16x16x32_bf16 a[232:235], a[240:243], v[48:51], a[232:235]
    v_exp_f32 v81, v81
    v_mfma_f32_16x16x32_bf16 a[232:235], a[240:243], v[52:55], a[232:235]
    ds_read_b128 a[96:99], v2 offset:0
    ds_read_b128 a[100:103], v2 offset:256
    v_mul_f32 v83, s20, v83
    v_mfma_f32_16x16x32_bf16 v[192:195], a[164:167], v[52:55], v[192:195]
    v_exp_f32 v82, v82
    v_mfma_f32_16x16x32_bf16 v[192:195], a[160:163], v[48:51], v[192:195]
    ds_read_b128 a[104:107], v2 offset:512
    ds_read_b128 a[108:111], v2 offset:768
    v_mfma_f32_16x16x32_bf16 v[196:199], a[168:171], v[48:51], v[196:199]
    ds_read_b128 a[112:115], v2 offset:4096
    v_mul_f32 v84, s20, v84
    v_mfma_f32_16x16x32_bf16 v[196:199], a[172:175], v[52:55], v[196:199]
    v_exp_f32 v83, v83
    v_mfma_f32_16x16x32_bf16 v[200:203], a[180:183], v[52:55], v[200:203]
    ds_read_b128 a[116:119], v2 offset:4352
    v_cvt_pk_bf16_f32 v40, v80, v81
    v_mul_f32 v85, s20, v85
    v_mfma_f32_16x16x32_bf16 v[200:203], a[176:179], v[48:51], v[200:203]
    v_exp_f32 v84, v84
    v_mfma_f32_16x16x32_bf16 v[204:207], a[184:187], v[48:51], v[204:207]
    ds_read_b128 a[120:123], v2 offset:4608
    v_mul_f32 v86, s20, v86
    v_mfma_f32_16x16x32_bf16 v[204:207], a[188:191], v[52:55], v[204:207]
    buffer_load_dwordx4 v1, s[12:15], s58 offen offset:1024 nt lds
    v_mfma_f32_16x16x32_bf16 v[208:211], a[196:199], v[52:55], v[208:211]
    ds_read_b128 a[124:127], v2 offset:4864
    v_exp_f32 v85, v85
    v_mfma_f32_16x16x32_bf16 v[208:211], a[192:195], v[48:51], v[208:211]
    ds_read_b128 a[128:131], v2 offset:8192
    ds_read_b128 a[132:135], v2 offset:8448
    v_mfma_f32_16x16x32_bf16 v[212:215], a[200:203], v[48:51], v[212:215]
    ds_read_b128 a[136:139], v2 offset:8704
    v_cvt_pk_bf16_f32 v41, v82, v83
    v_mfma_f32_16x16x32_bf16 v[212:215], a[204:207], v[52:55], v[212:215]
    ds_read_b128 a[140:143], v2 offset:8960
    v_mul_f32 v87, s20, v87
    v_mfma_f32_16x16x32_bf16 v[216:219], a[212:215], v[52:55], v[216:219]
    ds_read_b128 a[144:147], v2 offset:12288
    v_exp_f32 v86, v86
    v_mfma_f32_16x16x32_bf16 v[216:219], a[208:211], v[48:51], v[216:219]
    ds_read_b128 a[148:151], v2 offset:12544
    v_mul_f32 v88, s20, v88
    v_mfma_f32_16x16x32_bf16 v[220:223], a[216:219], v[48:51], v[220:223]
    v_exp_f32 v87, v87
    v_mfma_f32_16x16x32_bf16 v[220:223], a[220:223], v[52:55], v[220:223]
    ds_read_b128 a[152:155], v2 offset:12800
    v_cvt_pk_bf16_f32 v42, v84, v85
    v_mfma_f32_16x16x32_bf16 a[236:239], a[240:243], v[56:59], a[236:239]
    s_xor_b32 s27, s24, 8192
    v_mul_f32 v89, s20, v89
    v_exp_f32 v88, v88
    v_mfma_f32_16x16x32_bf16 a[236:239], a[240:243], v[60:63], a[236:239]
    ds_read_b128 a[156:159], v2 offset:13056
    v_mul_f32 v90, s20, v90
    v_mfma_f32_16x16x32_bf16 v[224:227], a[164:167], v[60:63], v[224:227]
    buffer_store_dwordx4 a[32:35], v5, s[16:19], s27 offen offset:0 sc1 nt
    v_mfma_f32_16x16x32_bf16 v[224:227], a[160:163], v[56:59], v[224:227]
    ds_read_b128 a[48:51], v7 offset:4096
    ds_read_b128 a[52:55], v7 offset:5120
    v_mfma_f32_16x16x32_bf16 v[228:231], a[168:171], v[56:59], v[228:231]
    ds_read_b128 a[56:59], v11 offset:6144
    ds_read_b128 a[60:63], v11 offset:7168
    v_mfma_f32_16x16x32_bf16 v[228:231], a[172:175], v[60:63], v[228:231]
    ds_read_b64_tr_b16 a[160:161], v3 offset:49152
    v_exp_f32 v89, v89
    v_mfma_f32_16x16x32_bf16 v[232:235], a[180:183], v[60:63], v[232:235]
    ds_read_b64_tr_b16 a[162:163], v3 offset:53248
    v_cvt_pk_bf16_f32 v43, v86, v87
    v_mfma_f32_16x16x32_bf16 v[232:235], a[176:179], v[56:59], v[232:235]
    v_mul_f32 v91, s20, v91
    v_mul_f32 v92, s20, v92
    v_mfma_f32_16x16x32_bf16 v[236:239], a[184:187], v[56:59], v[236:239]
    v_exp_f32 v90, v90
    v_mfma_f32_16x16x32_bf16 v[236:239], a[188:191], v[60:63], v[236:239]
    ds_read_b64_tr_b16 a[164:165], v3 offset:57344
    v_exp_f32 v91, v91
    v_mfma_f32_16x16x32_bf16 v[240:243], a[196:199], v[60:63], v[240:243]
    ds_read_b64_tr_b16 a[166:167], v3 offset:61440
    v_cvt_pk_bf16_f32 v44, v88, v89
    v_mfma_f32_16x16x32_bf16 v[240:243], a[192:195], v[56:59], v[240:243]
    buffer_store_dwordx4 a[36:39], v5, s[16:19], s27 offen offset:1024 sc1 nt
    v_mfma_f32_16x16x32_bf16 v[244:247], a[200:203], v[56:59], v[244:247]
    ds_read_b64_tr_b16 a[168:169], v4 offset:49152
    ds_read_b64_tr_b16 a[170:171], v4 offset:53248
    v_mfma_f32_16x16x32_bf16 v[244:247], a[204:207], v[60:63], v[244:247]
    v_mul_f32 v93, s20, v93
    v_exp_f32 v92, v92
    v_mfma_f32_16x16x32_bf16 v[248:251], a[212:215], v[60:63], v[248:251]
    ds_read_b64_tr_b16 a[172:173], v4 offset:57344
    v_mul_f32 v94, s20, v94
    v_mfma_f32_16x16x32_bf16 v[248:251], a[208:211], v[56:59], v[248:251]
    v_exp_f32 v93, v93
    v_mfma_f32_16x16x32_bf16 v[252:255], a[216:219], v[56:59], v[252:255]
    ds_read_b64_tr_b16 a[174:175], v4 offset:61440
    v_cvt_pk_bf16_f32 v45, v90, v91
    v_mfma_f32_16x16x32_bf16 v[252:255], a[220:223], v[60:63], v[252:255]
    s_waitcnt lgkmcnt(12)
    v_mul_f32 v95, s20, v95
    v_exp_f32 v94, v94
L_n23:
    v_mfma_f32_16x16x32_bf16 v[64:67], a[96:99], a[64:67], v[12:15]
    v_exp_f32 v95, v95
    v_mfma_f32_16x16x32_bf16 v[64:67], a[100:103], a[68:71], v[64:67]
    ds_read_b64_tr_b16 a[176:177], v3 offset:49408
    ds_read_b64_tr_b16 a[178:179], v3 offset:53504
    v_mfma_f32_16x16x32_bf16 v[64:67], a[104:107], a[72:75], v[64:67]
    ds_read_b64_tr_b16 a[180:181], v3 offset:57600
    v_cvt_pk_bf16_f32 v46, v92, v93
    v_mfma_f32_16x16x32_bf16 v[64:67], a[108:111], a[76:79], v[64:67]
    ds_read_b64_tr_b16 a[182:183], v3 offset:61696
    v_cvt_pk_bf16_f32 v47, v94, v95
    v_mfma_f32_16x16x32_bf16 v[68:71], a[124:127], a[76:79], v[12:15]
    ds_read_b64_tr_b16 a[184:185], v4 offset:49408
    v_mul_f32 v96, s20, v96
    v_mfma_f32_16x16x32_bf16 v[68:71], a[120:123], a[72:75], v[68:71]
    ds_read_b64_tr_b16 a[186:187], v4 offset:53504
    v_mul_f32 v97, s20, v97
    v_mul_f32 v98, s20, v98
    v_mfma_f32_16x16x32_bf16 v[68:71], a[116:119], a[68:71], v[68:71]
    v_exp_f32 v96, v96
    v_mfma_f32_16x16x32_bf16 v[68:71], a[112:115], a[64:67], v[68:71]
    ds_read_b64_tr_b16 a[188:189], v4 offset:57600
    v_mul_f32 v99, s20, v99
    v_mfma_f32_16x16x32_bf16 v[72:75], a[128:131], a[64:67], v[12:15]
    s_add_u32 m0, s22, 40960
    ds_read_b64_tr_b16 a[190:191], v4 offset:61696
    ds_read_b64_tr_b16 a[192:193], v3 offset:49664
    v_mfma_f32_16x16x32_bf16 v[72:75], a[132:135], a[68:71], v[72:75]
    buffer_load_dwordx4 v1, s[8:11], s61 offen offset:0 nt lds
    v_mfma_f32_16x16x32_bf16 v[72:75], a[136:139], a[72:75], v[72:75]
    ds_read_b64_tr_b16 a[194:195], v3 offset:53760
    ds_read_b64_tr_b16 a[196:197], v3 offset:57856
    v_mfma_f32_16x16x32_bf16 v[72:75], a[140:143], a[76:79], v[72:75]
    ds_read_b64_tr_b16 a[198:199], v3 offset:61952
    v_exp_f32 v97, v97
    v_mfma_f32_16x16x32_bf16 v[76:79], a[156:159], a[76:79], v[12:15]
    v_exp_f32 v98, v98
    v_mfma_f32_16x16x32_bf16 v[76:79], a[152:155], a[72:75], v[76:79]
    ds_read_b64_tr_b16 a[200:201], v4 offset:49664
    v_mul_f32 v100, s20, v100
    v_mfma_f32_16x16x32_bf16 v[76:79], a[148:151], a[68:71], v[76:79]
    v_exp_f32 v99, v99
    v_mfma_f32_16x16x32_bf16 v[76:79], a[144:147], a[64:67], v[76:79]
    ds_read_b64_tr_b16 a[202:203], v4 offset:53760
    ds_read_b64_tr_b16 a[204:205], v4 offset:57856
    v_mfma_f32_16x16x32_bf16 v[80:83], a[96:99], a[80:83], v[16:19]
    ds_read_b64_tr_b16 a[206:207], v4 offset:61952
    v_cvt_pk_bf16_f32 v48, v96, v97
    v_mul_f32 v101, s20, v101
    v_mfma_f32_16x16x32_bf16 v[80:83], a[100:103], a[84:87], v[80:83]
    v_exp_f32 v100, v100
    v_mfma_f32_16x16x32_bf16 v[80:83], a[104:107], a[88:91], v[80:83]
    ds_read_b64_tr_b16 a[208:209], v3 offset:49920
    ds_read_b64_tr_b16 a[210:211], v3 offset:54016
    v_mfma_f32_16x16x32_bf16 v[80:83], a[108:111], a[92:95], v[80:83]
    buffer_load_dwordx4 v1, s[8:11], s61 offen offset:1024 nt lds
    v_mfma_f32_16x16x32_bf16 v[84:87], a[124:127], a[92:95], v[16:19]
    ds_read_b64_tr_b16 a[212:213], v3 offset:58112
    ds_read_b64_tr_b16 a[214:215], v3 offset:62208
    v_mfma_f32_16x16x32_bf16 v[84:87], a[120:123], a[88:91], v[84:87]
    ds_read_b64_tr_b16 a[216:217], v4 offset:49920
    v_mul_f32 v102, s20, v102
    v_mfma_f32_16x16x32_bf16 v[84:87], a[116:119], a[84:87], v[84:87]
    ds_read_b64_tr_b16 a[218:219], v4 offset:54016
    v_exp_f32 v101, v101
    v_mfma_f32_16x16x32_bf16 v[84:87], a[112:115], a[80:83], v[84:87]
    ds_read_b64_tr_b16 a[220:221], v4 offset:58112
    v_cvt_pk_bf16_f32 v49, v98, v99
    v_mfma_f32_16x16x32_bf16 v[88:91], a[128:131], a[80:83], v[16:19]
    ds_read_b64_tr_b16 a[222:223], v4 offset:62208
    v_mul_f32 v103, s20, v103
    v_mfma_f32_16x16x32_bf16 v[88:91], a[132:135], a[84:87], v[88:91]
    v_exp_f32 v102, v102
    v_mfma_f32_16x16x32_bf16 v[88:91], a[136:139], a[88:91], v[88:91]
    v_mul_f32 v104, s20, v104
    v_cvt_pk_bf16_f32 v50, v100, v101
    v_mfma_f32_16x16x32_bf16 v[88:91], a[140:143], a[92:95], v[88:91]
    s_add_u32 m0, s22, 90112
    v_exp_f32 v103, v103
    v_mfma_f32_16x16x32_bf16 v[92:95], a[156:159], a[92:95], v[16:19]
    v_mul_f32 v105, s20, v105
    v_exp_f32 v104, v104
    v_mfma_f32_16x16x32_bf16 v[92:95], a[152:155], a[88:91], v[92:95]
    buffer_load_dwordx4 v1, s[12:15], s59 offen offset:0 nt lds
    v_mfma_f32_16x16x32_bf16 v[92:95], a[148:151], a[84:87], v[92:95]
    v_mul_f32 v106, s20, v106
    v_cvt_pk_bf16_f32 v51, v102, v103
    v_mfma_f32_16x16x32_bf16 v[92:95], a[144:147], a[80:83], v[92:95]
    s_waitcnt lgkmcnt(0)
    v_exp_f32 v105, v105
    v_mfma_f32_16x16x32_bf16 a[224:227], a[240:243], v[32:35], a[224:227]
    v_mul_f32 v107, s20, v107
    v_mul_f32 v108, s20, v108
    v_mfma_f32_16x16x32_bf16 a[224:227], a[240:243], v[36:39], a[224:227]
    v_exp_f32 v106, v106
    v_cvt_pk_bf16_f32 v52, v104, v105
    v_mfma_f32_16x16x32_bf16 v[128:131], a[164:167], v[36:39], v[128:131]
    v_exp_f32 v107, v107
    v_mfma_f32_16x16x32_bf16 v[128:131], a[160:163], v[32:35], v[128:131]
    v_mul_f32 v109, s20, v109
    v_mul_f32 v110, s20, v110
    v_mfma_f32_16x16x32_bf16 v[132:135], a[168:171], v[32:35], v[132:135]
    v_exp_f32 v108, v108
    v_mfma_f32_16x16x32_bf16 v[132:135], a[172:175], v[36:39], v[132:135]
    v_exp_f32 v109, v109
    v_mfma_f32_16x16x32_bf16 v[136:139], a[180:183], v[36:39], v[136:139]
    v_cvt_pk_bf16_f32 v53, v106, v107
    v_mul_f32 v111, s20, v111
    v_mfma_f32_16x16x32_bf16 v[136:139], a[176:179], v[32:35], v[136:139]
    v_exp_f32 v110, v110
    v_mul_f32 v112, s20, v112
    v_mfma_f32_16x16x32_bf16 v[140:143], a[184:187], v[32:35], v[140:143]
    buffer_load_dwordx4 v1, s[12:15], s59 offen offset:1024 nt lds
    v_mfma_f32_16x16x32_bf16 v[140:143], a[188:191], v[36:39], v[140:143]
    v_exp_f32 v111, v111
    v_mfma_f32_16x16x32_bf16 v[144:147], a[196:199], v[36:39], v[144:147]
    v_cvt_pk_bf16_f32 v54, v108, v109
    v_mul_f32 v113, s20, v113
    v_mfma_f32_16x16x32_bf16 v[144:147], a[192:195], v[32:35], v[144:147]
    v_exp_f32 v112, v112
    v_mfma_f32_16x16x32_bf16 v[148:151], a[200:203], v[32:35], v[148:151]
    v_mul_f32 v114, s20, v114
    v_cvt_pk_bf16_f32 v55, v110, v111
    v_mfma_f32_16x16x32_bf16 v[148:151], a[204:207], v[36:39], v[148:151]
    v_exp_f32 v113, v113
    v_mul_f32 v115, s20, v115
    v_mfma_f32_16x16x32_bf16 v[152:155], a[212:215], v[36:39], v[152:155]
    v_exp_f32 v114, v114
    v_mfma_f32_16x16x32_bf16 v[152:155], a[208:211], v[32:35], v[152:155]
    v_mul_f32 v116, s20, v116
    v_cvt_pk_bf16_f32 v56, v112, v113
    v_mfma_f32_16x16x32_bf16 v[156:159], a[216:219], v[32:35], v[156:159]
    s_add_u32 s23, s0, L_n26-L_pc
    v_exp_f32 v115, v115
    v_mfma_f32_16x16x32_bf16 v[156:159], a[220:223], v[36:39], v[156:159]
    v_mul_f32 v117, s20, v117
    v_mul_f32 v118, s20, v118
    v_mfma_f32_16x16x32_bf16 a[228:231], a[240:243], v[40:43], a[228:231]
    v_exp_f32 v116, v116
    v_cvt_pk_bf16_f32 v57, v114, v115
    v_mfma_f32_16x16x32_bf16 a[228:231], a[240:243], v[44:47], a[228:231]
    buffer_load_dword a247, off, s[96:99], s23
    v_mfma_f32_16x16x32_bf16 v[160:163], a[164:167], v[44:47], v[160:163]
    v_exp_f32 v117, v117
    v_mfma_f32_16x16x32_bf16 v[160:163], a[160:163], v[40:43], v[160:163]
    v_mul_f32 v119, s20, v119
    v_mul_f32 v120, s20, v120
    v_mfma_f32_16x16x32_bf16 v[164:167], a[168:171], v[40:43], v[164:167]
    v_exp_f32 v118, v118
    v_mfma_f32_16x16x32_bf16 v[164:167], a[172:175], v[44:47], v[164:167]
    v_exp_f32 v119, v119
    v_mfma_f32_16x16x32_bf16 v[168:171], a[180:183], v[44:47], v[168:171]
    v_cvt_pk_bf16_f32 v58, v116, v117
    v_mul_f32 v121, s20, v121
    v_mul_f32 v122, s20, v122
    v_mfma_f32_16x16x32_bf16 v[168:171], a[176:179], v[40:43], v[168:171]
    v_exp_f32 v120, v120
    v_mfma_f32_16x16x32_bf16 v[172:175], a[184:187], v[40:43], v[172:175]
    v_exp_f32 v121, v121
    v_mfma_f32_16x16x32_bf16 v[172:175], a[188:191], v[44:47], v[172:175]
    v_cvt_pk_bf16_f32 v59, v118, v119
    v_mul_f32 v123, s20, v123
    v_mfma_f32_16x16x32_bf16 v[176:179], a[196:199], v[44:47], v[176:179]
    v_exp_f32 v122, v122
    v_mfma_f32_16x16x32_bf16 v[176:179], a[192:195], v[40:43], v[176:179]
    buffer_store_dwordx4 a[40:43], v5, s[16:19], s27 offen offset:2048 sc1 nt
    v_mfma_f32_16x16x32_bf16 v[180:183], a[200:203], v[40:43], v[180:183]
    v_mul_f32 v124, s20, v124
    v_exp_f32 v123, v123
    v_mfma_f32_16x16x32_bf16 v[180:183], a[204:207], v[44:47], v[180:183]
    v_cvt_pk_bf16_f32 v60, v120, v121
    v_mul_f32 v125, s20, v125
    v_mfma_f32_16x16x32_bf16 v[184:187], a[212:215], v[44:47], v[184:187]
    v_exp_f32 v124, v124
    v_mfma_f32_16x16x32_bf16 v[184:187], a[208:211], v[40:43], v[184:187]
    v_mul_f32 v126, s20, v126
    v_cvt_pk_bf16_f32 v61, v122, v123
    v_mfma_f32_16x16x32_bf16 v[188:191], a[216:219], v[40:43], v[188:191]
    v_exp_f32 v125, v125
    v_mfma_f32_16x16x32_bf16 v[188:191], a[220:223], v[44:47], v[188:191]
    v_mul_f32 v127, s20, v127
    v_exp_f32 v126, v126
L_n24:
    v_mfma_f32_16x16x32_bf16 v[96:99], a[96:99], a[0:3], v[20:23]
    v_exp_f32 v127, v127
    v_mfma_f32_16x16x32_bf16 v[96:99], a[100:103], a[4:7], v[96:99]
    v_cvt_pk_bf16_f32 v62, v124, v125
    v_cvt_pk_bf16_f32 v63, v126, v127
    v_mfma_f32_16x16x32_bf16 v[96:99], a[104:107], a[8:11], v[96:99]
    v_mul_f32 v64, s20, v64
    v_mul_f32 v65, s20, v65
    v_mfma_f32_16x16x32_bf16 v[96:99], a[108:111], a[12:15], v[96:99]
    v_exp_f32 v64, v64
    v_mfma_f32_16x16x32_bf16 v[100:103], a[124:127], a[12:15], v[20:23]
    v_mul_f32 v66, s20, v66
    v_mul_f32 v67, s20, v67
    v_mfma_f32_16x16x32_bf16 v[100:103], a[120:123], a[8:11], v[100:103]
    v_exp_f32 v65, v65
    v_mfma_f32_16x16x32_bf16 v[100:103], a[116:119], a[4:7], v[100:103]
    v_exp_f32 v66, v66
    v_mul_f32 v68, s20, v68
    v_mfma_f32_16x16x32_bf16 v[100:103], a[112:115], a[0:3], v[100:103]
    s_add_u32 m0, s22, 49152
    v_exp_f32 v67, v67
    v_mfma_f32_16x16x32_bf16 v[104:107], a[128:131], a[0:3], v[20:23]
    v_cvt_pk_bf16_f32 v32, v64, v65
    v_mul_f32 v69, s20, v69
    v_mfma_f32_16x16x32_bf16 v[104:107], a[132:135], a[4:7], v[104:107]
    v_exp_f32 v68, v68
    v_mfma_f32_16x16x32_bf16 v[104:107], a[136:139], a[8:11], v[104:107]
    buffer_load_dwordx4 v1, s[8:11], s62 offen offset:0 nt lds
    v_mfma_f32_16x16x32_bf16 v[104:107], a[140:143], a[12:15], v[104:107]
    v_mul_f32 v70, s20, v70
    v_cvt_pk_bf16_f32 v33, v66, v67
    v_mfma_f32_16x16x32_bf16 v[108:111], a[156:159], a[12:15], v[20:23]
    v_exp_f32 v69, v69
    v_mfma_f32_16x16x32_bf16 v[108:111], a[152:155], a[8:11], v[108:111]
    v_mul_f32 v71, s20, v71
    v_exp_f32 v70, v70
    v_mfma_f32_16x16x32_bf16 v[108:111], a[148:151], a[4:7], v[108:111]
    v_mul_f32 v72, s20, v72
    v_cvt_pk_bf16_f32 v34, v68, v69
    v_mfma_f32_16x16x32_bf16 v[108:111], a[144:147], a[0:3], v[108:111]
    v_exp_f32 v71, v71
    v_mfma_f32_16x16x32_bf16 v[112:115], a[96:99], a[16:19], v[24:27]
    v_mul_f32 v73, s20, v73
    v_mul_f32 v74, s20, v74
    v_mfma_f32_16x16x32_bf16 v[112:115], a[100:103], a[20:23], v[112:115]
    v_exp_f32 v72, v72
    v_mfma_f32_16x16x32_bf16 v[112:115], a[104:107], a[24:27], v[112:115]
    v_exp_f32 v73, v73
    v_mfma_f32_16x16x32_bf16 v[112:115], a[108:111], a[28:31], v[112:115]
    v_cvt_pk_bf16_f32 v35, v70, v71
    v_mul_f32 v75, s20, v75
    v_mfma_f32_16x16x32_bf16 v[116:119], a[124:127], a[28:31], v[24:27]
    v_exp_f32 v74, v74
    v_mul_f32 v76, s20, v76
    v_mfma_f32_16x16x32_bf16 v[116:119], a[120:123], a[24:27], v[116:119]
    v_exp_f32 v75, v75
    v_mfma_f32_16x16x32_bf16 v[116:119], a[116:119], a[20:23], v[116:119]
    buffer_load_dwordx4 v1, s[8:11], s62 offen offset:1024 nt lds
    v_mfma_f32_16x16x32_bf16 v[116:119], a[112:115], a[16:19], v[116:119]
    s_waitcnt vmcnt(15)
    v_cvt_pk_bf16_f32 v36, v72, v73
    v_mul_f32 v77, s20, v77
    v_mfma_f32_16x16x32_bf16 v[120:123], a[128:131], a[16:19], v[24:27]
    s_barrier
    v_exp_f32 v76, v76
    v_mfma_f32_16x16x32_bf16 v[120:123], a[132:135], a[20:23], v[120:123]
    v_mul_f32 v78, s20, v78
    v_cvt_pk_bf16_f32 v37, v74, v75
    v_mfma_f32_16x16x32_bf16 v[120:123], a[136:139], a[24:27], v[120:123]
    v_exp_f32 v77, v77
    v_mfma_f32_16x16x32_bf16 v[120:123], a[140:143], a[28:31], v[120:123]
    v_mul_f32 v79, s20, v79
    v_exp_f32 v78, v78
    v_mfma_f32_16x16x32_bf16 v[124:127], a[156:159], a[28:31], v[24:27]
    v_mul_f32 v80, s20, v80
    v_cvt_pk_bf16_f32 v38, v76, v77
    v_mfma_f32_16x16x32_bf16 v[124:127], a[152:155], a[24:27], v[124:127]
    v_exp_f32 v79, v79
    v_mfma_f32_16x16x32_bf16 v[124:127], a[148:151], a[20:23], v[124:127]
    v_mul_f32 v81, s20, v81
    v_mul_f32 v82, s20, v82
    v_mfma_f32_16x16x32_bf16 v[124:127], a[144:147], a[16:19], v[124:127]
    v_exp_f32 v80, v80
    v_mfma_f32_16x16x32_bf16 a[232:235], a[240:243], v[48:51], a[232:235]
    v_exp_f32 v81, v81
    v_mfma_f32_16x16x32_bf16 a[232:235], a[240:243], v[52:55], a[232:235]
    ds_read_b128 a[96:99], v2 offset:16384
    v_cvt_pk_bf16_f32 v39, v78, v79
    v_mul_f32 v83, s20, v83
    v_mfma_f32_16x16x32_bf16 v[192:195], a[164:167], v[52:55], v[192:195]
    s_add_u32 m0, s22, 98304
    ds_read_b128 a[100:103], v2 offset:16640
    v_mul_f32 v84, s20, v84
    v_mfma_f32_16x16x32_bf16 v[192:195], a[160:163], v[48:51], v[192:195]
    buffer_load_dwordx4 v1, s[12:15], s60 offen offset:0 nt lds
    v_mfma_f32_16x16x32_bf16 v[196:199], a[168:171], v[48:51], v[196:199]
L_pad7:
    s_cbranch_execz L_back1
    ds_read_b128 a[104:107], v2 offset:16896
    ds_read_b128 a[108:111], v2 offset:17152
    v_mfma_f32_16x16x32_bf16 v[196:199], a[172:175], v[52:55], v[196:199]
    v_exp_f32 v82, v82
    v_mfma_f32_16x16x32_bf16 v[200:203], a[180:183], v[52:55], v[200:203]
    v_exp_f32 v83, v83
    v_mfma_f32_16x16x32_bf16 v[200:203], a[176:179], v[48:51], v[200:203]
    ds_read_b128 a[112:115], v2 offset:20480
    ds_read_b128 a[116:119], v2 offset:20736
    v_mfma_f32_16x16x32_bf16 v[204:207], a[184:187], v[48:51], v[204:207]
    v_cvt_pk_bf16_f32 v40, v80, v81
    v_mul_f32 v85, s20, v85
    v_mul_f32 v86, s20, v86
    v_mfma_f32_16x16x32_bf16 v[204:207], a[188:191], v[52:55], v[204:207]
    v_exp_f32 v84, v84
    v_mfma_f32_16x16x32_bf16 v[208:211], a[196:199], v[52:55], v[208:211]
    ds_read_b128 a[120:123], v2 offset:20992
    ds_read_b128 a[124:127], v2 offset:21248
    v_mfma_f32_16x16x32_bf16 v[208:211], a[192:195], v[48:51], v[208:211]
    v_exp_f32 v85, v85
    v_mfma_f32_16x16x32_bf16 v[212:215], a[200:203], v[48:51], v[212:215]
    ds_read_b128 a[128:131], v2 offset:24576
    v_cvt_pk_bf16_f32 v41, v82, v83
    v_mfma_f32_16x16x32_bf16 v[212:215], a[204:207], v[52:55], v[212:215]
    ds_read_b128 a[132:135], v2 offset:24832
    v_mul_f32 v87, s20, v87
    v_mfma_f32_16x16x32_bf16 v[216:219], a[212:215], v[52:55], v[216:219]
    v_exp_f32 v86, v86
    v_mfma_f32_16x16x32_bf16 v[216:219], a[208:211], v[48:51], v[216:219]
    ds_read_b128 a[136:139], v2 offset:25088
    buffer_load_dwordx4 v1, s[12:15], s60 offen offset:1024 nt lds
    v_mfma_f32_16x16x32_bf16 v[220:223], a[216:219], v[48:51], v[220:223]
    ds_read_b128 a[140:143], v2 offset:25344
    v_mul_f32 v88, s20, v88
    v_mfma_f32_16x16x32_bf16 v[220:223], a[220:223], v[52:55], v[220:223]
    v_exp_f32 v87, v87
    v_mfma_f32_16x16x32_bf16 a[236:239], a[240:243], v[56:59], a[236:239]
    ds_read_b128 a[144:147], v2 offset:28672
    v_cvt_pk_bf16_f32 v42, v84, v85
    v_mfma_f32_16x16x32_bf16 a[236:239], a[240:243], v[60:63], a[236:239]
    ds_read_b128 a[148:151], v2 offset:28928
    v_mul_f32 v89, s20, v89
    v_mfma_f32_16x16x32_bf16 v[224:227], a[164:167], v[60:63], v[224:227]
    v_exp_f32 v88, v88
    v_mfma_f32_16x16x32_bf16 v[224:227], a[160:163], v[56:59], v[224:227]
    ds_read_b128 a[152:155], v2 offset:29184
    v_mul_f32 v90, s20, v90
    v_mfma_f32_16x16x32_bf16 v[228:231], a[168:171], v[56:59], v[228:231]
    ds_read_b128 a[156:159], v2 offset:29440
    v_exp_f32 v89, v89
    v_mfma_f32_16x16x32_bf16 v[228:231], a[172:175], v[60:63], v[228:231]
    ds_read_b64_tr_b16 a[160:161], v3 offset:0
    v_cvt_pk_bf16_f32 v43, v86, v87
    v_mfma_f32_16x16x32_bf16 v[232:235], a[180:183], v[60:63], v[232:235]
    ds_read_b64_tr_b16 a[162:163], v3 offset:4096
    v_mul_f32 v91, s20, v91
    v_mfma_f32_16x16x32_bf16 v[232:235], a[176:179], v[56:59], v[232:235]
    v_exp_f32 v90, v90
    v_mfma_f32_16x16x32_bf16 v[236:239], a[184:187], v[56:59], v[236:239]
    ds_read_b64_tr_b16 a[164:165], v3 offset:8192
    v_mul_f32 v92, s20, v92
    v_mfma_f32_16x16x32_bf16 v[236:239], a[188:191], v[60:63], v[236:239]
    v_exp_f32 v91, v91
    v_mfma_f32_16x16x32_bf16 v[240:243], a[196:199], v[60:63], v[240:243]
    ds_read_b64_tr_b16 a[166:167], v3 offset:12288
    v_cvt_pk_bf16_f32 v44, v88, v89
    v_mfma_f32_16x16x32_bf16 v[240:243], a[192:195], v[56:59], v[240:243]
    buffer_store_dwordx4 a[44:47], v5, s[16:19], s27 offen offset:3072 sc1 nt
    ds_read_b64_tr_b16 a[168:169], v4 offset:0
    v_mfma_f32_16x16x32_bf16 v[244:247], a[200:203], v[56:59], v[244:247]
    ds_read_b64_tr_b16 a[170:171], v4 offset:4096
    v_mul_f32 v93, s20, v93
    v_mfma_f32_16x16x32_bf16 v[244:247], a[204:207], v[60:63], v[244:247]
    v_exp_f32 v92, v92
    v_mfma_f32_16x16x32_bf16 v[248:251], a[212:215], v[60:63], v[248:251]
    ds_read_b64_tr_b16 a[172:173], v4 offset:8192
    v_mul_f32 v94, s20, v94
    v_mfma_f32_16x16x32_bf16 v[248:251], a[208:211], v[56:59], v[248:251]
    v_exp_f32 v93, v93
    v_mfma_f32_16x16x32_bf16 v[252:255], a[216:219], v[56:59], v[252:255]
    ds_read_b64_tr_b16 a[174:175], v4 offset:12288
    v_cvt_pk_bf16_f32 v45, v90, v91
    v_mfma_f32_16x16x32_bf16 v[252:255], a[220:223], v[60:63], v[252:255]
    s_waitcnt lgkmcnt(8)
    v_mul_f32 v95, s20, v95
    v_exp_f32 v94, v94
L_n25:
    v_mfma_f32_16x16x32_bf16 v[64:67], a[96:99], a[64:67], v[12:15]
    v_exp_f32 v95, v95
    v_mfma_f32_16x16x32_bf16 v[64:67], a[100:103], a[68:71], v[64:67]
    ds_read_b64_tr_b16 a[176:177], v3 offset:256
    ds_read_b64_tr_b16 a[178:179], v3 offset:4352
    v_mfma_f32_16x16x32_bf16 v[64:67], a[104:107], a[72:75], v[64:67]
    ds_read_b64_tr_b16 a[180:181], v3 offset:8448
    v_cvt_pk_bf16_f32 v46, v92, v93
    v_mfma_f32_16x16x32_bf16 v[64:67], a[108:111], a[76:79], v[64:67]
    ds_read_b64_tr_b16 a[182:183], v3 offset:12544
    v_cvt_pk_bf16_f32 v47, v94, v95
    v_mfma_f32_16x16x32_bf16 v[68:71], a[124:127], a[76:79], v[12:15]
    ds_read_b64_tr_b16 a[184:185], v4 offset:256
    v_mul_f32 v96, s20, v96
    v_mfma_f32_16x16x32_bf16 v[68:71], a[120:123], a[72:75], v[68:71]
    ds_read_b64_tr_b16 a[186:187], v4 offset:4352
    v_mul_f32 v97, s20, v97
    v_mul_f32 v98, s20, v98
    v_mfma_f32_16x16x32_bf16 v[68:71], a[116:119], a[68:71], v[68:71]
    v_exp_f32 v96, v96
    v_mfma_f32_16x16x32_bf16 v[68:71], a[112:115], a[64:67], v[68:71]
    ds_read_b64_tr_b16 a[188:189], v4 offset:8448
    v_mul_f32 v99, s20, v99
    v_mfma_f32_16x16x32_bf16 v[72:75], a[128:131], a[64:67], v[12:15]
    s_add_u32 m0, s22, 57344
    ds_read_b64_tr_b16 a[190:191], v4 offset:12544
    ds_read_b64_tr_b16 a[192:193], v3 offset:512
    v_mfma_f32_16x16x32_bf16 v[72:75], a[132:135], a[68:71], v[72:75]
    buffer_load_dwordx4 v1, s[8:11], s63 offen offset:0 nt lds
    v_mfma_f32_16x16x32_bf16 v[72:75], a[136:139], a[72:75], v[72:75]
    ds_read_b64_tr_b16 a[194:195], v3 offset:4608
    ds_read_b64_tr_b16 a[196:197], v3 offset:8704
    v_mfma_f32_16x16x32_bf16 v[72:75], a[140:143], a[76:79], v[72:75]
    ds_read_b64_tr_b16 a[198:199], v3 offset:12800
    v_exp_f32 v97, v97
    v_mfma_f32_16x16x32_bf16 v[76:79], a[156:159], a[76:79], v[12:15]
    v_exp_f32 v98, v98
    v_mfma_f32_16x16x32_bf16 v[76:79], a[152:155], a[72:75], v[76:79]
    ds_read_b64_tr_b16 a[200:201], v4 offset:512
    v_mul_f32 v100, s20, v100
    v_mfma_f32_16x16x32_bf16 v[76:79], a[148:151], a[68:71], v[76:79]
    v_exp_f32 v99, v99
    v_mfma_f32_16x16x32_bf16 v[76:79], a[144:147], a[64:67], v[76:79]
    ds_read_b64_tr_b16 a[202:203], v4 offset:4608
    ds_read_b64_tr_b16 a[204:205], v4 offset:8704
    v_mfma_f32_16x16x32_bf16 v[80:83], a[96:99], a[80:83], v[16:19]
    ds_read_b64_tr_b16 a[206:207], v4 offset:12800
    v_cvt_pk_bf16_f32 v48, v96, v97
    v_mul_f32 v101, s20, v101
    v_mfma_f32_16x16x32_bf16 v[80:83], a[100:103], a[84:87], v[80:83]
    v_exp_f32 v100, v100
    v_mfma_f32_16x16x32_bf16 v[80:83], a[104:107], a[88:91], v[80:83]
    ds_read_b64_tr_b16 a[208:209], v3 offset:768
    ds_read_b64_tr_b16 a[210:211], v3 offset:4864
    v_mfma_f32_16x16x32_bf16 v[80:83], a[108:111], a[92:95], v[80:83]
    buffer_load_dwordx4 v1, s[8:11], s63 offen offset:1024 nt lds
    v_mfma_f32_16x16x32_bf16 v[84:87], a[124:127], a[92:95], v[16:19]
    ds_read_b64_tr_b16 a[212:213], v3 offset:8960
    ds_read_b64_tr_b16 a[214:215], v3 offset:13056
    v_mfma_f32_16x16x32_bf16 v[84:87], a[120:123], a[88:91], v[84:87]
    ds_read_b64_tr_b16 a[216:217], v4 offset:768
    v_mul_f32 v102, s20, v102
    v_mfma_f32_16x16x32_bf16 v[84:87], a[116:119], a[84:87], v[84:87]
    ds_read_b64_tr_b16 a[218:219], v4 offset:4864
    v_exp_f32 v101, v101
    v_mfma_f32_16x16x32_bf16 v[84:87], a[112:115], a[80:83], v[84:87]
    ds_read_b64_tr_b16 a[220:221], v4 offset:8960
    v_cvt_pk_bf16_f32 v49, v98, v99
    v_mfma_f32_16x16x32_bf16 v[88:91], a[128:131], a[80:83], v[16:19]
    ds_read_b64_tr_b16 a[222:223], v4 offset:13056
    v_mul_f32 v103, s20, v103
    v_mfma_f32_16x16x32_bf16 v[88:91], a[132:135], a[84:87], v[88:91]
    v_exp_f32 v102, v102
    v_mfma_f32_16x16x32_bf16 v[88:91], a[136:139], a[88:91], v[88:91]
    v_mul_f32 v104, s20, v104
    v_cvt_pk_bf16_f32 v50, v100, v101
    v_mfma_f32_16x16x32_bf16 v[88:91], a[140:143], a[92:95], v[88:91]
    s_add_u32 m0, s22, 106496
    v_exp_f32 v103, v103
    v_mfma_f32_16x16x32_bf16 v[92:95], a[156:159], a[92:95], v[16:19]
    v_mul_f32 v105, s20, v105
    v_exp_f32 v104, v104
    v_mfma_f32_16x16x32_bf16 v[92:95], a[152:155], a[88:91], v[92:95]
    buffer_load_dwordx4 v1, s[12:15], s61 offen offset:0 nt lds
    v_mfma_f32_16x16x32_bf16 v[92:95], a[148:151], a[84:87], v[92:95]
    v_mul_f32 v106, s20, v106
    v_cvt_pk_bf16_f32 v51, v102, v103
    v_mfma_f32_16x16x32_bf16 v[92:95], a[144:147], a[80:83], v[92:95]
    s_waitcnt lgkmcnt(0)
    v_exp_f32 v105, v105
    v_mfma_f32_16x16x32_bf16 a[224:227], a[240:243], v[32:35], a[224:227]
    v_mul_f32 v107, s20, v107
    v_mul_f32 v108, s20, v108
    v_mfma_f32_16x16x32_bf16 a[224:227], a[240:243], v[36:39], a[224:227]
    v_exp_f32 v106, v106
    v_cvt_pk_bf16_f32 v52, v104, v105
    v_mfma_f32_16x16x32_bf16 v[128:131], a[164:167], v[36:39], v[128:131]
    v_exp_f32 v107, v107
    v_mfma_f32_16x16x32_bf16 v[128:131], a[160:163], v[32:35], v[128:131]
    v_mul_f32 v109, s20, v109
    v_mul_f32 v110, s20, v110
    v_mfma_f32_16x16x32_bf16 v[132:135], a[168:171], v[32:35], v[132:135]
    v_exp_f32 v108, v108
    v_mfma_f32_16x16x32_bf16 v[132:135], a[172:175], v[36:39], v[132:135]
    v_exp_f32 v109, v109
    v_mfma_f32_16x16x32_bf16 v[136:139], a[180:183], v[36:39], v[136:139]
    v_cvt_pk_bf16_f32 v53, v106, v107
    v_mul_f32 v111, s20, v111
    v_mfma_f32_16x16x32_bf16 v[136:139], a[176:179], v[32:35], v[136:139]
    v_exp_f32 v110, v110
    v_mul_f32 v112, s20, v112
    v_mfma_f32_16x16x32_bf16 v[140:143], a[184:187], v[32:35], v[140:143]
    buffer_load_dwordx4 v1, s[12:15], s61 offen offset:1024 nt lds
    v_mfma_f32_16x16x32_bf16 v[140:143], a[188:191], v[36:39], v[140:143]
    v_exp_f32 v111, v111
    v_mfma_f32_16x16x32_bf16 v[144:147], a[196:199], v[36:39], v[144:147]
    v_cvt_pk_bf16_f32 v54, v108, v109
    v_mul_f32 v113, s20, v113
    v_mfma_f32_16x16x32_bf16 v[144:147], a[192:195], v[32:35], v[144:147]
    v_exp_f32 v112, v112
    v_mfma_f32_16x16x32_bf16 v[148:151], a[200:203], v[32:35], v[148:151]
    v_mul_f32 v114, s20, v114
    v_cvt_pk_bf16_f32 v55, v110, v111
    v_mfma_f32_16x16x32_bf16 v[148:151], a[204:207], v[36:39], v[148:151]
    v_exp_f32 v113, v113
    v_mul_f32 v115, s20, v115
    v_mfma_f32_16x16x32_bf16 v[152:155], a[212:215], v[36:39], v[152:155]
    v_exp_f32 v114, v114
    v_mfma_f32_16x16x32_bf16 v[152:155], a[208:211], v[32:35], v[152:155]
    v_mul_f32 v116, s20, v116
    v_cvt_pk_bf16_f32 v56, v112, v113
    v_mfma_f32_16x16x32_bf16 v[156:159], a[216:219], v[32:35], v[156:159]
    s_xor_b32 s27, s24, 12288
    v_exp_f32 v115, v115
    v_mfma_f32_16x16x32_bf16 v[156:159], a[220:223], v[36:39], v[156:159]
    v_mul_f32 v117, s20, v117
    v_mul_f32 v118, s20, v118
    v_mfma_f32_16x16x32_bf16 a[228:231], a[240:243], v[40:43], a[228:231]
    v_exp_f32 v116, v116
    v_cvt_pk_bf16_f32 v57, v114, v115
    v_mfma_f32_16x16x32_bf16 a[228:231], a[240:243], v[44:47], a[228:231]
    buffer_store_dwordx4 a[48:51], v5, s[16:19], s27 offen offset:0 sc1 nt
    v_mfma_f32_16x16x32_bf16 v[160:163], a[164:167], v[44:47], v[160:163]
    v_exp_f32 v117, v117
    v_mfma_f32_16x16x32_bf16 v[160:163], a[160:163], v[40:43], v[160:163]
    v_mul_f32 v119, s20, v119
    v_mul_f32 v120, s20, v120
    v_mfma_f32_16x16x32_bf16 v[164:167], a[168:171], v[40:43], v[164:167]
    v_exp_f32 v118, v118
    v_mfma_f32_16x16x32_bf16 v[164:167], a[172:175], v[44:47], v[164:167]
    v_exp_f32 v119, v119
    v_mfma_f32_16x16x32_bf16 v[168:171], a[180:183], v[44:47], v[168:171]
    v_cvt_pk_bf16_f32 v58, v116, v117
    v_mul_f32 v121, s20, v121
    v_mul_f32 v122, s20, v122
    v_mfma_f32_16x16x32_bf16 v[168:171], a[176:179], v[40:43], v[168:171]
    v_exp_f32 v120, v120
    v_mfma_f32_16x16x32_bf16 v[172:175], a[184:187], v[40:43], v[172:175]
    v_exp_f32 v121, v121
    v_mfma_f32_16x16x32_bf16 v[172:175], a[188:191], v[44:47], v[172:175]
    v_cvt_pk_bf16_f32 v59, v118, v119
    v_mul_f32 v123, s20, v123
    v_mfma_f32_16x16x32_bf16 v[176:179], a[196:199], v[44:47], v[176:179]
    v_exp_f32 v122, v122
    v_mfma_f32_16x16x32_bf16 v[176:179], a[192:195], v[40:43], v[176:179]
    buffer_store_dwordx4 a[52:55], v5, s[16:19], s27 offen offset:1024 sc1 nt
    v_mfma_f32_16x16x32_bf16 v[180:183], a[200:203], v[40:43], v[180:183]
    v_mul_f32 v124, s20, v124
    v_exp_f32 v123, v123
    v_mfma_f32_16x16x32_bf16 v[180:183], a[204:207], v[44:47], v[180:183]
    v_cvt_pk_bf16_f32 v60, v120, v121
    v_mul_f32 v125, s20, v125
    v_mfma_f32_16x16x32_bf16 v[184:187], a[212:215], v[44:47], v[184:187]
    v_exp_f32 v124, v124
    v_mfma_f32_16x16x32_bf16 v[184:187], a[208:211], v[40:43], v[184:187]
    v_mul_f32 v126, s20, v126
    v_cvt_pk_bf16_f32 v61, v122, v123
    v_mfma_f32_16x16x32_bf16 v[188:191], a[216:219], v[40:43], v[188:191]
    v_exp_f32 v125, v125
    v_mfma_f32_16x16x32_bf16 v[188:191], a[220:223], v[44:47], v[188:191]
    v_mul_f32 v127, s20, v127
    v_exp_f32 v126, v126
L_n26:
    v_mfma_f32_16x16x32_bf16 v[96:99], a[96:99], a[0:3], v[20:23]
    v_exp_f32 v127, v127
    v_mfma_f32_16x16x32_bf16 v[96:99], a[100:103], a[4:7], v[96:99]
    v_cvt_pk_bf16_f32 v62, v124, v125
    v_cvt_pk_bf16_f32 v63, v126, v127
    v_mfma_f32_16x16x32_bf16 v[96:99], a[104:107], a[8:11], v[96:99]
    v_mul_f32 v64, s20, v64
    v_mul_f32 v65, s20, v65
    v_mfma_f32_16x16x32_bf16 v[96:99], a[108:111], a[12:15], v[96:99]
    v_exp_f32 v64, v64
    v_mfma_f32_16x16x32_bf16 v[100:103], a[124:127], a[12:15], v[20:23]
    v_mul_f32 v66, s20, v66
    v_mul_f32 v67, s20, v67
    v_mfma_f32_16x16x32_bf16 v[100:103], a[120:123], a[8:11], v[100:103]
    v_exp_f32 v65, v65
    v_mfma_f32_16x16x32_bf16 v[100:103], a[116:119], a[4:7], v[100:103]
    v_exp_f32 v66, v66
    v_mfma_f32_16x16x32_bf16 v[100:103], a[112:115], a[0:3], v[100:103]
    v_mul_f32 v68, s20, v68
    v_cvt_pk_bf16_f32 v32, v64, v65
    v_mfma_f32_16x16x32_bf16 v[104:107], a[128:131], a[0:3], v[20:23]
    v_exp_f32 v67, v67
    v_mfma_f32_16x16x32_bf16 v[104:107], a[132:135], a[4:7], v[104:107]
    v_mul_f32 v69, s20, v69
    v_mul_f32 v70, s20, v70
    v_mfma_f32_16x16x32_bf16 v[104:107], a[136:139], a[8:11], v[104:107]
    v_exp_f32 v68, v68
    v_mfma_f32_16x16x32_bf16 v[104:107], a[140:143], a[12:15], v[104:107]
    s_add_u32 m0, s22, 114688
    v_exp_f32 v69, v69
    v_cvt_pk_bf16_f32 v33, v66, v67
    v_mfma_f32_16x16x32_bf16 v[108:111], a[156:159], a[12:15], v[20:23]
    v_mul_f32 v71, s20, v71
    v_mul_f32 v72, s20, v72
    v_mfma_f32_16x16x32_bf16 v[108:111], a[152:155], a[8:11], v[108:111]
    v_exp_f32 v70, v70
    v_mfma_f32_16x16x32_bf16 v[108:111], a[148:151], a[4:7], v[108:111]
    buffer_load_dwordx4 v1, s[12:15], s62 offen offset:0 nt lds
    v_mfma_f32_16x16x32_bf16 v[108:111], a[144:147], a[0:3], v[108:111]
    v_exp_f32 v71, v71
    v_mfma_f32_16x16x32_bf16 v[112:115], a[96:99], a[16:19], v[24:27]
    v_cvt_pk_bf16_f32 v34, v68, v69
    v_mul_f32 v73, s20, v73
    v_mfma_f32_16x16x32_bf16 v[112:115], a[100:103], a[20:23], v[112:115]
    v_exp_f32 v72, v72
    v_mfma_f32_16x16x32_bf16 v[112:115], a[104:107], a[24:27], v[112:115]
    v_mul_f32 v74, s20, v74
    v_cvt_pk_bf16_f32 v35, v70, v71
    v_mfma_f32_16x16x32_bf16 v[112:115], a[108:111], a[28:31], v[112:115]
    v_exp_f32 v73, v73
    v_mfma_f32_16x16x32_bf16 v[116:119], a[124:127], a[28:31], v[24:27]
    v_mul_f32 v75, s20, v75
    v_mul_f32 v76, s20, v76
    v_mfma_f32_16x16x32_bf16 v[116:119], a[120:123], a[24:27], v[116:119]
    v_exp_f32 v74, v74
    v_mfma_f32_16x16x32_bf16 v[116:119], a[116:119], a[20:23], v[116:119]
    v_exp_f32 v75, v75
    v_cvt_pk_bf16_f32 v36, v72, v73
    v_mfma_f32_16x16x32_bf16 v[116:119], a[112:115], a[16:19], v[116:119]
    s_waitcnt vmcnt(14)
    v_mul_f32 v77, s20, v77
    v_mul_f32 v78, s20, v78
    v_mfma_f32_16x16x32_bf16 v[120:123], a[128:131], a[16:19], v[24:27]
    s_barrier
    v_exp_f32 v76, v76
    v_mfma_f32_16x16x32_bf16 v[120:123], a[132:135], a[20:23], v[120:123]
    v_exp_f32 v77, v77
    v_mfma_f32_16x16x32_bf16 v[120:123], a[136:139], a[24:27], v[120:123]
    v_cvt_pk_bf16_f32 v37, v74, v75
    v_mul_f32 v79, s20, v79
    v_mfma_f32_16x16x32_bf16 v[120:123], a[140:143], a[28:31], v[120:123]
    v_exp_f32 v78, v78
    v_mfma_f32_16x16x32_bf16 v[124:127], a[156:159], a[28:31], v[24:27]
    v_mul_f32 v80, s20, v80
    v_cvt_pk_bf16_f32 v38, v76, v77
    v_mfma_f32_16x16x32_bf16 v[124:127], a[152:155], a[24:27], v[124:127]
    v_exp_f32 v79, v79
    v_mfma_f32_16x16x32_bf16 v[124:127], a[148:151], a[20:23], v[124:127]
    v_mul_f32 v81, s20, v81
    v_mul_f32 v82, s20, v82
    v_mfma_f32_16x16x32_bf16 v[124:127], a[144:147], a[16:19], v[124:127]
    v_exp_f32 v80, v80
    v_mfma_f32_16x16x32_bf16 a[232:235], a[240:243], v[48:51], a[232:235]
    v_exp_f32 v81, v81
    v_mfma_f32_16x16x32_bf16 a[232:235], a[240:243], v[52:55], a[232:235]
    ds_read_b128 a[96:99], v2 offset:32768
    ds_read_b128 a[100:103], v2 offset:33024
    v_cvt_pk_bf16_f32 v39, v78, v79
    v_mfma_f32_16x16x32_bf16 v[192:195], a[164:167], v[52:55], v[192:195]
    buffer_load_dwordx4 v1, s[12:15], s62 offen offset:1024 nt lds
    v_mfma_f32_16x16x32_bf16 v[192:195], a[160:163], v[48:51], v[192:195]
    ds_read_b128 a[104:107], v2 offset:33280
    v_mul_f32 v83, s20, v83
    v_mfma_f32_16x16x32_bf16 v[196:199], a[168:171], v[48:51], v[196:199]
    v_exp_f32 v82, v82
    v_mfma_f32_16x16x32_bf16 v[196:199], a[172:175], v[52:55], v[196:199]
    ds_read_b128 a[108:111], v2 offset:33536
    v_mul_f32 v84, s20, v84
    v_mfma_f32_16x16x32_bf16 v[200:203], a[180:183], v[52:55], v[200:203]
    v_exp_f32 v83, v83
    v_mfma_f32_16x16x32_bf16 v[200:203], a[176:179], v[48:51], v[200:203]
    ds_read_b128 a[112:115], v2 offset:36864
    ds_read_b128 a[116:119], v2 offset:37120
    v_mfma_f32_16x16x32_bf16 v[204:207], a[184:187], v[48:51], v[204:207]
    v_cvt_pk_bf16_f32 v40, v80, v81
    v_mul_f32 v85, s20, v85
    v_mfma_f32_16x16x32_bf16 v[204:207], a[188:191], v[52:55], v[204:207]
    v_exp_f32 v84, v84
    v_mfma_f32_16x16x32_bf16 v[208:211], a[196:199], v[52:55], v[208:211]
    ds_read_b128 a[120:123], v2 offset:37376
    ds_read_b128 a[124:127], v2 offset:37632
    v_mfma_f32_16x16x32_bf16 v[208:211], a[192:195], v[48:51], v[208:211]
    v_mul_f32 v86, s20, v86
    v_cvt_pk_bf16_f32 v41, v82, v83
    v_mfma_f32_16x16x32_bf16 v[212:215], a[200:203], v[48:51], v[212:215]
    v_exp_f32 v85, v85
    v_mfma_f32_16x16x32_bf16 v[212:215], a[204:207], v[52:55], v[212:215]
    ds_read_b128 a[128:131], v2 offset:40960
    ds_read_b128 a[132:135], v2 offset:41216
    v_mul_f32 v87, s20, v87
    v_mfma_f32_16x16x32_bf16 v[216:219], a[212:215], v[52:55], v[216:219]
    v_exp_f32 v86, v86
    v_mfma_f32_16x16x32_bf16 v[216:219], a[208:211], v[48:51], v[216:219]
    ds_read_b128 a[136:139], v2 offset:41472
    v_mul_f32 v88, s20, v88
    v_mfma_f32_16x16x32_bf16 v[220:223], a[216:219], v[48:51], v[220:223]
    v_exp_f32 v87, v87
    v_mfma_f32_16x16x32_bf16 v[220:223], a[220:223], v[52:55], v[220:223]
    ds_read_b128 a[140:143], v2 offset:41728
    v_cvt_pk_bf16_f32 v42, v84, v85
    v_mfma_f32_16x16x32_bf16 a[236:239], a[240:243], v[56:59], a[236:239]
    ds_read_b128 a[144:147], v2 offset:45056
    v_mul_f32 v89, s20, v89
    v_mfma_f32_16x16x32_bf16 a[236:239], a[240:243], v[60:63], a[236:239]
    v_exp_f32 v88, v88
    v_mfma_f32_16x16x32_bf16 v[224:227], a[164:167], v[60:63], v[224:227]
    ds_read_b128 a[148:151], v2 offset:45312
    v_mul_f32 v90, s20, v90
    v_mfma_f32_16x16x32_bf16 v[224:227], a[160:163], v[56:59], v[224:227]
    v_exp_f32 v89, v89
    v_mfma_f32_16x16x32_bf16 v[228:231], a[168:171], v[56:59], v[228:231]
    ds_read_b128 a[152:155], v2 offset:45568
    ds_read_b128 a[156:159], v2 offset:45824
    v_mfma_f32_16x16x32_bf16 v[228:231], a[172:175], v[60:63], v[228:231]
    ds_read_b64_tr_b16 a[160:161], v3 offset:16384
    v_cvt_pk_bf16_f32 v43, v86, v87
    v_mfma_f32_16x16x32_bf16 v[232:235], a[180:183], v[60:63], v[232:235]
    buffer_store_dwordx4 a[56:59], v5, s[16:19], s27 offen offset:2048 sc1 nt
    ds_read_b64_tr_b16 a[162:163], v3 offset:20480
    v_mfma_f32_16x16x32_bf16 v[232:235], a[176:179], v[56:59], v[232:235]
    v_mul_f32 v91, s20, v91
    v_mul_f32 v92, s20, v92
    v_mfma_f32_16x16x32_bf16 v[236:239], a[184:187], v[56:59], v[236:239]
    v_exp_f32 v90, v90
    v_mfma_f32_16x16x32_bf16 v[236:239], a[188:191], v[60:63], v[236:239]
    ds_read_b64_tr_b16 a[164:165], v3 offset:24576
    ds_read_b64_tr_b16 a[166:167], v3 offset:28672
    v_mfma_f32_16x16x32_bf16 v[240:243], a[196:199], v[60:63], v[240:243]
    v_exp_f32 v91, v91
    v_mfma_f32_16x16x32_bf16 v[240:243], a[192:195], v[56:59], v[240:243]
    ds_read_b64_tr_b16 a[168:169], v4 offset:16384
    v_cvt_pk_bf16_f32 v44, v88, v89
    v_mfma_f32_16x16x32_bf16 v[244:247], a[200:203], v[56:59], v[244:247]
    ds_read_b64_tr_b16 a[170:171], v4 offset:20480
    v_mul_f32 v93, s20, v93
    v_mfma_f32_16x16x32_bf16 v[244:247], a[204:207], v[60:63], v[244:247]
    v_exp_f32 v92, v92
    v_mfma_f32_16x16x32_bf16 v[248:251], a[212:215], v[60:63], v[248:251]
    ds_read_b64_tr_b16 a[172:173], v4 offset:24576
    v_mul_f32 v94, s20, v94
    v_mfma_f32_16x16x32_bf16 v[248:251], a[208:211], v[56:59], v[248:251]
    v_exp_f32 v93, v93
    v_mfma_f32_16x16x32_bf16 v[252:255], a[216:219], v[56:59], v[252:255]
    ds_read_b64_tr_b16 a[174:175], v4 offset:28672
    v_cvt_pk_bf16_f32 v45, v90, v91
    v_mfma_f32_16x16x32_bf16 v[252:255], a[220:223], v[60:63], v[252:255]
    s_waitcnt lgkmcnt(8)
    v_mul_f32 v95, s20, v95
    v_exp_f32 v94, v94
L_n27:
    v_mfma_f32_16x16x32_bf16 v[64:67], a[96:99], a[64:67], v[12:15]
    v_exp_f32 v95, v95
    v_mfma_f32_16x16x32_bf16 v[64:67], a[100:103], a[68:71], v[64:67]
    ds_read_b64_tr_b16 a[176:177], v3 offset:16640
    ds_read_b64_tr_b16 a[178:179], v3 offset:20736
    v_mfma_f32_16x16x32_bf16 v[64:67], a[104:107], a[72:75], v[64:67]
    ds_read_b64_tr_b16 a[180:181], v3 offset:24832
    v_cvt_pk_bf16_f32 v46, v92, v93
    v_mfma_f32_16x16x32_bf16 v[64:67], a[108:111], a[76:79], v[64:67]
    ds_read_b64_tr_b16 a[182:183], v3 offset:28928
    v_cvt_pk_bf16_f32 v47, v94, v95
    v_mfma_f32_16x16x32_bf16 v[68:71], a[124:127], a[76:79], v[12:15]
    ds_read_b64_tr_b16 a[184:185], v4 offset:16640
    v_mul_f32 v96, s20, v96
    v_mfma_f32_16x16x32_bf16 v[68:71], a[120:123], a[72:75], v[68:71]
    ds_read_b64_tr_b16 a[186:187], v4 offset:20736
    v_mul_f32 v97, s20, v97
    v_mfma_f32_16x16x32_bf16 v[68:71], a[116:119], a[68:71], v[68:71]
    v_exp_f32 v96, v96
    v_mfma_f32_16x16x32_bf16 v[68:71], a[112:115], a[64:67], v[68:71]
    ds_read_b64_tr_b16 a[188:189], v4 offset:24832
    ds_read_b64_tr_b16 a[190:191], v4 offset:28928
    v_mfma_f32_16x16x32_bf16 v[72:75], a[128:131], a[64:67], v[12:15]
    ds_read_b64_tr_b16 a[192:193], v3 offset:16896
    v_mul_f32 v98, s20, v98
    v_mfma_f32_16x16x32_bf16 v[72:75], a[132:135], a[68:71], v[72:75]
    v_exp_f32 v97, v97
    v_mfma_f32_16x16x32_bf16 v[72:75], a[136:139], a[72:75], v[72:75]
    ds_read_b64_tr_b16 a[194:195], v3 offset:20992
    ds_read_b64_tr_b16 a[196:197], v3 offset:25088
    v_mfma_f32_16x16x32_bf16 v[72:75], a[140:143], a[76:79], v[72:75]
    ds_read_b64_tr_b16 a[198:199], v3 offset:29184
    v_mul_f32 v99, s20, v99
    v_mul_f32 v100, s20, v100
    v_mfma_f32_16x16x32_bf16 v[76:79], a[156:159], a[76:79], v[12:15]
    s_add_u32 m0, s22, 122880
    v_exp_f32 v98, v98
    v_mfma_f32_16x16x32_bf16 v[76:79], a[152:155], a[72:75], v[76:79]
    v_exp_f32 v99, v99
    v_mfma_f32_16x16x32_bf16 v[76:79], a[148:151], a[68:71], v[76:79]
    ds_read_b64_tr_b16 a[200:201], v4 offset:16896
    v_cvt_pk_bf16_f32 v48, v96, v97
    v_mfma_f32_16x16x32_bf16 v[76:79], a[144:147], a[64:67], v[76:79]
    buffer_load_dwordx4 v1, s[12:15], s63 offen offset:0 nt lds
    v_mfma_f32_16x16x32_bf16 v[80:83], a[96:99], a[80:83], v[16:19]
    ds_read_b64_tr_b16 a[202:203], v4 offset:20992
    ds_read_b64_tr_b16 a[204:205], v4 offset:25088
    v_mfma_f32_16x16x32_bf16 v[80:83], a[100:103], a[84:87], v[80:83]
    ds_read_b64_tr_b16 a[206:207], v4 offset:29184
    ds_read_b64_tr_b16 a[208:209], v3 offset:17152
    v_mfma_f32_16x16x32_bf16 v[80:83], a[104:107], a[88:91], v[80:83]
    ds_read_b64_tr_b16 a[210:211], v3 offset:21248
    v_mul_f32 v101, s20, v101
    v_mfma_f32_16x16x32_bf16 v[80:83], a[108:111], a[92:95], v[80:83]
    v_exp_f32 v100, v100
    v_mfma_f32_16x16x32_bf16 v[84:87], a[124:127], a[92:95], v[16:19]
    ds_read_b64_tr_b16 a[212:213], v3 offset:25344
    ds_read_b64_tr_b16 a[214:215], v3 offset:29440
    v_mfma_f32_16x16x32_bf16 v[84:87], a[120:123], a[88:91], v[84:87]
    ds_read_b64_tr_b16 a[216:217], v4 offset:17152
    v_mul_f32 v102, s20, v102
    v_mfma_f32_16x16x32_bf16 v[84:87], a[116:119], a[84:87], v[84:87]
    ds_read_b64_tr_b16 a[218:219], v4 offset:21248
    v_exp_f32 v101, v101
    v_mfma_f32_16x16x32_bf16 v[84:87], a[112:115], a[80:83], v[84:87]
    ds_read_b64_tr_b16 a[220:221], v4 offset:25344
    v_cvt_pk_bf16_f32 v49, v98, v99
    v_mfma_f32_16x16x32_bf16 v[88:91], a[128:131], a[80:83], v[16:19]
    ds_read_b64_tr_b16 a[222:223], v4 offset:29440
    v_mul_f32 v103, s20, v103
    v_mfma_f32_16x16x32_bf16 v[88:91], a[132:135], a[84:87], v[88:91]
    v_exp_f32 v102, v102
    v_mfma_f32_16x16x32_bf16 v[88:91], a[136:139], a[88:91], v[88:91]
    v_mul_f32 v104, s20, v104
    v_cvt_pk_bf16_f32 v50, v100, v101
    v_mfma_f32_16x16x32_bf16 v[88:91], a[140:143], a[92:95], v[88:91]
    v_exp_f32 v103, v103
    v_mfma_f32_16x16x32_bf16 v[92:95], a[156:159], a[92:95], v[16:19]
    v_mul_f32 v105, s20, v105
    v_mul_f32 v106, s20, v106
    v_mfma_f32_16x16x32_bf16 v[92:95], a[152:155], a[88:91], v[92:95]
    v_exp_f32 v104, v104
    v_mfma_f32_16x16x32_bf16 v[92:95], a[148:151], a[84:87], v[92:95]
    v_exp_f32 v105, v105
    v_mfma_f32_16x16x32_bf16 v[92:95], a[144:147], a[80:83], v[92:95]
    s_waitcnt lgkmcnt(0)
    v_cvt_pk_bf16_f32 v51, v102, v103
    v_mul_f32 v107, s20, v107
    v_mfma_f32_16x16x32_bf16 a[224:227], a[240:243], v[32:35], a[224:227]
    v_exp_f32 v106, v106
    v_mfma_f32_16x16x32_bf16 a[224:227], a[240:243], v[36:39], a[224:227]
    v_mul_f32 v108, s20, v108
    v_exp_f32 v107, v107
    v_mfma_f32_16x16x32_bf16 v[128:131], a[164:167], v[36:39], v[128:131]
    buffer_load_dwordx4 v1, s[12:15], s63 offen offset:1024 nt lds
    v_mfma_f32_16x16x32_bf16 v[128:131], a[160:163], v[32:35], v[128:131]
    v_cvt_pk_bf16_f32 v52, v104, v105
    v_mul_f32 v109, s20, v109
    v_mfma_f32_16x16x32_bf16 v[132:135], a[168:171], v[32:35], v[132:135]
    v_exp_f32 v108, v108
    v_mfma_f32_16x16x32_bf16 v[132:135], a[172:175], v[36:39], v[132:135]
    v_mul_f32 v110, s20, v110
    v_cvt_pk_bf16_f32 v53, v106, v107
    v_mfma_f32_16x16x32_bf16 v[136:139], a[180:183], v[36:39], v[136:139]
    v_exp_f32 v109, v109
    v_mfma_f32_16x16x32_bf16 v[136:139], a[176:179], v[32:35], v[136:139]
    v_mul_f32 v111, s20, v111
    v_mul_f32 v112, s20, v112
    v_mfma_f32_16x16x32_bf16 v[140:143], a[184:187], v[32:35], v[140:143]
    v_exp_f32 v110, v110
    v_mfma_f32_16x16x32_bf16 v[140:143], a[188:191], v[36:39], v[140:143]
    v_exp_f32 v111, v111
    v_mfma_f32_16x16x32_bf16 v[144:147], a[196:199], v[36:39], v[144:147]
    v_cvt_pk_bf16_f32 v54, v108, v109
    v_mul_f32 v113, s20, v113
    v_mfma_f32_16x16x32_bf16 v[144:147], a[192:195], v[32:35], v[144:147]
    v_exp_f32 v112, v112
    v_mfma_f32_16x16x32_bf16 v[148:151], a[200:203], v[32:35], v[148:151]
    v_mul_f32 v114, s20, v114
    v_cvt_pk_bf16_f32 v55, v110, v111
    v_mfma_f32_16x16x32_bf16 v[148:151], a[204:207], v[36:39], v[148:151]
    v_exp_f32 v113, v113
    v_mul_f32 v115, s20, v115
    v_mfma_f32_16x16x32_bf16 v[152:155], a[212:215], v[36:39], v[152:155]
    v_exp_f32 v114, v114
    v_mfma_f32_16x16x32_bf16 v[152:155], a[208:211], v[32:35], v[152:155]
    v_mul_f32 v116, s20, v116
    v_cvt_pk_bf16_f32 v56, v112, v113
    v_mfma_f32_16x16x32_bf16 v[156:159], a[216:219], v[32:35], v[156:159]
    v_exp_f32 v115, v115
    v_mfma_f32_16x16x32_bf16 v[156:159], a[220:223], v[36:39], v[156:159]
    v_mul_f32 v117, s20, v117
    v_mul_f32 v118, s20, v118
    v_mfma_f32_16x16x32_bf16 a[228:231], a[240:243], v[40:43], a[228:231]
    v_exp_f32 v116, v116
    v_mfma_f32_16x16x32_bf16 a[228:231], a[240:243], v[44:47], a[228:231]
    v_exp_f32 v117, v117
    v_mfma_f32_16x16x32_bf16 v[160:163], a[164:167], v[44:47], v[160:163]
    v_cvt_pk_bf16_f32 v57, v114, v115
    v_mul_f32 v119, s20, v119
    v_mfma_f32_16x16x32_bf16 v[160:163], a[160:163], v[40:43], v[160:163]
    v_exp_f32 v118, v118
    v_mfma_f32_16x16x32_bf16 v[164:167], a[168:171], v[40:43], v[164:167]
    v_mul_f32 v120, s20, v120
    v_cvt_pk_bf16_f32 v58, v116, v117
    v_mfma_f32_16x16x32_bf16 v[164:167], a[172:175], v[44:47], v[164:167]
    v_exp_f32 v119, v119
    v_mfma_f32_16x16x32_bf16 v[168:171], a[180:183], v[44:47], v[168:171]
    buffer_store_dwordx4 a[60:63], v5, s[16:19], s27 offen offset:3072 sc1 nt
    v_mul_f32 v121, s20, v121
    v_mfma_f32_16x16x32_bf16 v[168:171], a[176:179], v[40:43], v[168:171]
    v_exp_f32 v120, v120
    v_mfma_f32_16x16x32_bf16 v[172:175], a[184:187], v[40:43], v[172:175]
    v_mul_f32 v122, s20, v122
    v_cvt_pk_bf16_f32 v59, v118, v119
    v_mfma_f32_16x16x32_bf16 v[172:175], a[188:191], v[44:47], v[172:175]
    v_exp_f32 v121, v121
    v_mfma_f32_16x16x32_bf16 v[176:179], a[196:199], v[44:47], v[176:179]
    v_mul_f32 v123, s20, v123
    v_mul_f32 v124, s20, v124
    v_mfma_f32_16x16x32_bf16 v[176:179], a[192:195], v[40:43], v[176:179]
    v_exp_f32 v122, v122
    v_mfma_f32_16x16x32_bf16 v[180:183], a[200:203], v[40:43], v[180:183]
    v_exp_f32 v123, v123
    v_mfma_f32_16x16x32_bf16 v[180:183], a[204:207], v[44:47], v[180:183]
    v_cvt_pk_bf16_f32 v60, v120, v121
    v_mul_f32 v125, s20, v125
    v_mfma_f32_16x16x32_bf16 v[184:187], a[212:215], v[44:47], v[184:187]
    v_exp_f32 v124, v124
    v_mfma_f32_16x16x32_bf16 v[184:187], a[208:211], v[40:43], v[184:187]
    v_mul_f32 v126, s20, v126
    v_cvt_pk_bf16_f32 v61, v122, v123
    v_mfma_f32_16x16x32_bf16 v[188:191], a[216:219], v[40:43], v[188:191]
    v_exp_f32 v125, v125
    v_mfma_f32_16x16x32_bf16 v[188:191], a[220:223], v[44:47], v[188:191]
L_pad8:
    s_cbranch_execz L_back2
    v_mul_f32 v127, s20, v127
    v_exp_f32 v126, v126
L_n28:
    v_mfma_f32_16x16x32_bf16 v[96:99], a[96:99], a[0:3], v[20:23]
    v_exp_f32 v127, v127
    v_mfma_f32_16x16x32_bf16 v[96:99], a[100:103], a[4:7], v[96:99]
    v_cvt_pk_bf16_f32 v62, v124, v125
    v_cvt_pk_bf16_f32 v63, v126, v127
    v_mfma_f32_16x16x32_bf16 v[96:99], a[104:107], a[8:11], v[96:99]
    v_mul_f32 v64, s20, v64
    v_mul_f32 v65, s20, v65
    v_mfma_f32_16x16x32_bf16 v[96:99], a[108:111], a[12:15], v[96:99]
    v_exp_f32 v64, v64
    v_mfma_f32_16x16x32_bf16 v[100:103], a[124:127], a[12:15], v[20:23]
    v_mul_f32 v66, s20, v66
    v_exp_f32 v65, v65
    v_mfma_f32_16x16x32_bf16 v[100:103], a[120:123], a[8:11], v[100:103]
    v_mul_f32 v67, s20, v67
    v_mul_f32 v68, s20, v68
    v_mfma_f32_16x16x32_bf16 v[100:103], a[116:119], a[4:7], v[100:103]
    v_exp_f32 v66, v66
    v_mfma_f32_16x16x32_bf16 v[100:103], a[112:115], a[0:3], v[100:103]
    v_exp_f32 v67, v67
    v_mfma_f32_16x16x32_bf16 v[104:107], a[128:131], a[0:3], v[20:23]
    v_cvt_pk_bf16_f32 v32, v64, v65
    v_mul_f32 v69, s20, v69
    v_mul_f32 v70, s20, v70
    v_mfma_f32_16x16x32_bf16 v[104:107], a[132:135], a[4:7], v[104:107]
    v_exp_f32 v68, v68
    v_mfma_f32_16x16x32_bf16 v[104:107], a[136:139], a[8:11], v[104:107]
    v_exp_f32 v69, v69
    v_mfma_f32_16x16x32_bf16 v[104:107], a[140:143], a[12:15], v[104:107]
    v_cvt_pk_bf16_f32 v33, v66, v67
    v_mul_f32 v71, s20, v71
    v_mfma_f32_16x16x32_bf16 v[108:111], a[156:159], a[12:15], v[20:23]
    v_exp_f32 v70, v70
    v_mul_f32 v72, s20, v72
    v_mfma_f32_16x16x32_bf16 v[108:111], a[152:155], a[8:11], v[108:111]
    v_exp_f32 v71, v71
    v_mfma_f32_16x16x32_bf16 v[108:111], a[148:151], a[4:7], v[108:111]
    v_cvt_pk_bf16_f32 v34, v68, v69
    v_mul_f32 v73, s20, v73
    v_mfma_f32_16x16x32_bf16 v[108:111], a[144:147], a[0:3], v[108:111]
    v_exp_f32 v72, v72
    v_mfma_f32_16x16x32_bf16 v[112:115], a[96:99], a[16:19], v[24:27]
    v_mul_f32 v74, s20, v74
    v_exp_f32 v73, v73
    v_mfma_f32_16x16x32_bf16 v[112:115], a[100:103], a[20:23], v[112:115]
    v_cvt_pk_bf16_f32 v35, v70, v71
    v_mul_f32 v75, s20, v75
    v_mfma_f32_16x16x32_bf16 v[112:115], a[104:107], a[24:27], v[112:115]
    v_exp_f32 v74, v74
    v_mfma_f32_16x16x32_bf16 v[112:115], a[108:111], a[28:31], v[112:115]
    v_mul_f32 v76, s20, v76
    v_cvt_pk_bf16_f32 v36, v72, v73
    v_mfma_f32_16x16x32_bf16 v[116:119], a[124:127], a[28:31], v[24:27]
    v_exp_f32 v75, v75
    v_mfma_f32_16x16x32_bf16 v[116:119], a[120:123], a[24:27], v[116:119]
    v_mul_f32 v77, s20, v77
    v_exp_f32 v76, v76
    v_mfma_f32_16x16x32_bf16 v[116:119], a[116:119], a[20:23], v[116:119]
    v_mul_f32 v78, s20, v78
    v_cvt_pk_bf16_f32 v37, v74, v75
    v_mfma_f32_16x16x32_bf16 v[116:119], a[112:115], a[16:19], v[116:119]
    s_waitcnt vmcnt(8)
    v_exp_f32 v77, v77
    v_mfma_f32_16x16x32_bf16 v[120:123], a[128:131], a[16:19], v[24:27]
    s_barrier
    v_mul_f32 v79, s20, v79
    v_mul_f32 v80, s20, v80
    v_mfma_f32_16x16x32_bf16 v[120:123], a[132:135], a[20:23], v[120:123]
    v_exp_f32 v78, v78
    v_cvt_pk_bf16_f32 v38, v76, v77
    v_mfma_f32_16x16x32_bf16 v[120:123], a[136:139], a[24:27], v[120:123]
    v_exp_f32 v79, v79
    v_mfma_f32_16x16x32_bf16 v[120:123], a[140:143], a[28:31], v[120:123]
    v_mul_f32 v81, s20, v81
    v_mul_f32 v82, s20, v82
    v_mfma_f32_16x16x32_bf16 v[124:127], a[156:159], a[28:31], v[24:27]
    v_exp_f32 v80, v80
    v_mfma_f32_16x16x32_bf16 v[124:127], a[152:155], a[24:27], v[124:127]
    v_exp_f32 v81, v81
    v_cvt_pk_bf16_f32 v39, v78, v79
    v_mfma_f32_16x16x32_bf16 v[124:127], a[148:151], a[20:23], v[124:127]
    v_mul_f32 v83, s20, v83
    v_mul_f32 v84, s20, v84
    v_mfma_f32_16x16x32_bf16 v[124:127], a[144:147], a[16:19], v[124:127]
    v_exp_f32 v82, v82
    v_mfma_f32_16x16x32_bf16 a[232:235], a[240:243], v[48:51], a[232:235]
    v_exp_f32 v83, v83
    v_mfma_f32_16x16x32_bf16 a[232:235], a[240:243], v[52:55], a[232:235]
    ds_read_b128 a[96:99], v2 offset:49152
    ds_read_b128 a[100:103], v2 offset:49408
    ds_read_b128 a[104:107], v2 offset:49664
    v_mfma_f32_16x16x32_bf16 v[192:195], a[164:167], v[52:55], v[192:195]
    ds_read_b128 a[108:111], v2 offset:49920
    v_cvt_pk_bf16_f32 v40, v80, v81
    v_mfma_f32_16x16x32_bf16 v[192:195], a[160:163], v[48:51], v[192:195]
    ds_read_b128 a[112:115], v2 offset:53248
    ds_read_b128 a[116:119], v2 offset:53504
    v_mfma_f32_16x16x32_bf16 v[196:199], a[168:171], v[48:51], v[196:199]
    ds_read_b128 a[120:123], v2 offset:53760
    v_mul_f32 v85, s20, v85
    v_mfma_f32_16x16x32_bf16 v[196:199], a[172:175], v[52:55], v[196:199]
    v_exp_f32 v84, v84
    v_mfma_f32_16x16x32_bf16 v[200:203], a[180:183], v[52:55], v[200:203]
    ds_read_b128 a[124:127], v2 offset:54016
    ds_read_b128 a[128:131], v2 offset:57344
    ds_read_b128 a[132:135], v2 offset:57600
    v_mfma_f32_16x16x32_bf16 v[200:203], a[176:179], v[48:51], v[200:203]
    ds_read_b128 a[136:139], v2 offset:57856
    v_mul_f32 v86, s20, v86
    v_mfma_f32_16x16x32_bf16 v[204:207], a[184:187], v[48:51], v[204:207]
    v_exp_f32 v85, v85
    v_mfma_f32_16x16x32_bf16 v[204:207], a[188:191], v[52:55], v[204:207]
    ds_read_b128 a[140:143], v2 offset:58112
    ds_read_b128 a[144:147], v2 offset:61440
    v_mfma_f32_16x16x32_bf16 v[208:211], a[196:199], v[52:55], v[208:211]
    ds_read_b128 a[148:151], v2 offset:61696
    ds_read_b128 a[152:155], v2 offset:61952
    v_cvt_pk_bf16_f32 v41, v82, v83
    v_mfma_f32_16x16x32_bf16 v[208:211], a[192:195], v[48:51], v[208:211]
    ds_read_b128 a[156:159], v2 offset:62208
    v_mul_f32 v87, s20, v87
    v_mfma_f32_16x16x32_bf16 v[212:215], a[200:203], v[48:51], v[212:215]
    v_exp_f32 v86, v86
    v_mfma_f32_16x16x32_bf16 v[212:215], a[204:207], v[52:55], v[212:215]
    ds_read_b64_tr_b16 a[32:33], v3 offset:33280
    ds_read_b64_tr_b16 a[34:35], v3 offset:37376
    v_mfma_f32_16x16x32_bf16 v[216:219], a[212:215], v[52:55], v[216:219]
    ds_read_b64_tr_b16 a[36:37], v3 offset:41472
    ds_read_b64_tr_b16 a[38:39], v3 offset:45568
    v_mul_f32 v88, s20, v88
    v_mfma_f32_16x16x32_bf16 v[216:219], a[208:211], v[48:51], v[216:219]
    v_exp_f32 v87, v87
    v_mfma_f32_16x16x32_bf16 v[220:223], a[216:219], v[48:51], v[220:223]
    ds_read_b64_tr_b16 a[40:41], v4 offset:33280
    ds_read_b64_tr_b16 a[42:43], v4 offset:37376
    v_mfma_f32_16x16x32_bf16 v[220:223], a[220:223], v[52:55], v[220:223]
    ds_read_b64_tr_b16 a[44:45], v4 offset:41472
    ds_read_b64_tr_b16 a[46:47], v4 offset:45568
    v_mfma_f32_16x16x32_bf16 a[236:239], a[240:243], v[56:59], a[236:239]
    ds_read_b64_tr_b16 a[48:49], v3 offset:33536
    ds_read_b64_tr_b16 a[50:51], v3 offset:37632
    v_cvt_pk_bf16_f32 v42, v84, v85
    v_mfma_f32_16x16x32_bf16 a[236:239], a[240:243], v[60:63], a[236:239]
    ds_read_b64_tr_b16 a[52:53], v3 offset:41728
    v_mul_f32 v89, s20, v89
    v_mfma_f32_16x16x32_bf16 v[224:227], a[164:167], v[60:63], v[224:227]
    v_exp_f32 v88, v88
    v_mfma_f32_16x16x32_bf16 v[224:227], a[160:163], v[56:59], v[224:227]
    ds_read_b64_tr_b16 a[54:55], v3 offset:45824
    ds_read_b64_tr_b16 a[56:57], v4 offset:33536
    v_mfma_f32_16x16x32_bf16 v[228:231], a[168:171], v[56:59], v[228:231]
    ds_read_b64_tr_b16 a[58:59], v4 offset:37632
    ds_read_b64_tr_b16 a[60:61], v4 offset:41728
    v_mfma_f32_16x16x32_bf16 v[228:231], a[172:175], v[60:63], v[228:231]
    ds_read_b64_tr_b16 a[62:63], v4 offset:45824
    ds_read_b64_tr_b16 a[160:161], v3 offset:32768
    v_mul_f32 v90, s20, v90
    v_mfma_f32_16x16x32_bf16 v[232:235], a[180:183], v[60:63], v[232:235]
    v_exp_f32 v89, v89
    v_mfma_f32_16x16x32_bf16 v[232:235], a[176:179], v[56:59], v[232:235]
    ds_read_b64_tr_b16 a[162:163], v3 offset:36864
    v_cvt_pk_bf16_f32 v43, v86, v87
    v_mfma_f32_16x16x32_bf16 v[236:239], a[184:187], v[56:59], v[236:239]
    ds_read_b64_tr_b16 a[164:165], v3 offset:40960
    v_mul_f32 v91, s20, v91
    v_mfma_f32_16x16x32_bf16 v[236:239], a[188:191], v[60:63], v[236:239]
    ds_read_b64_tr_b16 a[166:167], v3 offset:45056
    v_exp_f32 v90, v90
    v_mfma_f32_16x16x32_bf16 v[240:243], a[196:199], v[60:63], v[240:243]
    v_mul_f32 v92, s20, v92
    v_cvt_pk_bf16_f32 v44, v88, v89
    v_mfma_f32_16x16x32_bf16 v[240:243], a[192:195], v[56:59], v[240:243]
    v_exp_f32 v91, v91
    v_mfma_f32_16x16x32_bf16 v[244:247], a[200:203], v[56:59], v[244:247]
    ds_read_b64_tr_b16 a[168:169], v4 offset:32768
    ds_read_b64_tr_b16 a[170:171], v4 offset:36864
    v_mfma_f32_16x16x32_bf16 v[244:247], a[204:207], v[60:63], v[244:247]
    v_mul_f32 v93, s20, v93
    v_exp_f32 v92, v92
    v_mfma_f32_16x16x32_bf16 v[248:251], a[212:215], v[60:63], v[248:251]
    ds_read_b64_tr_b16 a[172:173], v4 offset:40960
    v_mul_f32 v94, s20, v94
    v_mfma_f32_16x16x32_bf16 v[248:251], a[208:211], v[56:59], v[248:251]
    v_exp_f32 v93, v93
    v_mfma_f32_16x16x32_bf16 v[252:255], a[216:219], v[56:59], v[252:255]
    ds_read_b64_tr_b16 a[174:175], v4 offset:45056
    v_cvt_pk_bf16_f32 v45, v90, v91
    v_mfma_f32_16x16x32_bf16 v[252:255], a[220:223], v[60:63], v[252:255]
    s_waitcnt lgkmcnt(15)
    v_mul_f32 v95, s20, v95
    v_exp_f32 v94, v94
L_n29:
    v_mfma_f32_16x16x32_bf16 v[64:67], a[96:99], a[64:67], v[12:15]
    v_exp_f32 v95, v95
    v_mfma_f32_16x16x32_bf16 v[64:67], a[100:103], a[68:71], v[64:67]
    ds_read_b64_tr_b16 a[176:177], v3 offset:33024
    ds_read_b64_tr_b16 a[178:179], v3 offset:37120
    v_mfma_f32_16x16x32_bf16 v[64:67], a[104:107], a[72:75], v[64:67]
    ds_read_b64_tr_b16 a[180:181], v3 offset:41216
    v_cvt_pk_bf16_f32 v46, v92, v93
    v_mfma_f32_16x16x32_bf16 v[64:67], a[108:111], a[76:79], v[64:67]
    ds_read_b64_tr_b16 a[182:183], v3 offset:45312
    v_cvt_pk_bf16_f32 v47, v94, v95
    v_mul_f32 v96, s20, v96
    v_mfma_f32_16x16x32_bf16 v[68:71], a[124:127], a[76:79], v[12:15]
    v_mul_f32 v97, s20, v97
    v_mul_f32 v98, s20, v98
    v_mfma_f32_16x16x32_bf16 v[68:71], a[120:123], a[72:75], v[68:71]
    v_exp_f32 v96, v96
    v_mfma_f32_16x16x32_bf16 v[68:71], a[116:119], a[68:71], v[68:71]
    ds_read_b64_tr_b16 a[184:185], v4 offset:33024
    v_exp_f32 v97, v97
    v_mfma_f32_16x16x32_bf16 v[68:71], a[112:115], a[64:67], v[68:71]
    ds_read_b64_tr_b16 a[186:187], v4 offset:37120
    ds_read_b64_tr_b16 a[188:189], v4 offset:41216
    v_mfma_f32_16x16x32_bf16 v[72:75], a[128:131], a[64:67], v[12:15]
    ds_read_b64_tr_b16 a[190:191], v4 offset:45312
    v_mul_f32 v99, s20, v99
    v_mfma_f32_16x16x32_bf16 v[72:75], a[132:135], a[68:71], v[72:75]
    v_exp_f32 v98, v98
    v_mul_f32 v100, s20, v100
    v_mfma_f32_16x16x32_bf16 v[72:75], a[136:139], a[72:75], v[72:75]
    v_exp_f32 v99, v99
    v_mfma_f32_16x16x32_bf16 v[72:75], a[140:143], a[76:79], v[72:75]
    v_cvt_pk_bf16_f32 v48, v96, v97
    v_mul_f32 v101, s20, v101
    v_mfma_f32_16x16x32_bf16 v[76:79], a[156:159], a[76:79], v[12:15]
    v_exp_f32 v100, v100
    v_mul_f32 v102, s20, v102
    v_mfma_f32_16x16x32_bf16 v[76:79], a[152:155], a[72:75], v[76:79]
    v_exp_f32 v101, v101
    v_mfma_f32_16x16x32_bf16 v[76:79], a[148:151], a[68:71], v[76:79]
    v_cvt_pk_bf16_f32 v49, v98, v99
    v_mul_f32 v103, s20, v103
    v_mfma_f32_16x16x32_bf16 v[76:79], a[144:147], a[64:67], v[76:79]
    s_waitcnt lgkmcnt(0)
    v_exp_f32 v102, v102
    v_mfma_f32_16x16x32_bf16 a[224:227], a[240:243], v[32:35], a[224:227]
    v_mul_f32 v104, s20, v104
    v_exp_f32 v103, v103
    v_mfma_f32_16x16x32_bf16 a[224:227], a[240:243], v[36:39], a[224:227]
    v_cvt_pk_bf16_f32 v50, v100, v101
    v_mul_f32 v105, s20, v105
    v_mfma_f32_16x16x32_bf16 v[128:131], a[164:167], v[36:39], v[128:131]
    v_exp_f32 v104, v104
    v_mfma_f32_16x16x32_bf16 v[128:131], a[160:163], v[32:35], v[128:131]
    v_mul_f32 v106, s20, v106
    v_exp_f32 v105, v105
    v_mfma_f32_16x16x32_bf16 v[132:135], a[168:171], v[32:35], v[132:135]
    v_cvt_pk_bf16_f32 v51, v102, v103
    v_mul_f32 v107, s20, v107
    v_mfma_f32_16x16x32_bf16 v[132:135], a[172:175], v[36:39], v[132:135]
    v_exp_f32 v106, v106
    v_mfma_f32_16x16x32_bf16 v[136:139], a[180:183], v[36:39], v[136:139]
    v_mul_f32 v108, s20, v108
    v_exp_f32 v107, v107
    v_mfma_f32_16x16x32_bf16 v[136:139], a[176:179], v[32:35], v[136:139]
    v_cvt_pk_bf16_f32 v52, v104, v105
    v_mul_f32 v109, s20, v109
    v_mfma_f32_16x16x32_bf16 v[140:143], a[184:187], v[32:35], v[140:143]
    v_exp_f32 v108, v108
    v_mfma_f32_16x16x32_bf16 v[140:143], a[188:191], v[36:39], v[140:143]
    v_mul_f32 v110, s20, v110
    v_exp_f32 v109, v109
    v_mfma_f32_16x16x32_bf16 v[144:147], a[36:39], v[36:39], v[144:147]
    v_cvt_pk_bf16_f32 v53, v106, v107
    v_mul_f32 v111, s20, v111
    v_mfma_f32_16x16x32_bf16 v[144:147], a[32:35], v[32:35], v[144:147]
    v_exp_f32 v110, v110
    v_mfma_f32_16x16x32_bf16 v[148:151], a[40:43], v[32:35], v[148:151]
    v_mul_f32 v112, s20, v112
    v_cvt_pk_bf16_f32 v54, v108, v109
    v_mfma_f32_16x16x32_bf16 v[148:151], a[44:47], v[36:39], v[148:151]
    v_exp_f32 v111, v111
    v_mul_f32 v113, s20, v113
    v_mfma_f32_16x16x32_bf16 v[152:155], a[52:55], v[36:39], v[152:155]
    v_exp_f32 v112, v112
    v_mfma_f32_16x16x32_bf16 v[152:155], a[48:51], v[32:35], v[152:155]
    v_mul_f32 v114, s20, v114
    v_cvt_pk_bf16_f32 v55, v110, v111
    v_mfma_f32_16x16x32_bf16 v[156:159], a[56:59], v[32:35], v[156:159]
    v_exp_f32 v113, v113
    v_mul_f32 v115, s20, v115
    v_mfma_f32_16x16x32_bf16 v[156:159], a[60:63], v[36:39], v[156:159]
    v_exp_f32 v114, v114
    v_mfma_f32_16x16x32_bf16 a[228:231], a[240:243], v[40:43], a[228:231]
    v_mul_f32 v116, s20, v116
    v_cvt_pk_bf16_f32 v56, v112, v113
    v_mfma_f32_16x16x32_bf16 a[228:231], a[240:243], v[44:47], a[228:231]
    v_exp_f32 v115, v115
    v_mul_f32 v117, s20, v117
    v_mfma_f32_16x16x32_bf16 v[160:163], a[164:167], v[44:47], v[160:163]
    v_exp_f32 v116, v116
    v_mfma_f32_16x16x32_bf16 v[160:163], a[160:163], v[40:43], v[160:163]
    v_mul_f32 v118, s20, v118
    v_cvt_pk_bf16_f32 v57, v114, v115
    v_mfma_f32_16x16x32_bf16 v[164:167], a[168:171], v[40:43], v[164:167]
    v_exp_f32 v117, v117
    v_mul_f32 v119, s20, v119
    v_mfma_f32_16x16x32_bf16 v[164:167], a[172:175], v[44:47], v[164:167]
    v_exp_f32 v118, v118
    v_mfma_f32_16x16x32_bf16 v[168:171], a[180:183], v[44:47], v[168:171]
    v_mul_f32 v120, s20, v120
    v_cvt_pk_bf16_f32 v58, v116, v117
    v_mfma_f32_16x16x32_bf16 v[168:171], a[176:179], v[40:43], v[168:171]
    v_exp_f32 v119, v119
    v_mfma_f32_16x16x32_bf16 v[172:175], a[184:187], v[40:43], v[172:175]
    v_mul_f32 v121, s20, v121
    v_exp_f32 v120, v120
    v_mfma_f32_16x16x32_bf16 v[172:175], a[188:191], v[44:47], v[172:175]
    v_mul_f32 v122, s20, v122
    v_cvt_pk_bf16_f32 v59, v118, v119
    v_mfma_f32_16x16x32_bf16 v[176:179], a[36:39], v[44:47], v[176:179]
    v_exp_f32 v121, v121
    v_mfma_f32_16x16x32_bf16 v[176:179], a[32:35], v[40:43], v[176:179]
    v_mul_f32 v123, s20, v123
    v_exp_f32 v122, v122
    v_mfma_f32_16x16x32_bf16 v[180:183], a[40:43], v[40:43], v[180:183]
    v_mul_f32 v124, s20, v124
    v_cvt_pk_bf16_f32 v60, v120, v121
    v_mfma_f32_16x16x32_bf16 v[180:183], a[44:47], v[44:47], v[180:183]
    v_exp_f32 v123, v123
    v_mfma_f32_16x16x32_bf16 v[184:187], a[52:55], v[44:47], v[184:187]
    v_mul_f32 v125, s20, v125
    v_exp_f32 v124, v124
    v_mfma_f32_16x16x32_bf16 v[184:187], a[48:51], v[40:43], v[184:187]
    v_mul_f32 v126, s20, v126
    v_cvt_pk_bf16_f32 v61, v122, v123
    v_mfma_f32_16x16x32_bf16 v[188:191], a[56:59], v[40:43], v[188:191]
    v_exp_f32 v125, v125
    v_mfma_f32_16x16x32_bf16 v[188:191], a[60:63], v[44:47], v[188:191]
    v_mul_f32 v127, s20, v127
    v_exp_f32 v126, v126
L_n30:
    v_mfma_f32_16x16x32_bf16 v[80:83], a[96:99], a[80:83], v[16:19]
    v_exp_f32 v127, v127
    v_mfma_f32_16x16x32_bf16 v[80:83], a[100:103], a[84:87], v[80:83]
    v_cvt_pk_bf16_f32 v62, v124, v125
    v_cvt_pk_bf16_f32 v63, v126, v127
    v_mfma_f32_16x16x32_bf16 v[80:83], a[104:107], a[88:91], v[80:83]
    v_mul_f32 v64, s20, v64
    v_mul_f32 v65, s20, v65
    v_mfma_f32_16x16x32_bf16 v[80:83], a[108:111], a[92:95], v[80:83]
    v_exp_f32 v64, v64
    v_mfma_f32_16x16x32_bf16 v[84:87], a[124:127], a[92:95], v[16:19]
    v_mul_f32 v66, s20, v66
    v_mul_f32 v67, s20, v67
    v_mfma_f32_16x16x32_bf16 v[84:87], a[120:123], a[88:91], v[84:87]
    v_exp_f32 v65, v65
    v_mfma_f32_16x16x32_bf16 v[84:87], a[116:119], a[84:87], v[84:87]
    v_mul_f32 v68, s20, v68
    v_mfma_f32_16x16x32_bf16 v[84:87], a[112:115], a[80:83], v[84:87]
    s_waitcnt vmcnt(1)
    v_exp_f32 v66, v66
    v_mfma_f32_16x16x32_bf16 v[88:91], a[128:131], a[80:83], v[16:19]
    s_barrier
    v_exp_f32 v67, v67
    v_mfma_f32_16x16x32_bf16 v[88:91], a[132:135], a[84:87], v[88:91]
    v_cvt_pk_bf16_f32 v32, v64, v65
    v_mfma_f32_16x16x32_bf16 v[88:91], a[136:139], a[88:91], v[88:91]
    v_mul_f32 v69, s20, v69
    v_mul_f32 v70, s20, v70
    v_mfma_f32_16x16x32_bf16 v[88:91], a[140:143], a[92:95], v[88:91]
    v_exp_f32 v68, v68
    v_mfma_f32_16x16x32_bf16 v[92:95], a[156:159], a[92:95], v[16:19]
    v_exp_f32 v69, v69
    v_mfma_f32_16x16x32_bf16 v[92:95], a[152:155], a[88:91], v[92:95]
    v_cvt_pk_bf16_f32 v33, v66, v67
    v_mfma_f32_16x16x32_bf16 v[92:95], a[148:151], a[84:87], v[92:95]
    v_mul_f32 v71, s20, v71
    v_mul_f32 v72, s20, v72
    v_mfma_f32_16x16x32_bf16 v[92:95], a[144:147], a[80:83], v[92:95]
    v_exp_f32 v70, v70
    v_mfma_f32_16x16x32_bf16 a[232:235], a[240:243], v[48:51], a[232:235]
    ds_read_b64_tr_b16 a[192:193], v3 offset:49152
    v_mfma_f32_16x16x32_bf16 a[232:235], a[240:243], v[52:55], a[232:235]
    v_exp_f32 v71, v71
    v_mfma_f32_16x16x32_bf16 v[192:195], a[164:167], v[52:55], v[192:195]
    ds_read_b64_tr_b16 a[194:195], v3 offset:53248
    ds_read_b64_tr_b16 a[196:197], v3 offset:57344
    v_mfma_f32_16x16x32_bf16 v[192:195], a[160:163], v[48:51], v[192:195]
    ds_read_b64_tr_b16 a[198:199], v3 offset:61440
    v_mfma_f32_16x16x32_bf16 v[196:199], a[168:171], v[48:51], v[196:199]
    ds_read_b64_tr_b16 a[200:201], v4 offset:49152
    v_cvt_pk_bf16_f32 v34, v68, v69
    v_mfma_f32_16x16x32_bf16 v[196:199], a[172:175], v[52:55], v[196:199]
    ds_read_b64_tr_b16 a[202:203], v4 offset:53248
    v_mul_f32 v73, s20, v73
    v_mfma_f32_16x16x32_bf16 v[200:203], a[180:183], v[52:55], v[200:203]
    ds_read_b64_tr_b16 a[204:205], v4 offset:57344
    v_mfma_f32_16x16x32_bf16 v[200:203], a[176:179], v[48:51], v[200:203]
    v_exp_f32 v72, v72
    v_mfma_f32_16x16x32_bf16 v[204:207], a[184:187], v[48:51], v[204:207]
    ds_read_b64_tr_b16 a[206:207], v4 offset:61440
    ds_read_b64_tr_b16 a[208:209], v3 offset:49408
    v_mfma_f32_16x16x32_bf16 v[204:207], a[188:191], v[52:55], v[204:207]
    ds_read_b64_tr_b16 a[210:211], v3 offset:53504
    v_mul_f32 v74, s20, v74
    v_mfma_f32_16x16x32_bf16 v[208:211], a[36:39], v[52:55], v[208:211]
    ds_read_b64_tr_b16 a[212:213], v3 offset:57600
    v_mfma_f32_16x16x32_bf16 v[208:211], a[32:35], v[48:51], v[208:211]
    v_exp_f32 v73, v73
    v_mfma_f32_16x16x32_bf16 v[212:215], a[40:43], v[48:51], v[212:215]
    ds_read_b64_tr_b16 a[214:215], v3 offset:61696
    ds_read_b64_tr_b16 a[216:217], v4 offset:49408
    v_mfma_f32_16x16x32_bf16 v[212:215], a[44:47], v[52:55], v[212:215]
    ds_read_b64_tr_b16 a[218:219], v4 offset:53504
    v_mfma_f32_16x16x32_bf16 v[216:219], a[52:55], v[52:55], v[216:219]
    ds_read_b64_tr_b16 a[220:221], v4 offset:57600
    v_cvt_pk_bf16_f32 v35, v70, v71
    v_mfma_f32_16x16x32_bf16 v[216:219], a[48:51], v[48:51], v[216:219]
    ds_read_b64_tr_b16 a[222:223], v4 offset:61696
    v_mul_f32 v75, s20, v75
    v_mfma_f32_16x16x32_bf16 v[220:223], a[56:59], v[48:51], v[220:223]
    v_mul_f32 v76, s20, v76
    v_mfma_f32_16x16x32_bf16 v[220:223], a[60:63], v[52:55], v[220:223]
    v_exp_f32 v74, v74
    v_mfma_f32_16x16x32_bf16 a[236:239], a[240:243], v[56:59], a[236:239]
    v_exp_f32 v75, v75
    v_mfma_f32_16x16x32_bf16 a[236:239], a[240:243], v[60:63], a[236:239]
    v_cvt_pk_bf16_f32 v36, v72, v73
    v_mfma_f32_16x16x32_bf16 v[224:227], a[164:167], v[60:63], v[224:227]
    v_mul_f32 v77, s20, v77
    v_mul_f32 v78, s20, v78
    v_mfma_f32_16x16x32_bf16 v[224:227], a[160:163], v[56:59], v[224:227]
    v_exp_f32 v76, v76
    v_mfma_f32_16x16x32_bf16 v[228:231], a[168:171], v[56:59], v[228:231]
    v_exp_f32 v77, v77
    v_mfma_f32_16x16x32_bf16 v[228:231], a[172:175], v[60:63], v[228:231]
    v_cvt_pk_bf16_f32 v37, v74, v75
    v_mfma_f32_16x16x32_bf16 v[232:235], a[180:183], v[60:63], v[232:235]
    v_mul_f32 v79, s20, v79
    v_mfma_f32_16x16x32_bf16 v[232:235], a[176:179], v[56:59], v[232:235]
    v_exp_f32 v78, v78
    v_mfma_f32_16x16x32_bf16 v[236:239], a[184:187], v[56:59], v[236:239]
    v_mfma_f32_16x16x32_bf16 v[236:239], a[188:191], v[60:63], v[236:239]
    ds_read_b64_tr_b16 a[160:161], v3 offset:49664
    ds_read_b64_tr_b16 a[162:163], v3 offset:53760
    v_mfma_f32_16x16x32_bf16 v[240:243], a[36:39], v[60:63], v[240:243]
    ds_read_b64_tr_b16 a[164:165], v3 offset:57856
    ds_read_b64_tr_b16 a[166:167], v3 offset:61952
    v_mfma_f32_16x16x32_bf16 v[240:243], a[32:35], v[56:59], v[240:243]
    ds_read_b64_tr_b16 a[168:169], v4 offset:49664
    ds_read_b64_tr_b16 a[170:171], v4 offset:53760
    v_mfma_f32_16x16x32_bf16 v[244:247], a[40:43], v[56:59], v[244:247]
    ds_read_b64_tr_b16 a[172:173], v4 offset:57856
    ds_read_b64_tr_b16 a[174:175], v4 offset:61952
    v_mfma_f32_16x16x32_bf16 v[244:247], a[44:47], v[60:63], v[244:247]
    ds_read_b64_tr_b16 a[176:177], v3 offset:49920
    ds_read_b64_tr_b16 a[178:179], v3 offset:54016
    v_mfma_f32_16x16x32_bf16 v[248:251], a[52:55], v[60:63], v[248:251]
    ds_read_b64_tr_b16 a[180:181], v3 offset:58112
    ds_read_b64_tr_b16 a[182:183], v3 offset:62208
    v_mfma_f32_16x16x32_bf16 v[248:251], a[48:51], v[56:59], v[248:251]
    ds_read_b64_tr_b16 a[184:185], v4 offset:49920
    ds_read_b64_tr_b16 a[186:187], v4 offset:54016
    v_mfma_f32_16x16x32_bf16 v[252:255], a[56:59], v[56:59], v[252:255]
    ds_read_b64_tr_b16 a[188:189], v4 offset:58112
    ds_read_b64_tr_b16 a[190:191], v4 offset:62208
    v_mfma_f32_16x16x32_bf16 v[252:255], a[60:63], v[60:63], v[252:255]
L_n31:
    v_mfma_f32_16x16x32_bf16 v[96:99], a[96:99], a[0:3], v[20:23]
    v_exp_f32 v79, v79
    v_mfma_f32_16x16x32_bf16 v[96:99], a[100:103], a[4:7], v[96:99]
    v_cvt_pk_bf16_f32 v38, v76, v77
    v_cvt_pk_bf16_f32 v39, v78, v79
    v_mfma_f32_16x16x32_bf16 v[96:99], a[104:107], a[8:11], v[96:99]
    v_mul_f32 v80, s20, v80
    v_mul_f32 v81, s20, v81
    v_mfma_f32_16x16x32_bf16 v[96:99], a[108:111], a[12:15], v[96:99]
    v_exp_f32 v80, v80
    v_mfma_f32_16x16x32_bf16 v[100:103], a[124:127], a[12:15], v[20:23]
    v_mul_f32 v82, s20, v82
    v_mul_f32 v83, s20, v83
    v_mfma_f32_16x16x32_bf16 v[100:103], a[120:123], a[8:11], v[100:103]
    v_exp_f32 v81, v81
    v_mfma_f32_16x16x32_bf16 v[100:103], a[116:119], a[4:7], v[100:103]
    v_mul_f32 v84, s20, v84
    v_mfma_f32_16x16x32_bf16 v[100:103], a[112:115], a[0:3], v[100:103]
    v_exp_f32 v82, v82
    v_mfma_f32_16x16x32_bf16 v[104:107], a[128:131], a[0:3], v[20:23]
    v_exp_f32 v83, v83
    v_mfma_f32_16x16x32_bf16 v[104:107], a[132:135], a[4:7], v[104:107]
    v_cvt_pk_bf16_f32 v40, v80, v81
    v_mul_f32 v85, s20, v85
    v_mfma_f32_16x16x32_bf16 v[104:107], a[136:139], a[8:11], v[104:107]
    v_mul_f32 v86, s20, v86
    v_mfma_f32_16x16x32_bf16 v[104:107], a[140:143], a[12:15], v[104:107]
    v_exp_f32 v84, v84
    v_mfma_f32_16x16x32_bf16 v[108:111], a[156:159], a[12:15], v[20:23]
    v_exp_f32 v85, v85
    v_mfma_f32_16x16x32_bf16 v[108:111], a[152:155], a[8:11], v[108:111]
    v_cvt_pk_bf16_f32 v41, v82, v83
    v_mfma_f32_16x16x32_bf16 v[108:111], a[148:151], a[4:7], v[108:111]
    v_mul_f32 v87, s20, v87
    v_mul_f32 v88, s20, v88
    v_mfma_f32_16x16x32_bf16 v[108:111], a[144:147], a[0:3], v[108:111]
    s_waitcnt lgkmcnt(0)
    v_exp_f32 v86, v86
    v_mfma_f32_16x16x32_bf16 a[224:227], a[240:243], v[32:35], a[224:227]
    s_add_u32 s23, s0, L_n34-L_pc
    v_exp_f32 v87, v87
    v_mfma_f32_16x16x32_bf16 a[224:227], a[240:243], v[36:39], a[224:227]
    buffer_load_dword a247, off, s[96:99], s23
    v_mfma_f32_16x16x32_bf16 v[128:131], a[196:199], v[36:39], v[128:131]
    v_cvt_pk_bf16_f32 v42, v84, v85
    v_mfma_f32_16x16x32_bf16 v[128:131], a[192:195], v[32:35], v[128:131]
    v_mul_f32 v89, s20, v89
    v_mul_f32 v90, s20, v90
    v_mfma_f32_16x16x32_bf16 v[132:135], a[200:203], v[32:35], v[132:135]
    v_mfma_f32_16x16x32_bf16 v[132:135], a[204:207], v[36:39], v[132:135]
    v_exp_f32 v88, v88
    v_mfma_f32_16x16x32_bf16 v[136:139], a[212:215], v[36:39], v[136:139]
    v_exp_f32 v89, v89
    v_mfma_f32_16x16x32_bf16 v[136:139], a[208:211], v[32:35], v[136:139]
    v_cvt_pk_bf16_f32 v43, v86, v87
    v_mul_f32 v91, s20, v91
    v_mfma_f32_16x16x32_bf16 v[140:143], a[216:219], v[32:35], v[140:143]
    v_exp_f32 v90, v90
    v_mfma_f32_16x16x32_bf16 v[140:143], a[220:223], v[36:39], v[140:143]
    v_mul_f32 v92, s20, v92
    v_cvt_pk_bf16_f32 v44, v88, v89
    v_mfma_f32_16x16x32_bf16 v[144:147], a[164:167], v[36:39], v[144:147]
    v_exp_f32 v91, v91
    v_mfma_f32_16x16x32_bf16 v[144:147], a[160:163], v[32:35], v[144:147]
    v_mul_f32 v93, s20, v93
    v_mfma_f32_16x16x32_bf16 v[148:151], a[168:171], v[32:35], v[148:151]
    v_exp_f32 v92, v92
    v_mfma_f32_16x16x32_bf16 v[148:151], a[172:175], v[36:39], v[148:151]
    v_mul_f32 v94, s20, v94
    v_cvt_pk_bf16_f32 v45, v90, v91
    v_mfma_f32_16x16x32_bf16 v[152:155], a[180:183], v[36:39], v[152:155]
    v_mul_f32 v95, s20, v95
    v_mfma_f32_16x16x32_bf16 v[152:155], a[176:179], v[32:35], v[152:155]
    v_exp_f32 v93, v93
    v_mfma_f32_16x16x32_bf16 v[156:159], a[184:187], v[32:35], v[156:159]
    v_exp_f32 v94, v94
    v_mfma_f32_16x16x32_bf16 v[156:159], a[188:191], v[36:39], v[156:159]
    v_accvgpr_read_b32 v30, a224
    v_cmp_ngt_f32 vcc, 0x53800000, v30
    v_rcp_f32 v30, v30
    s_mov_b64 s[30:31], vcc
    v_pk_mul_f32 v[128:129], v[128:129], v[30:31] op_sel_hi:[1,0]
    v_pk_mul_f32 v[130:131], v[130:131], v[30:31] op_sel_hi:[1,0]
    v_cvt_pk_bf16_f32 v128, v128, v129
    v_cvt_pk_bf16_f32 v129, v130, v131
    v_pk_mul_f32 v[132:133], v[132:133], v[30:31] op_sel_hi:[1,0]
    v_pk_mul_f32 v[134:135], v[134:135], v[30:31] op_sel_hi:[1,0]
    v_cvt_pk_bf16_f32 v130, v132, v133
    v_cvt_pk_bf16_f32 v131, v134, v135
    ds_write_b128 v6, v[128:131] offset:0
    v_pk_mul_f32 v[136:137], v[136:137], v[30:31] op_sel_hi:[1,0]
    v_pk_mul_f32 v[138:139], v[138:139], v[30:31] op_sel_hi:[1,0]
    v_cvt_pk_bf16_f32 v132, v136, v137
    v_cvt_pk_bf16_f32 v133, v138, v139
    v_pk_mul_f32 v[140:141], v[140:141], v[30:31] op_sel_hi:[1,0]
    v_pk_mul_f32 v[142:143], v[142:143], v[30:31] op_sel_hi:[1,0]
    v_cvt_pk_bf16_f32 v134, v140, v141
    v_cvt_pk_bf16_f32 v135, v142, v143
    ds_write_b128 v9, v[132:135] offset:0
    v_pk_mul_f32 v[144:145], v[144:145], v[30:31] op_sel_hi:[1,0]
    v_pk_mul_f32 v[146:147], v[146:147], v[30:31] op_sel_hi:[1,0]
    v_cvt_pk_bf16_f32 v136, v144, v145
    v_cvt_pk_bf16_f32 v137, v146, v147
    v_pk_mul_f32 v[148:149], v[148:149], v[30:31] op_sel_hi:[1,0]
    v_pk_mul_f32 v[150:151], v[150:151], v[30:31] op_sel_hi:[1,0]
    v_cvt_pk_bf16_f32 v138, v148, v149
    v_cvt_pk_bf16_f32 v139, v150, v151
    ds_write_b128 v6, v[136:139] offset:128
    v_pk_mul_f32 v[152:153], v[152:153], v[30:31] op_sel_hi:[1,0]
    v_pk_mul_f32 v[154:155], v[154:155], v[30:31] op_sel_hi:[1,0]
    v_cvt_pk_bf16_f32 v140, v152, v153
    v_cvt_pk_bf16_f32 v141, v154, v155
    v_pk_mul_f32 v[156:157], v[156:157], v[30:31] op_sel_hi:[1,0]
    v_pk_mul_f32 v[158:159], v[158:159], v[30:31] op_sel_hi:[1,0]
    v_cvt_pk_bf16_f32 v142, v156, v157
    v_cvt_pk_bf16_f32 v143, v158, v159
    ds_write_b128 v9, v[140:143] offset:128
    ds_read_b128 v[144:147], v7 offset:0
    ds_read_b128 v[148:151], v7 offset:1024
    ds_read_b128 v[152:155], v11 offset:2048
    ds_read_b128 v[156:159], v11 offset:3072
L_n32:
    v_mfma_f32_16x16x32_bf16 v[112:115], a[96:99], a[16:19], v[24:27]
    v_exp_f32 v95, v95
    v_mfma_f32_16x16x32_bf16 v[112:115], a[100:103], a[20:23], v[112:115]
    v_cvt_pk_bf16_f32 v46, v92, v93
    v_cvt_pk_bf16_f32 v47, v94, v95
    v_mfma_f32_16x16x32_bf16 v[112:115], a[104:107], a[24:27], v[112:115]
    v_mul_f32 v96, s20, v96
    v_mul_f32 v97, s20, v97
    v_mfma_f32_16x16x32_bf16 v[112:115], a[108:111], a[28:31], v[112:115]
    v_exp_f32 v96, v96
    v_mfma_f32_16x16x32_bf16 v[116:119], a[124:127], a[28:31], v[24:27]
    s_xor_b32 s27, s25, 0
    v_mul_f32 v98, s20, v98
    v_mul_f32 v99, s20, v99
    v_mfma_f32_16x16x32_bf16 v[116:119], a[120:123], a[24:27], v[116:119]
    v_exp_f32 v97, v97
    v_mfma_f32_16x16x32_bf16 v[116:119], a[116:119], a[20:23], v[116:119]
    s_waitcnt lgkmcnt(0)
    v_exp_f32 v98, v98
    v_mfma_f32_16x16x32_bf16 v[116:119], a[112:115], a[16:19], v[116:119]
    v_mul_f32 v100, s20, v100
    v_cvt_pk_bf16_f32 v48, v96, v97
    v_mfma_f32_16x16x32_bf16 v[120:123], a[128:131], a[16:19], v[24:27]
    v_exp_f32 v99, v99
    v_mfma_f32_16x16x32_bf16 v[120:123], a[132:135], a[20:23], v[120:123]
    buffer_store_dwordx4 v[144:147], v5, s[16:19], s27 offen offset:0 sc1 nt
    v_mfma_f32_16x16x32_bf16 v[120:123], a[136:139], a[24:27], v[120:123]
    buffer_store_dwordx4 v[148:151], v5, s[16:19], s27 offen offset:1024 sc1 nt
    v_mfma_f32_16x16x32_bf16 v[120:123], a[140:143], a[28:31], v[120:123]
    v_mul_f32 v101, s20, v101
    v_mul_f32 v102, s20, v102
    v_mfma_f32_16x16x32_bf16 v[124:127], a[156:159], a[28:31], v[24:27]
    v_exp_f32 v100, v100
    v_mfma_f32_16x16x32_bf16 v[124:127], a[152:155], a[24:27], v[124:127]
    buffer_store_dwordx4 v[152:155], v5, s[16:19], s27 offen offset:2048 sc1 nt
    v_mfma_f32_16x16x32_bf16 v[124:127], a[148:151], a[20:23], v[124:127]
    v_exp_f32 v101, v101
    v_mfma_f32_16x16x32_bf16 v[124:127], a[144:147], a[16:19], v[124:127]
    buffer_store_dwordx4 v[156:159], v5, s[16:19], s27 offen offset:3072 sc1 nt
    v_mfma_f32_16x16x32_bf16 a[228:231], a[240:243], v[40:43], a[228:231]
L_pad9:
    s_cbranch_execz L_back2
    v_cvt_pk_bf16_f32 v49, v98, v99
    v_mul_f32 v103, s20, v103
    v_mfma_f32_16x16x32_bf16 a[228:231], a[240:243], v[44:47], a[228:231]
    v_mul_f32 v104, s20, v104
    v_mfma_f32_16x16x32_bf16 v[160:163], a[196:199], v[44:47], v[160:163]
    v_exp_f32 v102, v102
    v_mfma_f32_16x16x32_bf16 v[160:163], a[192:195], v[40:43], v[160:163]
    v_exp_f32 v103, v103
    v_mfma_f32_16x16x32_bf16 v[164:167], a[200:203], v[40:43], v[164:167]
    v_cvt_pk_bf16_f32 v50, v100, v101
    v_mul_f32 v105, s20, v105
    v_mfma_f32_16x16x32_bf16 v[164:167], a[204:207], v[44:47], v[164:167]
    v_exp_f32 v104, v104
    v_mfma_f32_16x16x32_bf16 v[168:171], a[212:215], v[44:47], v[168:171]
    v_mul_f32 v106, s20, v106
    v_cvt_pk_bf16_f32 v51, v102, v103
    v_mfma_f32_16x16x32_bf16 v[168:171], a[208:211], v[40:43], v[168:171]
    v_exp_f32 v105, v105
    v_mfma_f32_16x16x32_bf16 v[172:175], a[216:219], v[40:43], v[172:175]
    v_mul_f32 v107, s20, v107
    v_mul_f32 v108, s20, v108
    v_mfma_f32_16x16x32_bf16 v[172:175], a[220:223], v[44:47], v[172:175]
    v_mfma_f32_16x16x32_bf16 v[176:179], a[164:167], v[44:47], v[176:179]
    v_exp_f32 v106, v106
    v_mfma_f32_16x16x32_bf16 v[176:179], a[160:163], v[40:43], v[176:179]
    v_exp_f32 v107, v107
    v_mfma_f32_16x16x32_bf16 v[180:183], a[168:171], v[40:43], v[180:183]
    v_cvt_pk_bf16_f32 v52, v104, v105
    v_mul_f32 v109, s20, v109
    v_mfma_f32_16x16x32_bf16 v[180:183], a[172:175], v[44:47], v[180:183]
    v_exp_f32 v108, v108
    v_mfma_f32_16x16x32_bf16 v[184:187], a[180:183], v[44:47], v[184:187]
    v_mul_f32 v110, s20, v110
    v_cvt_pk_bf16_f32 v53, v106, v107
    v_mfma_f32_16x16x32_bf16 v[184:187], a[176:179], v[40:43], v[184:187]
    v_exp_f32 v109, v109
    v_mfma_f32_16x16x32_bf16 v[188:191], a[184:187], v[40:43], v[188:191]
    v_mul_f32 v111, s20, v111
    v_mfma_f32_16x16x32_bf16 v[188:191], a[188:191], v[44:47], v[188:191]
    v_exp_f32 v110, v110
    v_accvgpr_read_b32 v31, a228
    v_cmp_ngt_f32 vcc, 0x53800000, v31
    v_rcp_f32 v31, v31
    s_or_b64 s[30:31], s[30:31], vcc
    v_pk_mul_f32 v[160:161], v[160:161], v[30:31] op_sel:[0,1] op_sel_hi:[1,1]
    v_pk_mul_f32 v[162:163], v[162:163], v[30:31] op_sel:[0,1] op_sel_hi:[1,1]
    v_cvt_pk_bf16_f32 v160, v160, v161
    v_cvt_pk_bf16_f32 v161, v162, v163
    v_pk_mul_f32 v[164:165], v[164:165], v[30:31] op_sel:[0,1] op_sel_hi:[1,1]
    v_pk_mul_f32 v[166:167], v[166:167], v[30:31] op_sel:[0,1] op_sel_hi:[1,1]
    v_cvt_pk_bf16_f32 v162, v164, v165
    v_cvt_pk_bf16_f32 v163, v166, v167
    ds_write_b128 v6, v[160:163] offset:4096
    v_pk_mul_f32 v[168:169], v[168:169], v[30:31] op_sel:[0,1] op_sel_hi:[1,1]
    v_pk_mul_f32 v[170:171], v[170:171], v[30:31] op_sel:[0,1] op_sel_hi:[1,1]
    v_cvt_pk_bf16_f32 v164, v168, v169
    v_cvt_pk_bf16_f32 v165, v170, v171
    v_pk_mul_f32 v[172:173], v[172:173], v[30:31] op_sel:[0,1] op_sel_hi:[1,1]
    v_pk_mul_f32 v[174:175], v[174:175], v[30:31] op_sel:[0,1] op_sel_hi:[1,1]
    v_cvt_pk_bf16_f32 v166, v172, v173
    v_cvt_pk_bf16_f32 v167, v174, v175
    ds_write_b128 v9, v[164:167] offset:4096
    v_pk_mul_f32 v[176:177], v[176:177], v[30:31] op_sel:[0,1] op_sel_hi:[1,1]
    v_pk_mul_f32 v[178:179], v[178:179], v[30:31] op_sel:[0,1] op_sel_hi:[1,1]
    v_cvt_pk_bf16_f32 v168, v176, v177
    v_cvt_pk_bf16_f32 v169, v178, v179
    v_pk_mul_f32 v[180:181], v[180:181], v[30:31] op_sel:[0,1] op_sel_hi:[1,1]
    v_pk_mul_f32 v[182:183], v[182:183], v[30:31] op_sel:[0,1] op_sel_hi:[1,1]
    v_cvt_pk_bf16_f32 v170, v180, v181
    v_cvt_pk_bf16_f32 v171, v182, v183
    ds_write_b128 v6, v[168:171] offset:4224
    v_pk_mul_f32 v[184:185], v[184:185], v[30:31] op_sel:[0,1] op_sel_hi:[1,1]
    v_pk_mul_f32 v[186:187], v[186:187], v[30:31] op_sel:[0,1] op_sel_hi:[1,1]
    v_cvt_pk_bf16_f32 v172, v184, v185
    v_cvt_pk_bf16_f32 v173, v186, v187
    v_pk_mul_f32 v[188:189], v[188:189], v[30:31] op_sel:[0,1] op_sel_hi:[1,1]
    v_pk_mul_f32 v[190:191], v[190:191], v[30:31] op_sel:[0,1] op_sel_hi:[1,1]
    v_cvt_pk_bf16_f32 v174, v188, v189
    v_cvt_pk_bf16_f32 v175, v190, v191
    ds_write_b128 v9, v[172:175] offset:4224
    ds_read_b128 v[176:179], v7 offset:4096
    ds_read_b128 v[180:183], v7 offset:5120
    ds_read_b128 v[184:187], v11 offset:6144
    ds_read_b128 v[188:191], v11 offset:7168
L_n33:
    v_exp_f32 v111, v111
    v_cvt_pk_bf16_f32 v54, v108, v109
    v_cvt_pk_bf16_f32 v55, v110, v111
    v_mfma_f32_16x16x32_bf16 a[232:235], a[240:243], v[48:51], a[232:235]
    v_mul_f32 v112, s20, v112
    v_mul_f32 v113, s20, v113
    v_mul_f32 v114, s20, v114
    v_mfma_f32_16x16x32_bf16 a[232:235], a[240:243], v[52:55], a[232:235]
    v_exp_f32 v112, v112
    v_mul_f32 v115, s20, v115
    v_mfma_f32_16x16x32_bf16 v[192:195], a[196:199], v[52:55], v[192:195]
    s_xor_b32 s27, s25, 4096
    v_exp_f32 v113, v113
    v_exp_f32 v114, v114
    v_mfma_f32_16x16x32_bf16 v[192:195], a[192:195], v[48:51], v[192:195]
    s_waitcnt lgkmcnt(0)
    v_mul_f32 v116, s20, v116
    v_exp_f32 v115, v115
    v_mfma_f32_16x16x32_bf16 v[196:199], a[200:203], v[48:51], v[196:199]
    buffer_store_dwordx4 v[176:179], v5, s[16:19], s27 offen offset:0 sc1 nt
    v_cvt_pk_bf16_f32 v56, v112, v113
    v_mfma_f32_16x16x32_bf16 v[196:199], a[204:207], v[52:55], v[196:199]
    buffer_store_dwordx4 v[180:183], v5, s[16:19], s27 offen offset:1024 sc1 nt
    v_mul_f32 v117, s20, v117
    v_mul_f32 v118, s20, v118
    v_mfma_f32_16x16x32_bf16 v[200:203], a[212:215], v[52:55], v[200:203]
    v_exp_f32 v116, v116
    v_cvt_pk_bf16_f32 v57, v114, v115
    v_mfma_f32_16x16x32_bf16 v[200:203], a[208:211], v[48:51], v[200:203]
    v_exp_f32 v117, v117
    v_mul_f32 v119, s20, v119
    v_mfma_f32_16x16x32_bf16 v[204:207], a[216:219], v[48:51], v[204:207]
    buffer_store_dwordx4 v[184:187], v5, s[16:19], s27 offen offset:2048 sc1 nt
    v_exp_f32 v118, v118
    v_mfma_f32_16x16x32_bf16 v[204:207], a[220:223], v[52:55], v[204:207]
    buffer_store_dwordx4 v[188:191], v5, s[16:19], s27 offen offset:3072 sc1 nt
    v_mul_f32 v120, s20, v120
    v_mfma_f32_16x16x32_bf16 v[208:211], a[164:167], v[52:55], v[208:211]
    v_exp_f32 v119, v119
    v_cvt_pk_bf16_f32 v58, v116, v117
    v_mfma_f32_16x16x32_bf16 v[208:211], a[160:163], v[48:51], v[208:211]
    v_mul_f32 v121, s20, v121
    v_exp_f32 v120, v120
    v_mul_f32 v122, s20, v122
    v_mfma_f32_16x16x32_bf16 v[212:215], a[168:171], v[48:51], v[212:215]
    v_exp_f32 v121, v121
    v_cvt_pk_bf16_f32 v59, v118, v119
    v_mfma_f32_16x16x32_bf16 v[212:215], a[172:175], v[52:55], v[212:215]
    v_mul_f32 v123, s20, v123
    v_exp_f32 v122, v122
    v_mfma_f32_16x16x32_bf16 v[216:219], a[180:183], v[52:55], v[216:219]
    v_mul_f32 v124, s20, v124
    v_exp_f32 v123, v123
    v_cvt_pk_bf16_f32 v60, v120, v121
    v_mfma_f32_16x16x32_bf16 v[216:219], a[176:179], v[48:51], v[216:219]
    v_mul_f32 v125, s20, v125
    v_exp_f32 v124, v124
    v_mfma_f32_16x16x32_bf16 v[220:223], a[184:187], v[48:51], v[220:223]
    v_mul_f32 v126, s20, v126
    v_exp_f32 v125, v125
    v_mfma_f32_16x16x32_bf16 v[220:223], a[188:191], v[52:55], v[220:223]
    v_cvt_pk_bf16_f32 v61, v122, v123
    v_mul_f32 v127, s20, v127
    v_exp_f32 v126, v126
    v_accvgpr_read_b32 v30, a232
    v_cmp_ngt_f32 vcc, 0x53800000, v30
    v_rcp_f32 v30, v30
    s_or_b64 s[30:31], s[30:31], vcc
    v_pk_mul_f32 v[192:193], v[192:193], v[30:31] op_sel_hi:[1,0]
    v_pk_mul_f32 v[194:195], v[194:195], v[30:31] op_sel_hi:[1,0]
    v_cvt_pk_bf16_f32 v192, v192, v193
    v_cvt_pk_bf16_f32 v193, v194, v195
    v_pk_mul_f32 v[196:197], v[196:197], v[30:31] op_sel_hi:[1,0]
    v_pk_mul_f32 v[198:199], v[198:199], v[30:31] op_sel_hi:[1,0]
    v_cvt_pk_bf16_f32 v194, v196, v197
    v_cvt_pk_bf16_f32 v195, v198, v199
    ds_write_b128 v6, v[192:195] offset:0
    v_pk_mul_f32 v[200:201], v[200:201], v[30:31] op_sel_hi:[1,0]
    v_pk_mul_f32 v[202:203], v[202:203], v[30:31] op_sel_hi:[1,0]
    v_cvt_pk_bf16_f32 v196, v200, v201
    v_cvt_pk_bf16_f32 v197, v202, v203
    v_pk_mul_f32 v[204:205], v[204:205], v[30:31] op_sel_hi:[1,0]
    v_pk_mul_f32 v[206:207], v[206:207], v[30:31] op_sel_hi:[1,0]
    v_cvt_pk_bf16_f32 v198, v204, v205
    v_cvt_pk_bf16_f32 v199, v206, v207
    ds_write_b128 v9, v[196:199] offset:0
    v_pk_mul_f32 v[208:209], v[208:209], v[30:31] op_sel_hi:[1,0]
    v_pk_mul_f32 v[210:211], v[210:211], v[30:31] op_sel_hi:[1,0]
    v_cvt_pk_bf16_f32 v200, v208, v209
    v_cvt_pk_bf16_f32 v201, v210, v211
    v_pk_mul_f32 v[212:213], v[212:213], v[30:31] op_sel_hi:[1,0]
    v_pk_mul_f32 v[214:215], v[214:215], v[30:31] op_sel_hi:[1,0]
    v_cvt_pk_bf16_f32 v202, v212, v213
    v_cvt_pk_bf16_f32 v203, v214, v215
    ds_write_b128 v6, v[200:203] offset:128
    v_pk_mul_f32 v[216:217], v[216:217], v[30:31] op_sel_hi:[1,0]
    v_pk_mul_f32 v[218:219], v[218:219], v[30:31] op_sel_hi:[1,0]
    v_cvt_pk_bf16_f32 v204, v216, v217
    v_cvt_pk_bf16_f32 v205, v218, v219
    v_pk_mul_f32 v[220:221], v[220:221], v[30:31] op_sel_hi:[1,0]
    v_pk_mul_f32 v[222:223], v[222:223], v[30:31] op_sel_hi:[1,0]
    v_cvt_pk_bf16_f32 v206, v220, v221
    v_cvt_pk_bf16_f32 v207, v222, v223
    ds_write_b128 v9, v[204:207] offset:128
    ds_read_b128 v[208:211], v7 offset:0
    ds_read_b128 v[212:215], v7 offset:1024
    ds_read_b128 v[216:219], v11 offset:2048
    ds_read_b128 v[220:223], v11 offset:3072
L_n34:
    v_exp_f32 v127, v127
    v_cvt_pk_bf16_f32 v62, v124, v125
    v_cvt_pk_bf16_f32 v63, v126, v127
    v_mfma_f32_16x16x32_bf16 a[236:239], a[240:243], v[56:59], a[236:239]
    s_nop 0
    v_mfma_f32_16x16x32_bf16 a[236:239], a[240:243], v[60:63], a[236:239]
    v_mfma_f32_16x16x32_bf16 v[224:227], a[196:199], v[60:63], v[224:227]
    s_xor_b32 s27, s25, 8192
    v_mfma_f32_16x16x32_bf16 v[224:227], a[192:195], v[56:59], v[224:227]
    s_waitcnt lgkmcnt(0)
    v_mfma_f32_16x16x32_bf16 v[228:231], a[200:203], v[56:59], v[228:231]
    buffer_store_dwordx4 v[208:211], v5, s[16:19], s27 offen offset:0 sc1 nt
    v_mfma_f32_16x16x32_bf16 v[228:231], a[204:207], v[60:63], v[228:231]
    buffer_store_dwordx4 v[212:215], v5, s[16:19], s27 offen offset:1024 sc1 nt
    v_mfma_f32_16x16x32_bf16 v[232:235], a[212:215], v[60:63], v[232:235]
    buffer_store_dwordx4 v[216:219], v5, s[16:19], s27 offen offset:2048 sc1 nt
    v_mfma_f32_16x16x32_bf16 v[232:235], a[208:211], v[56:59], v[232:235]
    buffer_store_dwordx4 v[220:223], v5, s[16:19], s27 offen offset:3072 sc1 nt
    v_mfma_f32_16x16x32_bf16 v[236:239], a[216:219], v[56:59], v[236:239]
    v_mfma_f32_16x16x32_bf16 v[236:239], a[220:223], v[60:63], v[236:239]
    v_mfma_f32_16x16x32_bf16 v[240:243], a[164:167], v[60:63], v[240:243]
    v_mfma_f32_16x16x32_bf16 v[240:243], a[160:163], v[56:59], v[240:243]
    v_mfma_f32_16x16x32_bf16 v[244:247], a[168:171], v[56:59], v[244:247]
    v_mfma_f32_16x16x32_bf16 v[244:247], a[172:175], v[60:63], v[244:247]
    v_mfma_f32_16x16x32_bf16 v[248:251], a[180:183], v[60:63], v[248:251]
    v_mfma_f32_16x16x32_bf16 v[248:251], a[176:179], v[56:59], v[248:251]
    v_mfma_f32_16x16x32_bf16 v[252:255], a[184:187], v[56:59], v[252:255]
    v_mfma_f32_16x16x32_bf16 v[252:255], a[188:191], v[60:63], v[252:255]
    v_accvgpr_read_b32 v31, a236
    v_cmp_ngt_f32 vcc, 0x53800000, v31
    v_rcp_f32 v31, v31
    s_or_b64 s[30:31], s[30:31], vcc
    v_pk_mul_f32 v[224:225], v[224:225], v[30:31] op_sel:[0,1] op_sel_hi:[1,1]
    v_pk_mul_f32 v[226:227], v[226:227], v[30:31] op_sel:[0,1] op_sel_hi:[1,1]
    v_cvt_pk_bf16_f32 v224, v224, v225
    v_cvt_pk_bf16_f32 v225, v226, v227
    v_pk_mul_f32 v[228:229], v[228:229], v[30:31] op_sel:[0,1] op_sel_hi:[1,1]
    v_pk_mul_f32 v[230:231], v[230:231], v[30:31] op_sel:[0,1] op_sel_hi:[1,1]
    v_cvt_pk_bf16_f32 v226, v228, v229
    v_cvt_pk_bf16_f32 v227, v230, v231
    ds_write_b128 v6, v[224:227] offset:4096
    v_pk_mul_f32 v[232:233], v[232:233], v[30:31] op_sel:[0,1] op_sel_hi:[1,1]
    v_pk_mul_f32 v[234:235], v[234:235], v[30:31] op_sel:[0,1] op_sel_hi:[1,1]
    v_cvt_pk_bf16_f32 v228, v232, v233
    v_cvt_pk_bf16_f32 v229, v234, v235
    v_pk_mul_f32 v[236:237], v[236:237], v[30:31] op_sel:[0,1] op_sel_hi:[1,1]
    v_pk_mul_f32 v[238:239], v[238:239], v[30:31] op_sel:[0,1] op_sel_hi:[1,1]
    v_cvt_pk_bf16_f32 v230, v236, v237
    v_cvt_pk_bf16_f32 v231, v238, v239
    ds_write_b128 v9, v[228:231] offset:4096
    v_pk_mul_f32 v[240:241], v[240:241], v[30:31] op_sel:[0,1] op_sel_hi:[1,1]
    v_pk_mul_f32 v[242:243], v[242:243], v[30:31] op_sel:[0,1] op_sel_hi:[1,1]
    v_cvt_pk_bf16_f32 v232, v240, v241
    v_cvt_pk_bf16_f32 v233, v242, v243
    v_pk_mul_f32 v[244:245], v[244:245], v[30:31] op_sel:[0,1] op_sel_hi:[1,1]
    v_pk_mul_f32 v[246:247], v[246:247], v[30:31] op_sel:[0,1] op_sel_hi:[1,1]
    v_cvt_pk_bf16_f32 v234, v244, v245
    v_cvt_pk_bf16_f32 v235, v246, v247
    ds_write_b128 v6, v[232:235] offset:4224
    v_pk_mul_f32 v[248:249], v[248:249], v[30:31] op_sel:[0,1] op_sel_hi:[1,1]
    v_pk_mul_f32 v[250:251], v[250:251], v[30:31] op_sel:[0,1] op_sel_hi:[1,1]
    v_cvt_pk_bf16_f32 v236, v248, v249
    v_cvt_pk_bf16_f32 v237, v250, v251
    v_pk_mul_f32 v[252:253], v[252:253], v[30:31] op_sel:[0,1] op_sel_hi:[1,1]
    v_pk_mul_f32 v[254:255], v[254:255], v[30:31] op_sel:[0,1] op_sel_hi:[1,1]
    v_cvt_pk_bf16_f32 v238, v252, v253
    v_cvt_pk_bf16_f32 v239, v254, v255
    ds_write_b128 v9, v[236:239] offset:4224
    ds_read_b128 v[240:243], v7 offset:4096
    ds_read_b128 v[244:247], v7 offset:5120
    ds_read_b128 v[248:251], v11 offset:6144
    ds_read_b128 v[252:255], v11 offset:7168
    s_xor_b32 s27, s25, 12288
    s_waitcnt lgkmcnt(0)
    buffer_store_dwordx4 v[240:243], v5, s[16:19], s27 offen offset:0 sc1 nt
    buffer_store_dwordx4 v[244:247], v5, s[16:19], s27 offen offset:1024 sc1 nt
    buffer_store_dwordx4 v[248:251], v5, s[16:19], s27 offen offset:2048 sc1 nt
    buffer_store_dwordx4 v[252:255], v5, s[16:19], s27 offen offset:3072 sc1 nt
    s_or_b64 s[40:41], s[28:29], s[30:31]
    s_cbranch_scc1 L_redo
    s_endpgm
L_redo:
    s_waitcnt vmcnt(0)
L_slow_next:
    s_cmp_lg_u64 s[28:29], 0
    s_cbranch_scc0 L_slow_b
    s_mov_b64 s[28:29], 0
    s_mov_b32 s36, s24
    s_mov_b32 s38, s3
    s_branch L_slow
L_slow_b:
    s_cmp_lg_u64 s[30:31], 0
    s_cbranch_scc0 L_end
    s_mov_b64 s[30:31], 0
    s_mov_b32 s36, s25
    s_add_u32 s38, s3, 131072
L_slow:
    v_mbcnt_lo_u32_b32 v0, -1, 0
    v_mbcnt_hi_u32_b32 v0, -1, v0
    v_and_b32 v16, 15, v0
    v_lshrrev_b32 v17, 4, v0
    v_lshlrev_b32 v2, 8, v16
    v_lshl_add_u32 v2, v17, 4, v2
    v_lshlrev_b32 v3, 10, v17
    v_lshl_add_u32 v3, v16, 1, v3
    s_xor_b32 s40, s36, 0
    buffer_load_dwordx4 a[0:3], v2, s[4:7], s40 offen offset:0
    buffer_load_dwordx4 a[4:7], v2, s[4:7], s40 offen offset:64
    buffer_load_dwordx4 a[8:11], v2, s[4:7], s40 offen offset:128
    buffer_load_dwordx4 a[12:15], v2, s[4:7], s40 offen offset:192
    s_xor_b32 s40, s36, 4096
    buffer_load_dwordx4 a[16:19], v2, s[4:7], s40 offen offset:0
    buffer_load_dwordx4 a[20:23], v2, s[4:7], s40 offen offset:64
    buffer_load_dwordx4 a[24:27], v2, s[4:7], s40 offen offset:128
    buffer_load_dwordx4 a[28:31], v2, s[4:7], s40 offen offset:192
    s_xor_b32 s40, s36, 8192
    buffer_load_dwordx4 a[32:35], v2, s[4:7], s40 offen offset:0
    buffer_load_dwordx4 a[36:39], v2, s[4:7], s40 offen offset:64
    buffer_load_dwordx4 a[40:43], v2, s[4:7], s40 offen offset:128
    buffer_load_dwordx4 a[44:47], v2, s[4:7], s40 offen offset:192
    s_xor_b32 s40, s36, 12288
    buffer_load_dwordx4 a[48:51], v2, s[4:7], s40 offen offset:0
    buffer_load_dwordx4 a[52:55], v2, s[4:7], s40 offen offset:64
    buffer_load_dwordx4 a[56:59], v2, s[4:7], s40 offen offset:128
    buffer_load_dwordx4 a[60:63], v2, s[4:7], s40 offen offset:192
    v_mov_b32 v128, 0
    v_mov_b32 v129, 0
    v_mov_b32 v130, 0
    v_mov_b32 v131, 0
    v_mov_b32 v132, 0
    v_mov_b32 v133, 0
    v_mov_b32 v134, 0
    v_mov_b32 v135, 0
    v_mov_b32 v136, 0
    v_mov_b32 v137, 0
    v_mov_b32 v138, 0
    v_mov_b32 v139, 0
    v_mov_b32 v140, 0
    v_mov_b32 v141, 0
    v_mov_b32 v142, 0
    v_mov_b32 v143, 0
    v_mov_b32 v144, 0
    v_mov_b32 v145, 0
    v_mov_b32 v146, 0
    v_mov_b32 v147, 0
    v_mov_b32 v148, 0
    v_mov_b32 v149, 0
    v_mov_b32 v150, 0
    v_mov_b32 v151, 0
    v_mov_b32 v152, 0
    v_mov_b32 v153, 0
    v_mov_b32 v154, 0
    v_mov_b32 v155, 0
    v_mov_b32 v156, 0
    v_mov_b32 v157, 0
    v_mov_b32 v158, 0
    v_mov_b32 v159, 0
    v_mov_b32 v160, 0
    v_mov_b32 v161, 0
    v_mov_b32 v162, 0
    v_mov_b32 v163, 0
    v_mov_b32 v164, 0
    v_mov_b32 v165, 0
    v_mov_b32 v166, 0
    v_mov_b32 v167, 0
    v_mov_b32 v168, 0
    v_mov_b32 v169, 0
    v_mov_b32 v170, 0
    v_mov_b32 v171, 0
    v_mov_b32 v172, 0
    v_mov_b32 v173, 0
    v_mov_b32 v174, 0
    v_mov_b32 v175, 0
    v_mov_b32 v176, 0
    v_mov_b32 v177, 0
    v_mov_b32 v178, 0
    v_mov_b32 v179, 0
    v_mov_b32 v180, 0
    v_mov_b32 v181, 0
    v_mov_b32 v182, 0
    v_mov_b32 v183, 0
    v_mov_b32 v184, 0
    v_mov_b32 v185, 0
    v_mov_b32 v186, 0
    v_mov_b32 v187, 0
    v_mov_b32 v188, 0
    v_mov_b32 v189, 0
    v_mov_b32 v190, 0
    v_mov_b32 v191, 0
    v_mov_b32 v192, 0
    v_mov_b32 v193, 0
    v_mov_b32 v194, 0
    v_mov_b32 v195, 0
    v_mov_b32 v196, 0
    v_mov_b32 v197, 0
    v_mov_b32 v198, 0
    v_mov_b32 v199, 0
    v_mov_b32 v200, 0
    v_mov_b32 v201, 0
    v_mov_b32 v202, 0
    v_mov_b32 v203, 0
    v_mov_b32 v204, 0
    v_mov_b32 v205, 0
    v_mov_b32 v206, 0
    v_mov_b32 v207, 0
    v_mov_b32 v208, 0
    v_mov_b32 v209, 0
    v_mov_b32 v210, 0
    v_mov_b32 v211, 0
    v_mov_b32 v212, 0
    v_mov_b32 v213, 0
    v_mov_b32 v214, 0
    v_mov_b32 v215, 0
    v_mov_b32 v216, 0
    v_mov_b32 v217, 0
    v_mov_b32 v218, 0
    v_mov_b32 v219, 0
    v_mov_b32 v220, 0
    v_mov_b32 v221, 0
    v_mov_b32 v222, 0
    v_mov_b32 v223, 0
    v_mov_b32 v224, 0
    v_mov_b32 v225, 0
    v_mov_b32 v226, 0
    v_mov_b32 v227, 0
    v_mov_b32 v228, 0
    v_mov_b32 v229, 0
    v_mov_b32 v230, 0
    v_mov_b32 v231, 0
    v_mov_b32 v232, 0
    v_mov_b32 v233, 0
    v_mov_b32 v234, 0
    v_mov_b32 v235, 0
    v_mov_b32 v236, 0
    v_mov_b32 v237, 0
    v_mov_b32 v238, 0
    v_mov_b32 v239, 0
    v_mov_b32 v240, 0
    v_mov_b32 v241, 0
    v_mov_b32 v242, 0
    v_mov_b32 v243, 0
    v_mov_b32 v244, 0
    v_mov_b32 v245, 0
    v_mov_b32 v246, 0
    v_mov_b32 v247, 0
    v_mov_b32 v248, 0
    v_mov_b32 v249, 0
    v_mov_b32 v250, 0
    v_mov_b32 v251, 0
    v_mov_b32 v252, 0
    v_mov_b32 v253, 0
    v_mov_b32 v254, 0
    v_mov_b32 v255, 0
    v_mov_b32 v4, 0xff800000
    v_mov_b32 v8, 0
    v_mov_b32 v5, 0xff800000
    v_mov_b32 v9, 0
    v_mov_b32 v6, 0xff800000
    v_mov_b32 v10, 0
    v_mov_b32 v7, 0xff800000
    v_mov_b32 v11, 0
    s_mov_b32 s39, 0
L_slow_tile:
    s_add_u32 s40, s38, 4096
    buffer_load_dwordx4 a[96:99], v2, s[8:11], s38 offen offset:0
    buffer_load_dwordx4 a[100:103], v2, s[8:11], s38 offen offset:64
    buffer_load_dwordx4 a[104:107], v2, s[8:11], s38 offen offset:128
    buffer_load_dwordx4 a[108:111], v2, s[8:11], s38 offen offset:192
    buffer_load_dwordx4 a[112:115], v2, s[8:11], s40 offen offset:0
    buffer_load_dwordx4 a[116:119], v2, s[8:11], s40 offen offset:64
    buffer_load_dwordx4 a[120:123], v2, s[8:11], s40 offen offset:128
    buffer_load_dwordx4 a[124:127], v2, s[8:11], s40 offen offset:192
    buffer_load_ushort v36, v3, s[12:15], s38 offen offset:0
    buffer_load_ushort v37, v3, s[12:15], s38 offen offset:256
    buffer_load_ushort v38, v3, s[12:15], s38 offen offset:512
    buffer_load_ushort v39, v3, s[12:15], s38 offen offset:768
    buffer_load_ushort v44, v3, s[12:15], s40 offen offset:0
    buffer_load_ushort v45, v3, s[12:15], s40 offen offset:256
    buffer_load_ushort v46, v3, s[12:15], s40 offen offset:512
    buffer_load_ushort v47, v3, s[12:15], s40 offen offset:768
    buffer_load_ushort v52, v3, s[12:15], s38 offen offset:32
    buffer_load_ushort v53, v3, s[12:15], s38 offen offset:288
    buffer_load_ushort v54, v3, s[12:15], s38 offen offset:544
    buffer_load_ushort v55, v3, s[12:15], s38 offen offset:800
    buffer_load_ushort v60, v3, s[12:15], s40 offen offset:32
    buffer_load_ushort v61, v3, s[12:15], s40 offen offset:288
    buffer_load_ushort v62, v3, s[12:15], s40 offen offset:544
    buffer_load_ushort v63, v3, s[12:15], s40 offen offset:800
    s_waitcnt vmcnt(0)
    v_lshl_or_b32 v72, v37, 16, v36
    v_lshl_or_b32 v73, v39, 16, v38
    v_lshl_or_b32 v74, v45, 16, v44
    v_lshl_or_b32 v75, v47, 16, v46
    v_lshl_or_b32 v76, v53, 16, v52
    v_lshl_or_b32 v77, v55, 16, v54
    v_lshl_or_b32 v78, v61, 16, v60
    v_lshl_or_b32 v79, v63, 16, v62
    buffer_load_ushort v36, v3, s[12:15], s38 offen offset:64
    buffer_load_ushort v37, v3, s[12:15], s38 offen offset:320
    buffer_load_ushort v38, v3, s[12:15], s38 offen offset:576
    buffer_load_ushort v39, v3, s[12:15], s38 offen offset:832
    buffer_load_ushort v44, v3, s[12:15], s40 offen offset:64
    buffer_load_ushort v45, v3, s[12:15], s40 offen offset:320
    buffer_load_ushort v46, v3, s[12:15], s40 offen offset:576
    buffer_load_ushort v47, v3, s[12:15], s40 offen offset:832
    buffer_load_ushort v52, v3, s[12:15], s38 offen offset:96
    buffer_load_ushort v53, v3, s[12:15], s38 offen offset:352
    buffer_load_ushort v54, v3, s[12:15], s38 offen offset:608
    buffer_load_ushort v55, v3, s[12:15], s38 offen offset:864
    buffer_load_ushort v60, v3, s[12:15], s40 offen offset:96
    buffer_load_ushort v61, v3, s[12:15], s40 offen offset:352
    buffer_load_ushort v62, v3, s[12:15], s40 offen offset:608
    buffer_load_ushort v63, v3, s[12:15], s40 offen offset:864
    s_waitcnt vmcnt(0)
    v_lshl_or_b32 v88, v37, 16, v36
    v_lshl_or_b32 v89, v39, 16, v38
    v_lshl_or_b32 v90, v45, 16, v44
    v_lshl_or_b32 v91, v47, 16, v46
    v_lshl_or_b32 v92, v53, 16, v52
    v_lshl_or_b32 v93, v55, 16, v54
    v_lshl_or_b32 v94, v61, 16, v60
    v_lshl_or_b32 v95, v63, 16, v62
    buffer_load_ushort v36, v3, s[12:15], s38 offen offset:128
    buffer_load_ushort v37, v3, s[12:15], s38 offen offset:384
    buffer_load_ushort v38, v3, s[12:15], s38 offen offset:640
    buffer_load_ushort v39, v3, s[12:15], s38 offen offset:896
    buffer_load_ushort v44, v3, s[12:15], s40 offen offset:128
    buffer_load_ushort v45, v3, s[12:15], s40 offen offset:384
    buffer_load_ushort v46, v3, s[12:15], s40 offen offset:640
    buffer_load_ushort v47, v3, s[12:15], s40 offen offset:896
    buffer_load_ushort v52, v3, s[12:15], s38 offen offset:160
    buffer_load_ushort v53, v3, s[12:15], s38 offen offset:416
    buffer_load_ushort v54, v3, s[12:15], s38 offen offset:672
    buffer_load_ushort v55, v3, s[12:15], s38 offen offset:928
    buffer_load_ushort v60, v3, s[12:15], s40 offen offset:160
    buffer_load_ushort v61, v3, s[12:15], s40 offen offset:416
    buffer_load_ushort v62, v3, s[12:15], s40 offen offset:672
    buffer_load_ushort v63, v3, s[12:15], s40 offen offset:928
    s_waitcnt vmcnt(0)
    v_lshl_or_b32 v104, v37, 16, v36
    v_lshl_or_b32 v105, v39, 16, v38
    v_lshl_or_b32 v106, v45, 16, v44
    v_lshl_or_b32 v107, v47, 16, v46
    v_lshl_or_b32 v108, v53, 16, v52
    v_lshl_or_b32 v109, v55, 16, v54
    v_lshl_or_b32 v110, v61, 16, v60
    v_lshl_or_b32 v111, v63, 16, v62
    buffer_load_ushort v36, v3, s[12:15], s38 offen offset:192
    buffer_load_ushort v37, v3, s[12:15], s38 offen offset:448
    buffer_load_ushort v38, v3, s[12:15], s38 offen offset:704
    buffer_load_ushort v39, v3, s[12:15], s38 offen offset:960
    buffer_load_ushort v44, v3, s[12:15], s40 offen offset:192
    buffer_load_ushort v45, v3, s[12:15], s40 offen offset:448
    buffer_load_ushort v46, v3, s[12:15], s40 offen offset:704
    buffer_load_ushort v47, v3, s[12:15], s40 offen offset:960
    buffer_load_ushort v52, v3, s[12:15], s38 offen offset:224
    buffer_load_ushort v53, v3, s[12:15], s38 offen offset:480
    buffer_load_ushort v54, v3, s[12:15], s38 offen offset:736
    buffer_load_ushort v55, v3, s[12:15], s38 offen offset:992
    buffer_load_ushort v60, v3, s[12:15], s40 offen offset:224
    buffer_load_ushort v61, v3, s[12:15], s40 offen offset:480
    buffer_load_ushort v62, v3, s[12:15], s40 offen offset:736
    buffer_load_ushort v63, v3, s[12:15], s40 offen offset:992
    s_waitcnt vmcnt(0)
    v_lshl_or_b32 v120, v37, 16, v36
    v_lshl_or_b32 v121, v39, 16, v38
    v_lshl_or_b32 v122, v45, 16, v44
    v_lshl_or_b32 v123, v47, 16, v46
    v_lshl_or_b32 v124, v53, 16, v52
    v_lshl_or_b32 v125, v55, 16, v54
    v_lshl_or_b32 v126, v61, 16, v60
    v_lshl_or_b32 v127, v63, 16, v62
    v_mfma_f32_16x16x32_bf16 v[64:67], a[96:99], a[0:3], 0
    v_mfma_f32_16x16x32_bf16 v[64:67], a[100:103], a[4:7], v[64:67]
    v_mfma_f32_16x16x32_bf16 v[64:67], a[104:107], a[8:11], v[64:67]
    v_mfma_f32_16x16x32_bf16 v[64:67], a[108:111], a[12:15], v[64:67]
    v_mfma_f32_16x16x32_bf16 v[68:71], a[124:127], a[12:15], 0
    v_mfma_f32_16x16x32_bf16 v[68:71], a[120:123], a[8:11], v[68:71]
    v_mfma_f32_16x16x32_bf16 v[68:71], a[116:119], a[4:7], v[68:71]
    v_mfma_f32_16x16x32_bf16 v[68:71], a[112:115], a[0:3], v[68:71]
    v_mfma_f32_16x16x32_bf16 v[80:83], a[96:99], a[16:19], 0
    v_mfma_f32_16x16x32_bf16 v[80:83], a[100:103], a[20:23], v[80:83]
    v_mfma_f32_16x16x32_bf16 v[80:83], a[104:107], a[24:27], v[80:83]
    v_mfma_f32_16x16x32_bf16 v[80:83], a[108:111], a[28:31], v[80:83]
    v_mfma_f32_16x16x32_bf16 v[84:87], a[124:127], a[28:31], 0
    v_mfma_f32_16x16x32_bf16 v[84:87], a[120:123], a[24:27], v[84:87]
    v_mfma_f32_16x16x32_bf16 v[84:87], a[116:119], a[20:23], v[84:87]
    v_mfma_f32_16x16x32_bf16 v[84:87], a[112:115], a[16:19], v[84:87]
    v_mfma_f32_16x16x32_bf16 v[96:99], a[96:99], a[32:35], 0
    v_mfma_f32_16x16x32_bf16 v[96:99], a[100:103], a[36:39], v[96:99]
    v_mfma_f32_16x16x32_bf16 v[96:99], a[104:107], a[40:43], v[96:99]
    v_mfma_f32_16x16x32_bf16 v[96:99], a[108:111], a[44:47], v[96:99]
    v_mfma_f32_16x16x32_bf16 v[100:103], a[124:127], a[44:47], 0
    v_mfma_f32_16x16x32_bf16 v[100:103], a[120:123], a[40:43], v[100:103]
    v_mfma_f32_16x16x32_bf16 v[100:103], a[116:119], a[36:39], v[100:103]
    v_mfma_f32_16x16x32_bf16 v[100:103], a[112:115], a[32:35], v[100:103]
    v_mfma_f32_16x16x32_bf16 v[112:115], a[96:99], a[48:51], 0
    v_mfma_f32_16x16x32_bf16 v[112:115], a[100:103], a[52:55], v[112:115]
    v_mfma_f32_16x16x32_bf16 v[112:115], a[104:107], a[56:59], v[112:115]
    v_mfma_f32_16x16x32_bf16 v[112:115], a[108:111], a[60:63], v[112:115]
    v_mfma_f32_16x16x32_bf16 v[116:119], a[124:127], a[60:63], 0
    v_mfma_f32_16x16x32_bf16 v[116:119], a[120:123], a[56:59], v[116:119]
    v_mfma_f32_16x16x32_bf16 v[116:119], a[116:119], a[52:55], v[116:119]
    v_mfma_f32_16x16x32_bf16 v[116:119], a[112:115], a[48:51], v[116:119]
    v_max3_f32 v16, v4, v64, v65
    v_max3_f32 v17, v5, v80, v81
    v_max3_f32 v18, v6, v96, v97
    s_nop 0
    v_max3_f32 v19, v7, v112, v113
    v_max3_f32 v16, v16, v66, v67
    v_max3_f32 v17, v17, v82, v83
    v_max3_f32 v18, v18, v98, v99
    v_max3_f32 v19, v19, v114, v115
    v_max3_f32 v16, v16, v68, v69
    v_max3_f32 v17, v17, v84, v85
    v_max3_f32 v18, v18, v100, v101
    v_max3_f32 v19, v19, v116, v117
    v_max3_f32 v16, v16, v70, v71
    v_max3_f32 v17, v17, v86, v87
    v_max3_f32 v18, v18, v102, v103
    v_max3_f32 v19, v19, v118, v119
    v_mov_b32 v20, v16
    v_mov_b32 v21, v17
    v_mov_b32 v22, v18
    v_mov_b32 v23, v19
    v_permlane32_swap_b32 v20, v16
    v_permlane32_swap_b32 v21, v17
    v_permlane32_swap_b32 v22, v18
    v_permlane32_swap_b32 v23, v19
    v_max_f32 v16, v16, v20
    v_max_f32 v17, v17, v21
    v_max_f32 v18, v18, v22
    v_max_f32 v19, v19, v23
    v_mov_b32 v20, v16
    v_mov_b32 v21, v17
    v_mov_b32 v22, v18
    v_mov_b32 v23, v19
    v_permlane16_swap_b32 v20, v16
    v_permlane16_swap_b32 v21, v17
    v_permlane16_swap_b32 v22, v18
    v_permlane16_swap_b32 v23, v19
    v_max_f32 v16, v16, v20
    v_max_f32 v17, v17, v21
    v_max_f32 v18, v18, v22
    v_max_f32 v19, v19, v23
    v_sub_f32 v12, v4, v16
    v_mul_f32 v12, s20, v12
    v_exp_f32 v12, v12
    v_mov_b32 v4, v16
    v_mul_f32 v8, v8, v12
    v_sub_f32 v64, v64, v4
    v_mul_f32 v64, s20, v64
    v_exp_f32 v64, v64
    s_nop 0
    v_add_f32 v8, v8, v64
    v_sub_f32 v65, v65, v4
    v_mul_f32 v65, s20, v65
    v_exp_f32 v65, v65
    s_nop 0
    v_add_f32 v8, v8, v65
    v_sub_f32 v66, v66, v4
    v_mul_f32 v66, s20, v66
    v_exp_f32 v66, v66
    s_nop 0
    v_add_f32 v8, v8, v66
    v_sub_f32 v67, v67, v4
    v_mul_f32 v67, s20, v67
    v_exp_f32 v67, v67
    s_nop 0
    v_add_f32 v8, v8, v67
    v_sub_f32 v68, v68, v4
    v_mul_f32 v68, s20, v68
    v_exp_f32 v68, v68
    s_nop 0
    v_add_f32 v8, v8, v68
    v_sub_f32 v69, v69, v4
    v_mul_f32 v69, s20, v69
    v_exp_f32 v69, v69
    s_nop 0
    v_add_f32 v8, v8, v69
    v_sub_f32 v70, v70, v4
    v_mul_f32 v70, s20, v70
    v_exp_f32 v70, v70
    s_nop 0
    v_add_f32 v8, v8, v70
    v_sub_f32 v71, v71, v4
    v_mul_f32 v71, s20, v71
    v_exp_f32 v71, v71
    s_nop 0
    v_add_f32 v8, v8, v71
    v_cvt_pk_bf16_f32 v32, v64, v65
    v_cvt_pk_bf16_f32 v33, v66, v67
    v_cvt_pk_bf16_f32 v34, v68, v69
    v_cvt_pk_bf16_f32 v35, v70, v71
    v_mul_f32 v128, v128, v12
    v_mul_f32 v129, v129, v12
    v_mul_f32 v130, v130, v12
    v_mul_f32 v131, v131, v12
    v_mul_f32 v132, v132, v12
    v_mul_f32 v133, v133, v12
    v_mul_f32 v134, v134, v12
    v_mul_f32 v135, v135, v12
    v_mul_f32 v136, v136, v12
    v_mul_f32 v137, v137, v12
    v_mul_f32 v138, v138, v12
    v_mul_f32 v139, v139, v12
    v_mul_f32 v140, v140, v12
    v_mul_f32 v141, v141, v12
    v_mul_f32 v142, v142, v12
    v_mul_f32 v143, v143, v12
    v_mul_f32 v144, v144, v12
    v_mul_f32 v145, v145, v12
    v_mul_f32 v146, v146, v12
    v_mul_f32 v147, v147, v12
    v_mul_f32 v148, v148, v12
    v_mul_f32 v149, v149, v12
    v_mul_f32 v150, v150, v12
    v_mul_f32 v151, v151, v12
    v_mul_f32 v152, v152, v12
    v_mul_f32 v153, v153, v12
    v_mul_f32 v154, v154, v12
    v_mul_f32 v155, v155, v12
    v_mul_f32 v156, v156, v12
    v_mul_f32 v157, v157, v12
    v_mul_f32 v158, v158, v12
    v_mul_f32 v159, v159, v12
    v_sub_f32 v13, v5, v17
    v_mul_f32 v13, s20, v13
    v_exp_f32 v13, v13
    v_mov_b32 v5, v17
    v_mul_f32 v9, v9, v13
    v_sub_f32 v80, v80, v5
    v_mul_f32 v80, s20, v80
    v_exp_f32 v80, v80
    s_nop 0
    v_add_f32 v9, v9, v80
    v_sub_f32 v81, v81, v5
    v_mul_f32 v81, s20, v81
    v_exp_f32 v81, v81
    s_nop 0
    v_add_f32 v9, v9, v81
    v_sub_f32 v82, v82, v5
    v_mul_f32 v82, s20, v82
    v_exp_f32 v82, v82
    s_nop 0
    v_add_f32 v9, v9, v82
    v_sub_f32 v83, v83, v5
    v_mul_f32 v83, s20, v83
    v_exp_f32 v83, v83
    s_nop 0
    v_add_f32 v9, v9, v83
    v_sub_f32 v84, v84, v5
    v_mul_f32 v84, s20, v84
    v_exp_f32 v84, v84
    s_nop 0
    v_add_f32 v9, v9, v84
    v_sub_f32 v85, v85, v5
    v_mul_f32 v85, s20, v85
    v_exp_f32 v85, v85
    s_nop 0
    v_add_f32 v9, v9, v85
    v_sub_f32 v86, v86, v5
    v_mul_f32 v86, s20, v86
    v_exp_f32 v86, v86
    s_nop 0
    v_add_f32 v9, v9, v86
    v_sub_f32 v87, v87, v5
    v_mul_f32 v87, s20, v87
    v_exp_f32 v87, v87
    s_nop 0
    v_add_f32 v9, v9, v87
    v_cvt_pk_bf16_f32 v40, v80, v81
    v_cvt_pk_bf16_f32 v41, v82, v83
    v_cvt_pk_bf16_f32 v42, v84, v85
    v_cvt_pk_bf16_f32 v43, v86, v87
    v_mul_f32 v160, v160, v13
    v_mul_f32 v161, v161, v13
    v_mul_f32 v162, v162, v13
    v_mul_f32 v163, v163, v13
    v_mul_f32 v164, v164, v13
    v_mul_f32 v165, v165, v13
    v_mul_f32 v166, v166, v13
    v_mul_f32 v167, v167, v13
    v_mul_f32 v168, v168, v13
    v_mul_f32 v169, v169, v13
    v_mul_f32 v170, v170, v13
    v_mul_f32 v171, v171, v13
    v_mul_f32 v172, v172, v13
    v_mul_f32 v173, v173, v13
    v_mul_f32 v174, v174, v13
    v_mul_f32 v175, v175, v13
    v_mul_f32 v176, v176, v13
    v_mul_f32 v177, v177, v13
    v_mul_f32 v178, v178, v13
    v_mul_f32 v179, v179, v13
    v_mul_f32 v180, v180, v13
    v_mul_f32 v181, v181, v13
    v_mul_f32 v182, v182, v13
    v_mul_f32 v183, v183, v13
    v_mul_f32 v184, v184, v13
    v_mul_f32 v185, v185, v13
    v_mul_f32 v186, v186, v13
    v_mul_f32 v187, v187, v13
    v_mul_f32 v188, v188, v13
    v_mul_f32 v189, v189, v13
    v_mul_f32 v190, v190, v13
    v_mul_f32 v191, v191, v13
    v_sub_f32 v14, v6, v18
    v_mul_f32 v14, s20, v14
    v_exp_f32 v14, v14
    v_mov_b32 v6, v18
    v_mul_f32 v10, v10, v14
    v_sub_f32 v96, v96, v6
    v_mul_f32 v96, s20, v96
    v_exp_f32 v96, v96
    s_nop 0
    v_add_f32 v10, v10, v96
    v_sub_f32 v97, v97, v6
    v_mul_f32 v97, s20, v97
    v_exp_f32 v97, v97
    s_nop 0
    v_add_f32 v10, v10, v97
    v_sub_f32 v98, v98, v6
    v_mul_f32 v98, s20, v98
    v_exp_f32 v98, v98
    s_nop 0
    v_add_f32 v10, v10, v98
    v_sub_f32 v99, v99, v6
    v_mul_f32 v99, s20, v99
    v_exp_f32 v99, v99
    s_nop 0
    v_add_f32 v10, v10, v99
    v_sub_f32 v100, v100, v6
    v_mul_f32 v100, s20, v100
    v_exp_f32 v100, v100
    s_nop 0
    v_add_f32 v10, v10, v100
    v_sub_f32 v101, v101, v6
    v_mul_f32 v101, s20, v101
    v_exp_f32 v101, v101
    s_nop 0
    v_add_f32 v10, v10, v101
    v_sub_f32 v102, v102, v6
    v_mul_f32 v102, s20, v102
    v_exp_f32 v102, v102
    s_nop 0
    v_add_f32 v10, v10, v102
    v_sub_f32 v103, v103, v6
    v_mul_f32 v103, s20, v103
    v_exp_f32 v103, v103
    s_nop 0
    v_add_f32 v10, v10, v103
    v_cvt_pk_bf16_f32 v48, v96, v97
    v_cvt_pk_bf16_f32 v49, v98, v99
    v_cvt_pk_bf16_f32 v50, v100, v101
    v_cvt_pk_bf16_f32 v51, v102, v103
    v_mul_f32 v192, v192, v14
    v_mul_f32 v193, v193, v14
    v_mul_f32 v194, v194, v14
    v_mul_f32 v195, v195, v14
    v_mul_f32 v196, v196, v14
    v_mul_f32 v197, v197, v14
    v_mul_f32 v198, v198, v14
    v_mul_f32 v199, v199, v14
    v_mul_f32 v200, v200, v14
    v_mul_f32 v201, v201, v14
    v_mul_f32 v202, v202, v14
    v_mul_f32 v203, v203, v14
    v_mul_f32 v204, v204, v14
    v_mul_f32 v205, v205, v14
    v_mul_f32 v206, v206, v14
    v_mul_f32 v207, v207, v14
    v_mul_f32 v208, v208, v14
    v_mul_f32 v209, v209, v14
    v_mul_f32 v210, v210, v14
    v_mul_f32 v211, v211, v14
    v_mul_f32 v212, v212, v14
    v_mul_f32 v213, v213, v14
    v_mul_f32 v214, v214, v14
    v_mul_f32 v215, v215, v14
    v_mul_f32 v216, v216, v14
    v_mul_f32 v217, v217, v14
    v_mul_f32 v218, v218, v14
    v_mul_f32 v219, v219, v14
    v_mul_f32 v220, v220, v14
    v_mul_f32 v221, v221, v14
    v_mul_f32 v222, v222, v14
    v_mul_f32 v223, v223, v14
    v_sub_f32 v15, v7, v19
    v_mul_f32 v15, s20, v15
    v_exp_f32 v15, v15
    v_mov_b32 v7, v19
    v_mul_f32 v11, v11, v15
    v_sub_f32 v112, v112, v7
    v_mul_f32 v112, s20, v112
    v_exp_f32 v112, v112
    s_nop 0
    v_add_f32 v11, v11, v112
    v_sub_f32 v113, v113, v7
    v_mul_f32 v113, s20, v113
    v_exp_f32 v113, v113
    s_nop 0
    v_add_f32 v11, v11, v113
    v_sub_f32 v114, v114, v7
    v_mul_f32 v114, s20, v114
    v_exp_f32 v114, v114
    s_nop 0
    v_add_f32 v11, v11, v114
    v_sub_f32 v115, v115, v7
    v_mul_f32 v115, s20, v115
    v_exp_f32 v115, v115
    s_nop 0
    v_add_f32 v11, v11, v115
    v_sub_f32 v116, v116, v7
    v_mul_f32 v116, s20, v116
    v_exp_f32 v116, v116
    s_nop 0
    v_add_f32 v11, v11, v116
    v_sub_f32 v117, v117, v7
    v_mul_f32 v117, s20, v117
    v_exp_f32 v117, v117
    s_nop 0
    v_add_f32 v11, v11, v117
    v_sub_f32 v118, v118, v7
    v_mul_f32 v118, s20, v118
    v_exp_f32 v118, v118
    s_nop 0
    v_add_f32 v11, v11, v118
    v_sub_f32 v119, v119, v7
    v_mul_f32 v119, s20, v119
    v_exp_f32 v119, v119
    s_nop 0
    v_add_f32 v11, v11, v119
    v_cvt_pk_bf16_f32 v56, v112, v113
    v_cvt_pk_bf16_f32 v57, v114, v115
    v_cvt_pk_bf16_f32 v58, v116, v117
    v_cvt_pk_bf16_f32 v59, v118, v119
    v_mul_f32 v224, v224, v15
    v_mul_f32 v225, v225, v15
    v_mul_f32 v226, v226, v15
    v_mul_f32 v227, v227, v15
    v_mul_f32 v228, v228, v15
    v_mul_f32 v229, v229, v15
    v_mul_f32 v230, v230, v15
    v_mul_f32 v231, v231, v15
    v_mul_f32 v232, v232, v15
    v_mul_f32 v233, v233, v15
    v_mul_f32 v234, v234, v15
    v_mul_f32 v235, v235, v15
    v_mul_f32 v236, v236, v15
    v_mul_f32 v237, v237, v15
    v_mul_f32 v238, v238, v15
    v_mul_f32 v239, v239, v15
    v_mul_f32 v240, v240, v15
    v_mul_f32 v241, v241, v15
    v_mul_f32 v242, v242, v15
    v_mul_f32 v243, v243, v15
    v_mul_f32 v244, v244, v15
    v_mul_f32 v245, v245, v15
    v_mul_f32 v246, v246, v15
    v_mul_f32 v247, v247, v15
    v_mul_f32 v248, v248, v15
    v_mul_f32 v249, v249, v15
    v_mul_f32 v250, v250, v15
    v_mul_f32 v251, v251, v15
    v_mul_f32 v252, v252, v15
    v_mul_f32 v253, v253, v15
    v_mul_f32 v254, v254, v15
    v_mul_f32 v255, v255, v15
    v_mfma_f32_16x16x32_bf16 v[128:131], v[72:75], v[32:35], v[128:131]
    v_mfma_f32_16x16x32_bf16 v[160:163], v[72:75], v[40:43], v[160:163]
    v_mfma_f32_16x16x32_bf16 v[192:195], v[72:75], v[48:51], v[192:195]
    v_mfma_f32_16x16x32_bf16 v[224:227], v[72:75], v[56:59], v[224:227]
    v_mfma_f32_16x16x32_bf16 v[132:135], v[76:79], v[32:35], v[132:135]
    v_mfma_f32_16x16x32_bf16 v[164:167], v[76:79], v[40:43], v[164:167]
    v_mfma_f32_16x16x32_bf16 v[196:199], v[76:79], v[48:51], v[196:199]
    v_mfma_f32_16x16x32_bf16 v[228:231], v[76:79], v[56:59], v[228:231]
    v_mfma_f32_16x16x32_bf16 v[136:139], v[88:91], v[32:35], v[136:139]
    v_mfma_f32_16x16x32_bf16 v[168:171], v[88:91], v[40:43], v[168:171]
    v_mfma_f32_16x16x32_bf16 v[200:203], v[88:91], v[48:51], v[200:203]
    v_mfma_f32_16x16x32_bf16 v[232:235], v[88:91], v[56:59], v[232:235]
    v_mfma_f32_16x16x32_bf16 v[140:143], v[92:95], v[32:35], v[140:143]
    v_mfma_f32_16x16x32_bf16 v[172:175], v[92:95], v[40:43], v[172:175]
    v_mfma_f32_16x16x32_bf16 v[204:207], v[92:95], v[48:51], v[204:207]
    v_mfma_f32_16x16x32_bf16 v[236:239], v[92:95], v[56:59], v[236:239]
    v_mfma_f32_16x16x32_bf16 v[144:147], v[104:107], v[32:35], v[144:147]
    v_mfma_f32_16x16x32_bf16 v[176:179], v[104:107], v[40:43], v[176:179]
    v_mfma_f32_16x16x32_bf16 v[208:211], v[104:107], v[48:51], v[208:211]
    v_mfma_f32_16x16x32_bf16 v[240:243], v[104:107], v[56:59], v[240:243]
    v_mfma_f32_16x16x32_bf16 v[148:151], v[108:111], v[32:35], v[148:151]
    v_mfma_f32_16x16x32_bf16 v[180:183], v[108:111], v[40:43], v[180:183]
    v_mfma_f32_16x16x32_bf16 v[212:215], v[108:111], v[48:51], v[212:215]
    v_mfma_f32_16x16x32_bf16 v[244:247], v[108:111], v[56:59], v[244:247]
    v_mfma_f32_16x16x32_bf16 v[152:155], v[120:123], v[32:35], v[152:155]
    v_mfma_f32_16x16x32_bf16 v[184:187], v[120:123], v[40:43], v[184:187]
    v_mfma_f32_16x16x32_bf16 v[216:219], v[120:123], v[48:51], v[216:219]
    v_mfma_f32_16x16x32_bf16 v[248:251], v[120:123], v[56:59], v[248:251]
    v_mfma_f32_16x16x32_bf16 v[156:159], v[124:127], v[32:35], v[156:159]
    v_mfma_f32_16x16x32_bf16 v[188:191], v[124:127], v[40:43], v[188:191]
    v_mfma_f32_16x16x32_bf16 v[220:223], v[124:127], v[48:51], v[220:223]
    v_mfma_f32_16x16x32_bf16 v[252:255], v[124:127], v[56:59], v[252:255]
    s_nop 15
    s_add_u32 s38, s38, 8192
    s_add_u32 s39, s39, 1
    s_cmp_lt_u32 s39, 16
    s_cbranch_scc1 L_slow_tile
    v_mov_b32 v20, v8
    v_mov_b32 v21, v9
    v_mov_b32 v22, v10
    v_mov_b32 v23, v11
    v_permlane32_swap_b32 v20, v8
    v_permlane32_swap_b32 v21, v9
    v_permlane32_swap_b32 v22, v10
    v_permlane32_swap_b32 v23, v11
    v_add_f32 v8, v8, v20
    v_add_f32 v9, v9, v21
    v_add_f32 v10, v10, v22
    v_add_f32 v11, v11, v23
    v_mov_b32 v20, v8
    v_mov_b32 v21, v9
    v_mov_b32 v22, v10
    v_mov_b32 v23, v11
    v_permlane16_swap_b32 v20, v8
    v_permlane16_swap_b32 v21, v9
    v_permlane16_swap_b32 v22, v10
    v_permlane16_swap_b32 v23, v11
    v_add_f32 v8, v8, v20
    v_add_f32 v9, v9, v21
    v_add_f32 v10, v10, v22
    v_add_f32 v11, v11, v23
    v_rcp_f32 v12, v8
    v_rcp_f32 v13, v9
    v_rcp_f32 v14, v10
    v_rcp_f32 v15, v11
    v_lshrrev_b32 v17, 4, v0
    v_lshlrev_b32 v17, 3, v17
    v_sub_u32 v2, v2, v17
    s_xor_b32 s40, s36, 0
    v_mul_f32 v128, v128, v12
    v_mul_f32 v129, v129, v12
    v_mul_f32 v130, v130, v12
    v_mul_f32 v131, v131, v12
    v_cvt_pk_bf16_f32 v128, v128, v129
    v_cvt_pk_bf16_f32 v129, v130, v131
    buffer_store_dwordx2 v[128:129], v2, s[16:19], s40 offen offset:0
    v_mul_f32 v132, v132, v12
    v_mul_f32 v133, v133, v12
    v_mul_f32 v134, v134, v12
    v_mul_f32 v135, v135, v12
    v_cvt_pk_bf16_f32 v132, v132, v133
    v_cvt_pk_bf16_f32 v133, v134, v135
    buffer_store_dwordx2 v[132:133], v2, s[16:19], s40 offen offset:32
    v_mul_f32 v136, v136, v12
    v_mul_f32 v137, v137, v12
    v_mul_f32 v138, v138, v12
    v_mul_f32 v139, v139, v12
    v_cvt_pk_bf16_f32 v136, v136, v137
    v_cvt_pk_bf16_f32 v137, v138, v139
    buffer_store_dwordx2 v[136:137], v2, s[16:19], s40 offen offset:64
    v_mul_f32 v140, v140, v12
    v_mul_f32 v141, v141, v12
    v_mul_f32 v142, v142, v12
    v_mul_f32 v143, v143, v12
    v_cvt_pk_bf16_f32 v140, v140, v141
    v_cvt_pk_bf16_f32 v141, v142, v143
    buffer_store_dwordx2 v[140:141], v2, s[16:19], s40 offen offset:96
    v_mul_f32 v144, v144, v12
    v_mul_f32 v145, v145, v12
    v_mul_f32 v146, v146, v12
    v_mul_f32 v147, v147, v12
    v_cvt_pk_bf16_f32 v144, v144, v145
    v_cvt_pk_bf16_f32 v145, v146, v147
    buffer_store_dwordx2 v[144:145], v2, s[16:19], s40 offen offset:128
    v_mul_f32 v148, v148, v12
    v_mul_f32 v149, v149, v12
    v_mul_f32 v150, v150, v12
    v_mul_f32 v151, v151, v12
    v_cvt_pk_bf16_f32 v148, v148, v149
    v_cvt_pk_bf16_f32 v149, v150, v151
    buffer_store_dwordx2 v[148:149], v2, s[16:19], s40 offen offset:160
    v_mul_f32 v152, v152, v12
    v_mul_f32 v153, v153, v12
    v_mul_f32 v154, v154, v12
    v_mul_f32 v155, v155, v12
    v_cvt_pk_bf16_f32 v152, v152, v153
    v_cvt_pk_bf16_f32 v153, v154, v155
    buffer_store_dwordx2 v[152:153], v2, s[16:19], s40 offen offset:192
    v_mul_f32 v156, v156, v12
    v_mul_f32 v157, v157, v12
    v_mul_f32 v158, v158, v12
    v_mul_f32 v159, v159, v12
    v_cvt_pk_bf16_f32 v156, v156, v157
    v_cvt_pk_bf16_f32 v157, v158, v159
    buffer_store_dwordx2 v[156:157], v2, s[16:19], s40 offen offset:224
    s_xor_b32 s40, s36, 4096
    v_mul_f32 v160, v160, v13
    v_mul_f32 v161, v161, v13
    v_mul_f32 v162, v162, v13
    v_mul_f32 v163, v163, v13
    v_cvt_pk_bf16_f32 v160, v160, v161
    v_cvt_pk_bf16_f32 v161, v162, v163
    buffer_store_dwordx2 v[160:161], v2, s[16:19], s40 offen offset:0
    v_mul_f32 v164, v164, v13
    v_mul_f32 v165, v165, v13
    v_mul_f32 v166, v166, v13
    v_mul_f32 v167, v167, v13
    v_cvt_pk_bf16_f32 v164, v164, v165
    v_cvt_pk_bf16_f32 v165, v166, v167
    buffer_store_dwordx2 v[164:165], v2, s[16:19], s40 offen offset:32
    v_mul_f32 v168, v168, v13
    v_mul_f32 v169, v169, v13
    v_mul_f32 v170, v170, v13
    v_mul_f32 v171, v171, v13
    v_cvt_pk_bf16_f32 v168, v168, v169
    v_cvt_pk_bf16_f32 v169, v170, v171
    buffer_store_dwordx2 v[168:169], v2, s[16:19], s40 offen offset:64
    v_mul_f32 v172, v172, v13
    v_mul_f32 v173, v173, v13
    v_mul_f32 v174, v174, v13
    v_mul_f32 v175, v175, v13
    v_cvt_pk_bf16_f32 v172, v172, v173
    v_cvt_pk_bf16_f32 v173, v174, v175
    buffer_store_dwordx2 v[172:173], v2, s[16:19], s40 offen offset:96
    v_mul_f32 v176, v176, v13
    v_mul_f32 v177, v177, v13
    v_mul_f32 v178, v178, v13
    v_mul_f32 v179, v179, v13
    v_cvt_pk_bf16_f32 v176, v176, v177
    v_cvt_pk_bf16_f32 v177, v178, v179
    buffer_store_dwordx2 v[176:177], v2, s[16:19], s40 offen offset:128
    v_mul_f32 v180, v180, v13
    v_mul_f32 v181, v181, v13
    v_mul_f32 v182, v182, v13
    v_mul_f32 v183, v183, v13
    v_cvt_pk_bf16_f32 v180, v180, v181
    v_cvt_pk_bf16_f32 v181, v182, v183
    buffer_store_dwordx2 v[180:181], v2, s[16:19], s40 offen offset:160
    v_mul_f32 v184, v184, v13
    v_mul_f32 v185, v185, v13
    v_mul_f32 v186, v186, v13
    v_mul_f32 v187, v187, v13
    v_cvt_pk_bf16_f32 v184, v184, v185
    v_cvt_pk_bf16_f32 v185, v186, v187
    buffer_store_dwordx2 v[184:185], v2, s[16:19], s40 offen offset:192
    v_mul_f32 v188, v188, v13
    v_mul_f32 v189, v189, v13
    v_mul_f32 v190, v190, v13
    v_mul_f32 v191, v191, v13
    v_cvt_pk_bf16_f32 v188, v188, v189
    v_cvt_pk_bf16_f32 v189, v190, v191
    buffer_store_dwordx2 v[188:189], v2, s[16:19], s40 offen offset:224
    s_xor_b32 s40, s36, 8192
    v_mul_f32 v192, v192, v14
    v_mul_f32 v193, v193, v14
    v_mul_f32 v194, v194, v14
    v_mul_f32 v195, v195, v14
    v_cvt_pk_bf16_f32 v192, v192, v193
    v_cvt_pk_bf16_f32 v193, v194, v195
    buffer_store_dwordx2 v[192:193], v2, s[16:19], s40 offen offset:0
    v_mul_f32 v196, v196, v14
    v_mul_f32 v197, v197, v14
    v_mul_f32 v198, v198, v14
    v_mul_f32 v199, v199, v14
    v_cvt_pk_bf16_f32 v196, v196, v197
    v_cvt_pk_bf16_f32 v197, v198, v199
    buffer_store_dwordx2 v[196:197], v2, s[16:19], s40 offen offset:32
    v_mul_f32 v200, v200, v14
    v_mul_f32 v201, v201, v14
    v_mul_f32 v202, v202, v14
    v_mul_f32 v203, v203, v14
    v_cvt_pk_bf16_f32 v200, v200, v201
    v_cvt_pk_bf16_f32 v201, v202, v203
    buffer_store_dwordx2 v[200:201], v2, s[16:19], s40 offen offset:64
    v_mul_f32 v204, v204, v14
    v_mul_f32 v205, v205, v14
    v_mul_f32 v206, v206, v14
    v_mul_f32 v207, v207, v14
    v_cvt_pk_bf16_f32 v204, v204, v205
    v_cvt_pk_bf16_f32 v205, v206, v207
    buffer_store_dwordx2 v[204:205], v2, s[16:19], s40 offen offset:96
    v_mul_f32 v208, v208, v14
    v_mul_f32 v209, v209, v14
    v_mul_f32 v210, v210, v14
    v_mul_f32 v211, v211, v14
    v_cvt_pk_bf16_f32 v208, v208, v209
    v_cvt_pk_bf16_f32 v209, v210, v211
    buffer_store_dwordx2 v[208:209], v2, s[16:19], s40 offen offset:128
    v_mul_f32 v212, v212, v14
    v_mul_f32 v213, v213, v14
    v_mul_f32 v214, v214, v14
    v_mul_f32 v215, v215, v14
    v_cvt_pk_bf16_f32 v212, v212, v213
    v_cvt_pk_bf16_f32 v213, v214, v215
    buffer_store_dwordx2 v[212:213], v2, s[16:19], s40 offen offset:160
    v_mul_f32 v216, v216, v14
    v_mul_f32 v217, v217, v14
    v_mul_f32 v218, v218, v14
    v_mul_f32 v219, v219, v14
    v_cvt_pk_bf16_f32 v216, v216, v217
    v_cvt_pk_bf16_f32 v217, v218, v219
    buffer_store_dwordx2 v[216:217], v2, s[16:19], s40 offen offset:192
    v_mul_f32 v220, v220, v14
    v_mul_f32 v221, v221, v14
    v_mul_f32 v222, v222, v14
    v_mul_f32 v223, v223, v14
    v_cvt_pk_bf16_f32 v220, v220, v221
    v_cvt_pk_bf16_f32 v221, v222, v223
    buffer_store_dwordx2 v[220:221], v2, s[16:19], s40 offen offset:224
    s_xor_b32 s40, s36, 12288
    v_mul_f32 v224, v224, v15
    v_mul_f32 v225, v225, v15
    v_mul_f32 v226, v226, v15
    v_mul_f32 v227, v227, v15
    v_cvt_pk_bf16_f32 v224, v224, v225
    v_cvt_pk_bf16_f32 v225, v226, v227
    buffer_store_dwordx2 v[224:225], v2, s[16:19], s40 offen offset:0
    v_mul_f32 v228, v228, v15
    v_mul_f32 v229, v229, v15
    v_mul_f32 v230, v230, v15
    v_mul_f32 v231, v231, v15
    v_cvt_pk_bf16_f32 v228, v228, v229
    v_cvt_pk_bf16_f32 v229, v230, v231
    buffer_store_dwordx2 v[228:229], v2, s[16:19], s40 offen offset:32
    v_mul_f32 v232, v232, v15
    v_mul_f32 v233, v233, v15
    v_mul_f32 v234, v234, v15
    v_mul_f32 v235, v235, v15
    v_cvt_pk_bf16_f32 v232, v232, v233
    v_cvt_pk_bf16_f32 v233, v234, v235
    buffer_store_dwordx2 v[232:233], v2, s[16:19], s40 offen offset:64
    v_mul_f32 v236, v236, v15
    v_mul_f32 v237, v237, v15
    v_mul_f32 v238, v238, v15
    v_mul_f32 v239, v239, v15
    v_cvt_pk_bf16_f32 v236, v236, v237
    v_cvt_pk_bf16_f32 v237, v238, v239
    buffer_store_dwordx2 v[236:237], v2, s[16:19], s40 offen offset:96
    v_mul_f32 v240, v240, v15
    v_mul_f32 v241, v241, v15
    v_mul_f32 v242, v242, v15
    v_mul_f32 v243, v243, v15
    v_cvt_pk_bf16_f32 v240, v240, v241
    v_cvt_pk_bf16_f32 v241, v242, v243
    buffer_store_dwordx2 v[240:241], v2, s[16:19], s40 offen offset:128
    v_mul_f32 v244, v244, v15
    v_mul_f32 v245, v245, v15
    v_mul_f32 v246, v246, v15
    v_mul_f32 v247, v247, v15
    v_cvt_pk_bf16_f32 v244, v244, v245
    v_cvt_pk_bf16_f32 v245, v246, v247
    buffer_store_dwordx2 v[244:245], v2, s[16:19], s40 offen offset:160
    v_mul_f32 v248, v248, v15
    v_mul_f32 v249, v249, v15
    v_mul_f32 v250, v250, v15
    v_mul_f32 v251, v251, v15
    v_cvt_pk_bf16_f32 v248, v248, v249
    v_cvt_pk_bf16_f32 v249, v250, v251
    buffer_store_dwordx2 v[248:249], v2, s[16:19], s40 offen offset:192
    v_mul_f32 v252, v252, v15
    v_mul_f32 v253, v253, v15
    v_mul_f32 v254, v254, v15
    v_mul_f32 v255, v255, v15
    v_cvt_pk_bf16_f32 v252, v252, v253
    v_cvt_pk_bf16_f32 v253, v254, v255
    buffer_store_dwordx2 v[252:253], v2, s[16:19], s40 offen offset:224
    s_waitcnt vmcnt(0)
    s_branch L_slow_next
L_end:
    s_endpgm
.fill 64, 4, 0xbf800000
.section .rodata,"a"
.p2align 6
.amdhsa_kernel standalone__mha_softmax__near_ridge_kernel
  .amdhsa_next_free_vgpr 512
  .amdhsa_next_free_sgpr 102
  .amdhsa_accum_offset 256
  .amdhsa_group_segment_fixed_size 0
  .amdhsa_kernarg_size 48
  .amdhsa_user_sgpr_count 2
  .amdhsa_user_sgpr_kernarg_segment_ptr 1
  .amdhsa_system_sgpr_workgroup_id_x 1
  .amdhsa_float_denorm_mode_32 3
  .amdhsa_float_denorm_mode_16_64 3
.end_amdhsa_kernel
```
